```python
import torch

def _softmax(x, axis=-1):
    return torch.softmax(x, dim=axis)
def _gelu(x):
    return torch.nn.functional.gelu(x, approximate="tanh")
def _silu(x):
    return torch.nn.functional.silu(x)
def _sigmoid(x):
    return torch.sigmoid(x)
def _layernorm(x, axis=-1, eps=1e-5):
    m = x.mean(dim=axis, keepdim=True)
    v = x.var(dim=axis, keepdim=True, unbiased=False)
    return (x - m) / torch.sqrt(v + eps)
def _scatter_add(tgt, idx, src, axis=0):
    return tgt.clone().index_add_(axis, idx, src)
def _segment_sum(src, seg, n):
    out = torch.zeros((n,) + src.shape[1:], dtype=src.dtype)
    return out.index_add_(0, seg, src)
def _pad(x, pw):
    flat = tuple(v for pair in reversed(pw) for v in pair)
    return torch.nn.functional.pad(x, flat)

kernel_name = 'parallel_sum__ssm_conv_h3__swiglu_ffn__prompt'

def setup_inputs():

    _w = (lambda a: (lambda t: t.to(torch.bfloat16) if t.is_floating_point() else t)(torch.as_tensor(a)))
    def _A_setup():
        B, S, D = 1, 2048, 1024
        ks = 4
        return {
            "q": _w((lambda *s: torch.randn(*s, dtype=torch.bfloat16) * 0.05)(B, S, D)),
            "k": _w((lambda *s: torch.randn(*s, dtype=torch.bfloat16) * 0.8)(B, S, D)),
            "v": _w((lambda *s: torch.randn(*s, dtype=torch.bfloat16) * 0.8)(B, S, D)),
            "shift_k": _w((lambda *s: torch.randn(*s, dtype=torch.bfloat16) * 0.8)(D, ks) * 0.5),
            "ssm_k": _w((lambda *s: torch.randn(*s, dtype=torch.bfloat16) * 0.8)(D, S) * (1.0 / S ** 0.5)),
            "ssm_D": _w((lambda *s: torch.randn(*s, dtype=torch.bfloat16) * 0.8)(D)),
        }
    _A_in = _A_setup()

    def _B_setup():
        B, S, D, F = 1, 2048, 1024, 3584
        return {
            "x": _w((lambda *s: torch.randn(*s, dtype=torch.bfloat16) * 0.05)(B, S, D)),
            "w_gate": _w((lambda *s: torch.randn(*s, dtype=torch.bfloat16) * 0.05)(D, F)),
            "w_up": _w((lambda *s: torch.randn(*s, dtype=torch.bfloat16) * 0.05)(D, F)),
            "w_down": _w((lambda *s: torch.randn(*s, dtype=torch.bfloat16) * 0.05)(F, D)),
        }
    _B_in = _B_setup()

    return {
        "A_q": _A_in["q"],
        "A_k": _A_in["k"],
        "A_v": _A_in["v"],
        "A_shift_k": _A_in["shift_k"],
        "A_ssm_k": _A_in["ssm_k"],
        "A_ssm_D": _A_in["ssm_D"],
        "B_x": _B_in["x"],
        "B_w_gate": _B_in["w_gate"],
        "B_w_up": _B_in["w_up"],
        "B_w_down": _B_in["w_down"],
    }

def reference(A_q, A_k, A_v, A_shift_k, A_ssm_k, A_ssm_D, B_x, B_w_gate, B_w_up, B_w_down):
    def _A_ref(q, k, v, shift_k, ssm_k, ssm_D):
        B, S, D = q.shape
        ks = shift_k.shape[-1]
        k_pad = _pad(k, ((0, 0), (ks - 1, 0), (0, 0)))
        k_shift = torch.zeros_like(k)
        for t in range(ks):
            k_shift = k_shift + k_pad[:, t:t + S, :] * shift_k[:, ks - 1 - t][None, None, :]
        kv = k_shift * v
        L = 2 * S
        kv_pad = _pad(kv, ((0, 0), (0, S), (0, 0)))
        kf_pad = _pad(ssm_k, ((0, 0), (0, S)))
        kv_f = (lambda x, axes=(-2,-1): torch.fft.rfft2(x.float(), dim=axes))(kv_pad[:, None, :, :], axes=(1, 2))
        kf_f = (lambda x, axes=(-2,-1): torch.fft.rfft2(x.float(), dim=axes))(kf_pad[:, None, :], axes=(1, 2))
        kf_f = (lambda x, *d: x.permute(*d))(kf_f, 1, 2, 0)
        y_f = kv_f * kf_f[None, :, :, :]
        y = (lambda x, s, axes=(-2,-1): torch.fft.irfft2(x, s=s, dim=axes).to(torch.bfloat16))(y_f, (1, L), axes=(1, 2))[:, 0, :S, :]
        y = y + kv * ssm_D[None, None, :]
        return q * y

    def _B_ref(x, w_gate, w_up, w_down):
        g = _silu(x @ w_gate)
        u = x @ w_up
        return (g * u) @ w_down

    x = A_q
    xn = _layernorm(x, axis=-1)
    return x + _A_ref(xn, A_k, A_v, A_shift_k, A_ssm_k, A_ssm_D) + _B_ref(xn, B_w_gate, B_w_up, B_w_down)
```

```asm
; @launch grid=(256,1,1) block=(256,1,1) lds=163840
.amdgcn_target "amdgcn-amd-amdhsa--gfx950"
.text
.globl parallel_sum__ssm_conv_h3__swiglu_ffn__prompt_kernel
.p2align 8
.type parallel_sum__ssm_conv_h3__swiglu_ffn__prompt_kernel,@function
parallel_sum__ssm_conv_h3__swiglu_ffn__prompt_kernel:
    s_cmp_ge_u32 s2, 256
    s_cbranch_scc1 L_end
    s_load_dwordx2 s[8:9], s[0:1], 0
    s_load_dwordx2 s[12:13], s[0:1], 56
    s_load_dwordx2 s[16:17], s[0:1], 64
    s_load_dwordx2 s[88:89], s[0:1], 96
    s_load_dwordx2 s[28:29], s[0:1], 32
    s_load_dwordx2 s[40:41], s[0:1], 88
    s_load_dwordx2 s[44:45], s[0:1], 72
    s_load_dwordx2 s[48:49], s[0:1], 80
    s_load_dwordx2 s[52:53], s[0:1], 8
    s_load_dwordx2 s[56:57], s[0:1], 16
    s_load_dwordx2 s[60:61], s[0:1], 24
    s_load_dwordx2 s[86:87], s[0:1], 40
    s_getpc_b64 s[82:83]
L_pc:
    s_lshr_b32 s78, s2, 3
    s_and_b32 s78, s78, 3
    s_lshl_b32 s78, s78, 14
    v_lshlrev_b32 v50, 6, v0
    v_add_u32 v50, s78, v50
    v_min_u32 v50, L_end-L_pc, v50
    v_mov_b32 v51, s83
    v_add_co_u32 v50, vcc, s82, v50
    s_nop 1
    v_addc_co_u32 v51, vcc, 0, v51, vcc
    global_load_dword a255, v[50:51], off
    v_lshrrev_b32 v1, 6, v0
    v_mov_b32 v29, v0
    v_and_b32 v0, 63, v0
    v_readfirstlane_b32 s64, v1
    v_lshlrev_b32 v2, 4, v0
    s_mov_b32 s10, 0x400000
    s_mov_b32 s11, 0x20000
    s_mov_b32 s14, 0x700000
    s_mov_b32 s15, 0x20000
    s_mov_b32 s18, 0x700000
    s_mov_b32 s19, 0x20000
    s_and_b32 s6, s2, 7
    s_lshr_b32 s7, s2, 3
    s_and_b32 s65, s7, 7
    s_lshr_b32 s66, s7, 3
    s_lshl_b32 s78, s6, 2
    s_add_u32 s66, s66, s78
    s_mul_i32 s70, s64, 24576
    s_lshl_b32 s71, s64, 11
    s_add_u32 s71, s71, 98304
    s_lshr_b32 s3, s65, 1
    s_mul_i32 s72, s3, 1835008
    s_add_u32 s73, s72, 27648
    v_lshrrev_b32 v22, 4, v0
    v_bfe_u32 v23, v0, 1, 3
    s_and_b32 s78, s64, 1
    s_lshl_b32 s78, s78, 2
    v_or_b32 v24, s78, v22
    v_xor_b32 v23, v23, v24
    v_and_b32 v25, 1, v0
    s_lshl_b32 s78, s64, 3
    v_lshlrev_b32 v3, 5, v23
    v_lshl_add_u32 v3, v25, 4, v3
    v_add_u32 v26, s78, v22
    v_mul_u32_u24 v27, 7168, v26
    v_add_u32 v3, v3, v27
    s_mul_i32 s78, s66, 224
    v_add_u32 v3, s78, v3
    v_cmp_eq_u32 vcc, 7, v23
    v_mov_b32 v27, 0x80000000
    v_lshlrev_b32 v28, 8, v26
    v_cndmask_b32 v3, v3, v27, vcc
    v_lshl_add_u32 v28, v23, 5, v28
    v_lshl_add_u32 v28, v25, 4, v28
    v_lshrrev_b32 v23, 3, v0
    v_and_b32 v24, 7, v0
    v_xor_b32 v24, v24, v22
    s_lshl_b32 s78, s65, 19
    s_lshl_b32 s79, s64, 17
    s_add_u32 s78, s78, s79
    v_lshlrev_b32 v4, 11, v23
    v_add_u32 v4, s78, v4
    v_xor_b32 v25, 4, v24
    v_lshl_add_u32 v5, v25, 4, v4
    v_lshl_add_u32 v4, v24, 4, v4
    v_add_u32 v5, 15360, v5
    v_add_u32 v6, 30720, v4
    v_add_u32 v7, 30720, v5
    s_mul_i32 s77, s3, 512
    s_add_u32 s76, s70, 16384
    s_add_u32 s91, s70, 24576
    s_waitcnt lgkmcnt(0)
    s_add_u32 m0, s71, 0
    s_nop 0
    buffer_load_dwordx4 v3, s[12:15], s72 offen lds
    buffer_load_dwordx4 v3, s[12:15], s73 offen offset:1024 lds
    s_add_u32 m0, s71, 8192
    s_nop 0
    buffer_load_dwordx4 v3, s[16:19], s72 offen lds
    buffer_load_dwordx4 v3, s[16:19], s73 offen offset:1024 lds
    s_add_u32 s72, s72, 229376
    s_cmp_eq_u32 s72, 7340032
    s_cselect_b32 s72, 0, s72
    s_add_u32 s73, s72, 27648
    s_mov_b32 m0, s76
    s_nop 0
    buffer_load_dwordx4 v4, s[8:11], s77 offen lds
    buffer_load_dwordx4 v5, s[8:11], s77 offen offset:1024 lds
    buffer_load_dwordx4 v6, s[8:11], s77 offen offset:2048 lds
    buffer_load_dwordx4 v7, s[8:11], s77 offen offset:3072 lds
    s_add_u32 m0, s76, 4096
    s_add_u32 s79, s77, 0x10000
    buffer_load_dwordx4 v4, s[8:11], s79 offen lds
    buffer_load_dwordx4 v5, s[8:11], s79 offen offset:1024 lds
    buffer_load_dwordx4 v6, s[8:11], s79 offen offset:2048 lds
    buffer_load_dwordx4 v7, s[8:11], s79 offen offset:3072 lds
    s_add_u32 s77, s77, 128
    s_and_b32 s77, s77, 0x7ff
    s_add_u32 s76, s76, 8192
    s_cmp_eq_u32 s76, s91
    s_cselect_b32 s76, s70, s76
    s_add_u32 m0, s71, 16384
    s_nop 0
    buffer_load_dwordx4 v3, s[12:15], s72 offen lds
    buffer_load_dwordx4 v3, s[12:15], s73 offen offset:1024 lds
    s_add_u32 m0, s71, 24576
    s_nop 0
    buffer_load_dwordx4 v3, s[16:19], s72 offen lds
    buffer_load_dwordx4 v3, s[16:19], s73 offen offset:1024 lds
    s_add_u32 s72, s72, 229376
    s_cmp_eq_u32 s72, 7340032
    s_cselect_b32 s72, 0, s72
    s_add_u32 s73, s72, 27648
    s_lshl_b32 s69, s2, 2
    s_add_u32 s69, s69, s64
    s_lshr_b32 s78, s69, 1
    s_lshl_b32 s78, s78, 2
    s_load_dword s90, s[86:87], s78
    s_mov_b32 m0, s76
    s_nop 0
    buffer_load_dwordx4 v4, s[8:11], s77 offen lds
    buffer_load_dwordx4 v5, s[8:11], s77 offen offset:1024 lds
    buffer_load_dwordx4 v6, s[8:11], s77 offen offset:2048 lds
    buffer_load_dwordx4 v7, s[8:11], s77 offen offset:3072 lds
    s_add_u32 m0, s76, 4096
    s_add_u32 s79, s77, 0x10000
    buffer_load_dwordx4 v4, s[8:11], s79 offen lds
    buffer_load_dwordx4 v5, s[8:11], s79 offen offset:1024 lds
    buffer_load_dwordx4 v6, s[8:11], s79 offen offset:2048 lds
    buffer_load_dwordx4 v7, s[8:11], s79 offen offset:3072 lds
    s_add_u32 s77, s77, 128
    s_and_b32 s77, s77, 0x7ff
    s_add_u32 s76, s76, 8192
    s_cmp_eq_u32 s76, s91
    s_cselect_b32 s76, s70, s76
    s_add_u32 m0, s71, 32768
    s_nop 0
    buffer_load_dwordx4 v3, s[12:15], s72 offen lds
    buffer_load_dwordx4 v3, s[12:15], s73 offen offset:1024 lds
    s_add_u32 m0, s71, 40960
    s_nop 0
    buffer_load_dwordx4 v3, s[16:19], s72 offen lds
    buffer_load_dwordx4 v3, s[16:19], s73 offen offset:1024 lds
    s_add_u32 s72, s72, 229376
    s_cmp_eq_u32 s72, 7340032
    s_cselect_b32 s72, 0, s72
    s_add_u32 s73, s72, 27648
    v_bfe_u32 v24, v0, 2, 2
    v_and_b32 v25, 3, v0
    v_lshl_add_u32 v26, v22, 3, v24
    v_lshlrev_b32 v26, 8, v26
    v_lshl_add_u32 v26, v25, 3, v26
    v_add_u32 v26, 98304, v26
    v_and_b32 v27, 1, v22
    v_lshl_or_b32 v27, v27, 2, v24
    v_xor_b32 v1, 0, v27
    v_lshl_add_u32 v8, v1, 5, v26
    v_xor_b32 v1, 1, v27
    v_lshl_add_u32 v9, v1, 5, v26
    v_xor_b32 v1, 2, v27
    v_lshl_add_u32 v10, v1, 5, v26
    v_xor_b32 v1, 3, v27
    v_lshl_add_u32 v11, v1, 5, v26
    v_xor_b32 v1, 4, v27
    v_lshl_add_u32 v12, v1, 5, v26
    v_xor_b32 v1, 5, v27
    v_lshl_add_u32 v13, v1, 5, v26
    v_xor_b32 v1, 6, v27
    v_lshl_add_u32 v14, v1, 5, v26
    s_lshr_b32 s78, s64, 1
    s_lshl_b32 s78, s78, 13
    v_add_u32 v26, s78, v26
    s_and_b32 s78, s64, 1
    s_lshl_b32 s78, s78, 1
    s_and_b32 s79, s65, 1
    s_add_u32 s78, s78, s79
    s_lshl_b32 s85, s78, 1
    v_xor_b32 v27, s85, v27
    v_xor_b32 v1, 0, v27
    v_lshl_add_u32 v18, v1, 5, v26
    v_xor_b32 v1, 1, v27
    v_lshl_add_u32 v19, v1, 5, v26
    v_and_b32 v24, 15, v0
    v_lshrrev_b32 v25, 1, v24
    v_xor_b32 v25, v25, v22
    v_lshlrev_b32 v15, 7, v24
    v_lshl_add_u32 v15, v25, 4, v15
    v_add_u32 v15, s70, v15
    v_xor_b32 v16, 64, v15
    v_and_b32 v24, 3, v0
    v_mov_b32 v25, 0x3f803f80
    v_cmp_eq_u32 vcc, 0, v24
    s_nop 1
    v_cndmask_b32 v26, 0, v25, vcc
    v_accvgpr_write_b32 a160, v26
    v_accvgpr_write_b32 a161, v26
    v_accvgpr_write_b32 a162, v26
    v_accvgpr_write_b32 a163, v26
    v_cmp_eq_u32 vcc, 1, v24
    s_nop 1
    v_cndmask_b32 v26, 0, v25, vcc
    v_accvgpr_write_b32 a164, v26
    v_accvgpr_write_b32 a165, v26
    v_accvgpr_write_b32 a166, v26
    v_accvgpr_write_b32 a167, v26
    s_waitcnt vmcnt(16)
    s_waitcnt lgkmcnt(0)
    s_barrier
    s_movk_i32 s75, 16384
    v_add_u32 v17, s75, v15
    ds_read_b128 a[56:59], v17 offset:0
    ds_read_b128 a[60:63], v17 offset:2048
    ds_read_b128 a[64:67], v17 offset:4096
    ds_read_b128 a[68:71], v17 offset:6144
    ds_read_b64_tr_b16 a[0:1], v8 offset:0
    ds_read_b64_tr_b16 a[2:3], v8 offset:1024
    ds_read_b64_tr_b16 a[4:5], v9 offset:0
    ds_read_b64_tr_b16 a[6:7], v9 offset:1024
    ds_read_b64_tr_b16 a[8:9], v10 offset:0
    ds_read_b64_tr_b16 a[10:11], v10 offset:1024
    ds_read_b64_tr_b16 a[12:13], v11 offset:0
    ds_read_b64_tr_b16 a[14:15], v11 offset:1024
    ds_read_b64_tr_b16 a[16:17], v12 offset:0
    ds_read_b64_tr_b16 a[18:19], v12 offset:1024
    ds_read_b64_tr_b16 a[20:21], v13 offset:0
    ds_read_b64_tr_b16 a[22:23], v13 offset:1024
    ds_read_b64_tr_b16 a[24:25], v14 offset:0
    ds_read_b64_tr_b16 a[26:27], v14 offset:1024
    ds_read_b64_tr_b16 a[28:29], v8 offset:8192
    ds_read_b64_tr_b16 a[30:31], v8 offset:9216
    ds_read_b64_tr_b16 a[32:33], v9 offset:8192
    ds_read_b64_tr_b16 a[34:35], v9 offset:9216
    ds_read_b64_tr_b16 a[36:37], v10 offset:8192
    ds_read_b64_tr_b16 a[38:39], v10 offset:9216
    ds_read_b64_tr_b16 a[40:41], v11 offset:8192
    ds_read_b64_tr_b16 a[42:43], v11 offset:9216
    ds_read_b64_tr_b16 a[44:45], v12 offset:8192
    ds_read_b64_tr_b16 a[46:47], v12 offset:9216
    ds_read_b64_tr_b16 a[48:49], v13 offset:8192
    ds_read_b64_tr_b16 a[50:51], v13 offset:9216
    ds_read_b64_tr_b16 a[52:53], v14 offset:8192
    ds_read_b64_tr_b16 a[54:55], v14 offset:9216
    ds_read_b64_tr_b16 a[144:145], v18 offset:0
    ds_read_b64_tr_b16 a[146:147], v18 offset:1024
    ds_read_b64_tr_b16 a[148:149], v19 offset:0
    ds_read_b64_tr_b16 a[150:151], v19 offset:1024
    s_add_u32 m0, s71, 49152
    s_nop 0
    buffer_load_dwordx4 v3, s[12:15], s72 offen lds
    buffer_load_dwordx4 v3, s[12:15], s73 offen offset:1024 lds
    s_add_u32 m0, s71, 57344
    s_nop 0
    buffer_load_dwordx4 v3, s[16:19], s72 offen lds
    buffer_load_dwordx4 v3, s[16:19], s73 offen offset:1024 lds
    s_add_u32 s72, s72, 229376
    s_cmp_eq_u32 s72, 7340032
    s_cselect_b32 s72, 0, s72
    s_add_u32 s73, s72, 27648
    s_mov_b32 m0, s76
    s_nop 0
    buffer_load_dwordx4 v4, s[8:11], s77 offen lds
    buffer_load_dwordx4 v5, s[8:11], s77 offen offset:1024 lds
    buffer_load_dwordx4 v6, s[8:11], s77 offen offset:2048 lds
    buffer_load_dwordx4 v7, s[8:11], s77 offen offset:3072 lds
    s_waitcnt vmcnt(20) lgkmcnt(0)
    s_barrier
    v_mfma_f32_16x16x32_bf16 a[176:179], a[144:147], a[160:163], 0
    ds_read_b64_tr_b16 a[72:73], v8 offset:16384
    v_add_u32 v17, s75, v16
    v_mfma_f32_16x16x32_bf16 a[176:179], a[148:151], a[164:167], a[176:179]
    ds_read_b64_tr_b16 a[74:75], v8 offset:17408
    v_mfma_f32_16x16x32_bf16 v[32:35], a[0:3], a[56:59], 0
    ds_read_b64_tr_b16 a[76:77], v9 offset:16384
    s_add_u32 m0, s76, 4096
    v_mfma_f32_16x16x32_bf16 v[36:39], a[0:3], a[60:63], 0
    ds_read_b64_tr_b16 a[78:79], v9 offset:17408
    s_add_u32 s79, s77, 0x10000
    v_mfma_f32_16x16x32_bf16 v[40:43], a[0:3], a[64:67], 0
    ds_read_b128 a[128:131], v17 offset:0
    buffer_load_dwordx4 v4, s[8:11], s79 offen lds
    v_mfma_f32_16x16x32_bf16 v[44:47], a[0:3], a[68:71], 0
    ds_read_b128 a[132:135], v17 offset:2048
    s_add_u32 s36, s88, 0x0
    s_addc_u32 s37, s89, 0
    v_mfma_f32_16x16x32_bf16 v[60:63], a[4:7], a[68:71], 0
    ds_read_b128 a[136:139], v17 offset:4096
    s_mov_b32 s38, 0x500000
    v_mfma_f32_16x16x32_bf16 v[56:59], a[4:7], a[64:67], 0
    ds_read_b128 a[140:143], v17 offset:6144
    s_mov_b32 s39, 0x20000
    v_mfma_f32_16x16x32_bf16 v[52:55], a[4:7], a[60:63], 0
    ds_read_b64_tr_b16 a[80:81], v10 offset:16384
    s_add_u32 s20, s88, 0x1000000
    s_addc_u32 s21, s89, 0
    v_mfma_f32_16x16x32_bf16 v[48:51], a[4:7], a[56:59], 0
    ds_read_b64_tr_b16 a[82:83], v10 offset:17408
    s_mov_b32 s22, 0xe00000
    v_mfma_f32_16x16x32_bf16 v[64:67], a[8:11], a[56:59], 0
    ds_read_b64_tr_b16 a[84:85], v11 offset:16384
    buffer_load_dwordx4 v5, s[8:11], s79 offen offset:1024 lds
    v_mfma_f32_16x16x32_bf16 v[68:71], a[8:11], a[60:63], 0
    ds_read_b64_tr_b16 a[86:87], v11 offset:17408
    s_mov_b32 s23, 0x20000
    v_mfma_f32_16x16x32_bf16 v[72:75], a[8:11], a[64:67], 0
    ds_read_b64_tr_b16 a[88:89], v12 offset:16384
    s_add_u32 s24, s88, 0x600000
    s_addc_u32 s25, s89, 0
    v_mfma_f32_16x16x32_bf16 v[76:79], a[8:11], a[68:71], 0
    ds_read_b64_tr_b16 a[90:91], v12 offset:17408
    s_mov_b32 s26, 0x420000
    v_mfma_f32_16x16x32_bf16 v[92:95], a[12:15], a[68:71], 0
    ds_read_b64_tr_b16 a[92:93], v13 offset:16384
    s_mov_b32 s27, 0x20000
    v_mfma_f32_16x16x32_bf16 v[88:91], a[12:15], a[64:67], 0
    ds_read_b64_tr_b16 a[94:95], v13 offset:17408
    s_add_u32 s32, s88, 0xb00000
    s_addc_u32 s33, s89, 0
    v_mfma_f32_16x16x32_bf16 v[84:87], a[12:15], a[60:63], 0
    ds_read_b64_tr_b16 a[96:97], v14 offset:16384
    s_mov_b32 s34, 0x400000
    v_mfma_f32_16x16x32_bf16 v[80:83], a[12:15], a[56:59], 0
    ds_read_b64_tr_b16 a[98:99], v14 offset:17408
    buffer_load_dwordx4 v6, s[8:11], s79 offen offset:2048 lds
    v_mfma_f32_16x16x32_bf16 v[96:99], a[16:19], a[56:59], 0
    ds_read_b64_tr_b16 a[100:101], v8 offset:24576
    s_mov_b32 s35, 0x20000
    v_mfma_f32_16x16x32_bf16 v[100:103], a[16:19], a[60:63], 0
    ds_read_b64_tr_b16 a[102:103], v8 offset:25600
    s_mov_b32 s54, 0x400000
    v_mfma_f32_16x16x32_bf16 v[104:107], a[16:19], a[64:67], 0
    ds_read_b64_tr_b16 a[104:105], v9 offset:24576
    s_mov_b32 s55, 0x20000
    v_mfma_f32_16x16x32_bf16 v[108:111], a[16:19], a[68:71], 0
    ds_read_b64_tr_b16 a[106:107], v9 offset:25600
    s_mov_b32 s58, 0x400000
    v_mfma_f32_16x16x32_bf16 v[124:127], a[20:23], a[68:71], 0
    ds_read_b64_tr_b16 a[108:109], v10 offset:24576
    s_mov_b32 s59, 0x20000
    v_mfma_f32_16x16x32_bf16 v[120:123], a[20:23], a[64:67], 0
    ds_read_b64_tr_b16 a[110:111], v10 offset:25600
    buffer_load_dwordx4 v7, s[8:11], s79 offen offset:3072 lds
    v_mfma_f32_16x16x32_bf16 v[116:119], a[20:23], a[60:63], 0
    ds_read_b64_tr_b16 a[112:113], v11 offset:24576
    s_mov_b32 s30, 0x400000
    v_mfma_f32_16x16x32_bf16 v[112:115], a[20:23], a[56:59], 0
    ds_read_b64_tr_b16 a[114:115], v11 offset:25600
    s_add_u32 s77, s77, 128
    v_mfma_f32_16x16x32_bf16 a[180:183], a[24:27], a[56:59], 0
    ds_read_b64_tr_b16 a[116:117], v12 offset:24576
    s_and_b32 s77, s77, 0x7ff
    v_mfma_f32_16x16x32_bf16 a[184:187], a[24:27], a[60:63], 0
    ds_read_b64_tr_b16 a[118:119], v12 offset:25600
    s_add_u32 s76, s76, 8192
    v_mfma_f32_16x16x32_bf16 a[188:191], a[24:27], a[64:67], 0
    s_cmp_eq_u32 s76, s91
    s_cselect_b32 s76, s70, s76
    s_mov_b32 s31, 0x20000
    s_mov_b32 s42, 0x100
    v_mfma_f32_16x16x32_bf16 a[192:195], a[24:27], a[68:71], 0
    ds_read_b64_tr_b16 a[120:121], v13 offset:24576
    s_add_u32 m0, s71, 0
    v_mfma_f32_16x16x32_bf16 v[140:143], a[28:31], a[68:71], 0
    ds_read_b64_tr_b16 a[122:123], v13 offset:25600
    buffer_load_dwordx4 v3, s[12:15], s72 offen lds
    v_mfma_f32_16x16x32_bf16 v[136:139], a[28:31], a[64:67], 0
    ds_read_b64_tr_b16 a[124:125], v14 offset:24576
    s_mov_b32 s43, 0x20000
    v_mfma_f32_16x16x32_bf16 v[132:135], a[28:31], a[60:63], 0
    ds_read_b64_tr_b16 a[126:127], v14 offset:25600
    s_mov_b32 s46, 0x700000
    v_mfma_f32_16x16x32_bf16 v[128:131], a[28:31], a[56:59], 0
    ds_read_b64_tr_b16 a[144:145], v18 offset:16384
    s_mov_b32 s47, 0x20000
    v_mfma_f32_16x16x32_bf16 v[144:147], a[32:35], a[56:59], 0
    ds_read_b64_tr_b16 a[146:147], v18 offset:17408
    s_mov_b32 s50, 0x400000
    v_mfma_f32_16x16x32_bf16 v[148:151], a[32:35], a[60:63], 0
    ds_read_b64_tr_b16 a[148:149], v19 offset:16384
    s_mov_b32 s51, 0x20000
    v_mfma_f32_16x16x32_bf16 v[152:155], a[32:35], a[64:67], 0
    ds_read_b64_tr_b16 a[150:151], v19 offset:17408
    s_mov_b32 s62, 0x2000
    v_mfma_f32_16x16x32_bf16 v[156:159], a[32:35], a[68:71], 0
    buffer_load_dwordx4 v3, s[12:15], s73 offen offset:1024 lds
    s_mov_b32 s63, 0x20000
    s_bfe_u32 s67, s6, 0x10001
    v_mfma_f32_16x16x32_bf16 v[172:175], a[36:39], a[68:71], 0
    s_lshl_b32 s67, s67, 3
    v_mfma_f32_16x16x32_bf16 v[168:171], a[36:39], a[64:67], 0
    s_and_b32 s78, s7, 7
    v_mfma_f32_16x16x32_bf16 v[164:167], a[36:39], a[60:63], 0
    s_add_u32 s67, s67, s78
    v_mfma_f32_16x16x32_bf16 v[160:163], a[36:39], a[56:59], 0
    v_mfma_f32_16x16x32_bf16 v[176:179], a[40:43], a[56:59], 0
    s_add_u32 m0, s71, 8192
    s_lshr_b32 s68, s6, 2
    v_mfma_f32_16x16x32_bf16 v[180:183], a[40:43], a[60:63], 0
    buffer_load_dwordx4 v3, s[16:19], s72 offen lds
    s_lshl_b32 s68, s68, 2
    v_mfma_f32_16x16x32_bf16 v[184:187], a[40:43], a[64:67], 0
    s_lshr_b32 s78, s7, 3
    v_mfma_f32_16x16x32_bf16 v[188:191], a[40:43], a[68:71], 0
    v_mfma_f32_16x16x32_bf16 v[204:207], a[44:47], a[68:71], 0
    s_add_u32 s68, s68, s78
    v_mfma_f32_16x16x32_bf16 v[200:203], a[44:47], a[64:67], 0
    s_mul_i32 s78, s66, 12288
    v_mfma_f32_16x16x32_bf16 v[196:199], a[44:47], a[60:63], 0
    v_mfma_f32_16x16x32_bf16 v[192:195], a[44:47], a[56:59], 0
    s_add_u32 s78, s78, 32768
    v_mfma_f32_16x16x32_bf16 v[208:211], a[48:51], a[56:59], 0
    buffer_load_dwordx4 v3, s[16:19], s73 offen offset:1024 lds
    s_cmp_eq_u32 s64, 3
    s_cselect_b32 s78, 0x80000000, s78
    v_mfma_f32_16x16x32_bf16 v[212:215], a[48:51], a[60:63], 0
    s_add_u32 s72, s72, 229376
    v_add_u32 v28, s78, v28
    v_mfma_f32_16x16x32_bf16 v[216:219], a[48:51], a[64:67], 0
    s_cmp_eq_u32 s72, 7340032
    s_cselect_b32 s72, 0, s72
    v_mfma_f32_16x16x32_bf16 v[220:223], a[48:51], a[68:71], 0
    s_add_u32 s73, s72, 27648
    s_and_b32 s4, s2, 31
    v_mfma_f32_16x16x32_bf16 a[208:211], a[52:55], a[68:71], 0
    s_lshr_b32 s5, s2, 5
    v_mfma_f32_16x16x32_bf16 a[204:207], a[52:55], a[64:67], 0
    v_mfma_f32_16x16x32_bf16 a[200:203], a[52:55], a[60:63], 0
    v_mfma_f32_16x16x32_bf16 a[196:199], a[52:55], a[56:59], 0
    s_waitcnt vmcnt(16) lgkmcnt(0)
    s_barrier
    v_mfma_f32_16x16x32_bf16 a[176:179], a[144:147], a[160:163], a[176:179]
    ds_read_b64_tr_b16 a[0:1], v8 offset:32768
    s_add_u32 s75, s75, 8192
    v_mfma_f32_16x16x32_bf16 a[176:179], a[148:151], a[164:167], a[176:179]
    s_cmp_eq_u32 s75, 24576
    s_cselect_b32 s75, 0, s75
    v_mfma_f32_16x16x32_bf16 v[32:35], a[72:75], a[128:131], v[32:35]
    ds_read_b64_tr_b16 a[2:3], v8 offset:33792
    v_add_u32 v17, s75, v15
    v_mfma_f32_16x16x32_bf16 v[36:39], a[72:75], a[132:135], v[36:39]
    ds_read_b64_tr_b16 a[4:5], v9 offset:32768
    s_mov_b32 m0, s76
    v_mfma_f32_16x16x32_bf16 v[40:43], a[72:75], a[136:139], v[40:43]
    ds_read_b64_tr_b16 a[6:7], v9 offset:33792
    buffer_load_dwordx4 v4, s[8:11], s77 offen lds
    v_mfma_f32_16x16x32_bf16 v[44:47], a[72:75], a[140:143], v[44:47]
    ds_read_b128 a[56:59], v17 offset:0
    s_lshl_b32 s78, s4, 17
    v_mfma_f32_16x16x32_bf16 v[60:63], a[76:79], a[140:143], v[60:63]
    ds_read_b128 a[60:63], v17 offset:2048
    s_lshl_b32 s3, s5, 8
    v_mfma_f32_16x16x32_bf16 v[56:59], a[76:79], a[136:139], v[56:59]
    ds_read_b128 a[64:67], v17 offset:4096
    s_add_u32 s78, s78, s3
    v_mfma_f32_16x16x32_bf16 v[52:55], a[76:79], a[132:135], v[52:55]
    ds_read_b128 a[68:71], v17 offset:6144
    s_and_b32 s3, s64, 1
    v_mfma_f32_16x16x32_bf16 v[48:51], a[76:79], a[128:131], v[48:51]
    ds_read_b64_tr_b16 a[8:9], v10 offset:32768
    s_lshl_b32 s3, s3, 7
    v_mfma_f32_16x16x32_bf16 v[64:67], a[80:83], a[128:131], v[64:67]
    ds_read_b64_tr_b16 a[10:11], v10 offset:33792
    buffer_load_dwordx4 v5, s[8:11], s77 offen offset:1024 lds
    v_mfma_f32_16x16x32_bf16 v[68:71], a[80:83], a[132:135], v[68:71]
    ds_read_b64_tr_b16 a[12:13], v11 offset:32768
    s_add_u32 s78, s78, s3
    v_mfma_f32_16x16x32_bf16 v[72:75], a[80:83], a[136:139], v[72:75]
    ds_read_b64_tr_b16 a[14:15], v11 offset:33792
    s_lshr_b32 s3, s64, 1
    v_mfma_f32_16x16x32_bf16 v[76:79], a[80:83], a[140:143], v[76:79]
    ds_read_b64_tr_b16 a[16:17], v12 offset:32768
    s_lshl_b32 s3, s3, 16
    v_mfma_f32_16x16x32_bf16 v[92:95], a[84:87], a[140:143], v[92:95]
    ds_read_b64_tr_b16 a[18:19], v12 offset:33792
    s_add_u32 s78, s78, s3
    v_mfma_f32_16x16x32_bf16 v[88:91], a[84:87], a[136:139], v[88:91]
    ds_read_b64_tr_b16 a[20:21], v13 offset:32768
    v_and_b32 v224, 7, v0
    v_mfma_f32_16x16x32_bf16 v[84:87], a[84:87], a[132:135], v[84:87]
    ds_read_b64_tr_b16 a[22:23], v13 offset:33792
    v_lshrrev_b32 v248, 3, v0
    v_mfma_f32_16x16x32_bf16 v[80:83], a[84:87], a[128:131], v[80:83]
    ds_read_b64_tr_b16 a[24:25], v14 offset:32768
    buffer_load_dwordx4 v6, s[8:11], s77 offen offset:2048 lds
    v_mfma_f32_16x16x32_bf16 v[96:99], a[88:91], a[128:131], v[96:99]
    ds_read_b64_tr_b16 a[26:27], v14 offset:33792
    v_lshlrev_b32 v248, 13, v248
    v_mfma_f32_16x16x32_bf16 v[100:103], a[88:91], a[132:135], v[100:103]
    ds_read_b64_tr_b16 a[28:29], v8 offset:40960
    v_lshl_add_u32 v248, v224, 4, v248
    v_mfma_f32_16x16x32_bf16 v[104:107], a[88:91], a[136:139], v[104:107]
    ds_read_b64_tr_b16 a[30:31], v8 offset:41984
    v_add_u32 v248, s78, v248
    v_mfma_f32_16x16x32_bf16 v[108:111], a[88:91], a[140:143], v[108:111]
    ds_read_b64_tr_b16 a[32:33], v9 offset:40960
    v_add_u32 v249, 0xffffe000, v248
    v_mfma_f32_16x16x32_bf16 v[124:127], a[92:95], a[140:143], v[124:127]
    ds_read_b64_tr_b16 a[34:35], v9 offset:41984
    v_add_u32 v250, 0xfffff000, v248
    v_mfma_f32_16x16x32_bf16 v[120:123], a[92:95], a[136:139], v[120:123]
    ds_read_b64_tr_b16 a[36:37], v10 offset:40960
    buffer_load_dwordx4 v7, s[8:11], s77 offen offset:3072 lds
    v_mfma_f32_16x16x32_bf16 v[116:119], a[92:95], a[132:135], v[116:119]
    ds_read_b64_tr_b16 a[38:39], v10 offset:41984
    v_add_u32 v251, 0x1000, v248
    v_mfma_f32_16x16x32_bf16 v[112:115], a[92:95], a[128:131], v[112:115]
    ds_read_b64_tr_b16 a[40:41], v11 offset:40960
    s_lshl_b32 s78, s65, 5
    v_mfma_f32_16x16x32_bf16 a[180:183], a[96:99], a[128:131], a[180:183]
    ds_read_b64_tr_b16 a[42:43], v11 offset:41984
    s_add_u32 s78, s78, s66
    v_mfma_f32_16x16x32_bf16 a[184:187], a[96:99], a[132:135], a[184:187]
    ds_read_b64_tr_b16 a[44:45], v12 offset:40960
    s_lshl_b32 s78, s78, 2
    v_mfma_f32_16x16x32_bf16 a[188:191], a[96:99], a[136:139], a[188:191]
    ds_read_b64_tr_b16 a[46:47], v12 offset:41984
    s_add_u32 s80, s78, 16384
    v_mfma_f32_16x16x32_bf16 a[192:195], a[96:99], a[140:143], a[192:195]
    ds_read_b64_tr_b16 a[48:49], v13 offset:40960
    s_add_u32 m0, s71, 16384
    v_mfma_f32_16x16x32_bf16 v[140:143], a[100:103], a[140:143], v[140:143]
    ds_read_b64_tr_b16 a[50:51], v13 offset:41984
    buffer_load_dwordx4 v3, s[12:15], s72 offen lds
    v_mfma_f32_16x16x32_bf16 v[136:139], a[100:103], a[136:139], v[136:139]
    ds_read_b64_tr_b16 a[52:53], v14 offset:40960
    s_lshl_b32 s78, s2, 2
    v_mfma_f32_16x16x32_bf16 v[132:135], a[100:103], a[132:135], v[132:135]
    ds_read_b64_tr_b16 a[54:55], v14 offset:41984
    s_add_u32 s81, s78, 17408
    v_mfma_f32_16x16x32_bf16 v[128:131], a[100:103], a[128:131], v[128:131]
    ds_read_b64_tr_b16 a[144:145], v18 offset:32768
    v_mov_b32 v225, s80
    v_mfma_f32_16x16x32_bf16 v[144:147], a[104:107], a[128:131], v[144:147]
    ds_read_b64_tr_b16 a[146:147], v18 offset:33792
    v_cmp_eq_u32 vcc, 1, v29
    v_mfma_f32_16x16x32_bf16 v[148:151], a[104:107], a[132:135], v[148:151]
    ds_read_b64_tr_b16 a[148:149], v19 offset:32768
    v_mov_b32 v226, 0x80000000
    v_mfma_f32_16x16x32_bf16 v[152:155], a[104:107], a[136:139], v[152:155]
    ds_read_b64_tr_b16 a[150:151], v19 offset:33792
    v_mov_b32 v227, s81
    v_mfma_f32_16x16x32_bf16 v[156:159], a[104:107], a[140:143], v[156:159]
    buffer_load_dwordx4 v3, s[12:15], s73 offen offset:1024 lds
    v_cndmask_b32 v227, v227, v225, vcc
    v_mov_b32 v228, 0
    v_mfma_f32_16x16x32_bf16 v[172:175], a[108:111], a[140:143], v[172:175]
    v_cmp_gt_u32 vcc, 2, v29
    v_mfma_f32_16x16x32_bf16 v[168:171], a[108:111], a[136:139], v[168:171]
    v_mfma_f32_16x16x32_bf16 v[164:167], a[108:111], a[132:135], v[164:167]
    v_lshrrev_b32 v229, 5, v29
    v_mfma_f32_16x16x32_bf16 v[160:163], a[108:111], a[128:131], v[160:163]
    v_and_b32 v230, 31, v29
    v_mfma_f32_16x16x32_bf16 v[176:179], a[112:115], a[128:131], v[176:179]
    s_add_u32 m0, s71, 24576
    v_cndmask_b32 v227, v226, v227, vcc
    v_mfma_f32_16x16x32_bf16 v[180:183], a[112:115], a[132:135], v[180:183]
    buffer_load_dwordx4 v3, s[16:19], s72 offen lds
    v_mfma_f32_16x16x32_bf16 v[184:187], a[112:115], a[136:139], v[184:187]
    s_lshl_b32 s78, s2, 14
    v_mfma_f32_16x16x32_bf16 v[188:191], a[112:115], a[140:143], v[188:191]
    v_lshlrev_b32 v245, 11, v229
    v_mfma_f32_16x16x32_bf16 v[204:207], a[116:119], a[140:143], v[204:207]
    v_lshl_add_u32 v245, v230, 4, v245
    v_mfma_f32_16x16x32_bf16 v[200:203], a[116:119], a[136:139], v[200:203]
    v_mfma_f32_16x16x32_bf16 v[196:199], a[116:119], a[132:135], v[196:199]
    v_add_u32 v245, s78, v245
    v_mfma_f32_16x16x32_bf16 v[192:195], a[116:119], a[128:131], v[192:195]
    s_lshl_b32 s78, s2, 6
    v_mfma_f32_16x16x32_bf16 v[208:211], a[120:123], a[128:131], v[208:211]
    buffer_load_dwordx4 v3, s[16:19], s73 offen offset:1024 lds
    v_cmp_eq_u32 vcc, 0, v230
    v_mfma_f32_16x16x32_bf16 v[212:215], a[120:123], a[132:135], v[212:215]
    s_add_u32 s72, s72, 229376
    v_mfma_f32_16x16x32_bf16 v[216:219], a[120:123], a[136:139], v[216:219]
    s_cmp_eq_u32 s72, 7340032
    s_cselect_b32 s72, 0, s72
    v_lshlrev_b32 v244, 3, v229
    v_mfma_f32_16x16x32_bf16 v[220:223], a[120:123], a[140:143], v[220:223]
    s_add_u32 s73, s72, 27648
    v_add_u32 v244, s78, v244
    v_mfma_f32_16x16x32_bf16 a[208:211], a[124:127], a[140:143], a[208:211]
    v_cndmask_b32 v244, v226, v244, vcc
    v_mfma_f32_16x16x32_bf16 a[204:207], a[124:127], a[136:139], a[204:207]
    v_mfma_f32_16x16x32_bf16 a[200:203], a[124:127], a[132:135], a[200:203]
    v_mfma_f32_16x16x32_bf16 a[196:199], a[124:127], a[128:131], a[196:199]
    s_waitcnt vmcnt(20) lgkmcnt(0)
    s_barrier
    v_mfma_f32_16x16x32_bf16 a[176:179], a[144:147], a[160:163], a[176:179]
    ds_read_b64_tr_b16 a[72:73], v8 offset:49152
    v_add_u32 v17, s75, v16
    v_mfma_f32_16x16x32_bf16 a[176:179], a[148:151], a[164:167], a[176:179]
    ds_read_b64_tr_b16 a[74:75], v8 offset:50176
    v_mfma_f32_16x16x32_bf16 v[32:35], a[0:3], a[56:59], v[32:35]
    ds_read_b64_tr_b16 a[76:77], v9 offset:49152
    s_add_u32 m0, s76, 4096
    v_mfma_f32_16x16x32_bf16 v[36:39], a[0:3], a[60:63], v[36:39]
    ds_read_b64_tr_b16 a[78:79], v9 offset:50176
    s_add_u32 s79, s77, 0x10000
    v_mfma_f32_16x16x32_bf16 v[40:43], a[0:3], a[64:67], v[40:43]
    ds_read_b128 a[128:131], v17 offset:0
    buffer_load_dwordx4 v4, s[8:11], s79 offen lds
    v_mfma_f32_16x16x32_bf16 v[44:47], a[0:3], a[68:71], v[44:47]
    ds_read_b128 a[132:135], v17 offset:2048
    v_and_b32 v26, 7, v0
    v_mfma_f32_16x16x32_bf16 v[60:63], a[4:7], a[68:71], v[60:63]
    ds_read_b128 a[136:139], v17 offset:4096
    v_lshlrev_b32 v22, 3, v26
    v_mfma_f32_16x16x32_bf16 v[56:59], a[4:7], a[64:67], v[56:59]
    ds_read_b128 a[140:143], v17 offset:6144
    v_lshlrev_b32 v26, 6, v26
    v_mfma_f32_16x16x32_bf16 v[52:55], a[4:7], a[60:63], v[52:55]
    ds_read_b64_tr_b16 a[80:81], v10 offset:49152
    s_lshl_b32 s74, s5, 10
    v_mfma_f32_16x16x32_bf16 v[48:51], a[4:7], a[56:59], v[48:51]
    ds_read_b64_tr_b16 a[82:83], v10 offset:50176
    buffer_load_dwordx4 v5, s[8:11], s79 offen offset:1024 lds
    v_mfma_f32_16x16x32_bf16 v[64:67], a[8:11], a[56:59], v[64:67]
    ds_read_b64_tr_b16 a[84:85], v11 offset:49152
    s_and_b32 s3, s64, 1
    v_mfma_f32_16x16x32_bf16 v[68:71], a[8:11], a[60:63], v[68:71]
    ds_read_b64_tr_b16 a[86:87], v11 offset:50176
    s_lshl_b32 s3, s3, 9
    v_mfma_f32_16x16x32_bf16 v[72:75], a[8:11], a[64:67], v[72:75]
    ds_read_b64_tr_b16 a[88:89], v12 offset:49152
    s_add_u32 s74, s74, s3
    v_mfma_f32_16x16x32_bf16 v[76:79], a[8:11], a[68:71], v[76:79]
    ds_read_b64_tr_b16 a[90:91], v12 offset:50176
    s_lshr_b32 s3, s74, 3
    v_mfma_f32_16x16x32_bf16 v[92:95], a[12:15], a[68:71], v[92:95]
    ds_read_b64_tr_b16 a[92:93], v13 offset:49152
    v_mfma_f32_16x16x32_bf16 v[88:91], a[12:15], a[64:67], v[88:91]
    ds_read_b64_tr_b16 a[94:95], v13 offset:50176
    buffer_load_dwordx4 v6, s[8:11], s79 offen offset:2048 lds
    v_mfma_f32_16x16x32_bf16 v[84:87], a[12:15], a[60:63], v[84:87]
    ds_read_b64_tr_b16 a[96:97], v14 offset:49152
    v_add_u32 v22, s3, v22
    v_mfma_f32_16x16x32_bf16 v[80:83], a[12:15], a[56:59], v[80:83]
    ds_read_b64_tr_b16 a[98:99], v14 offset:50176
    v_mul_u32_u24 v22, 4224, v22
    v_mfma_f32_16x16x32_bf16 v[96:99], a[16:19], a[56:59], v[96:99]
    ds_read_b64_tr_b16 a[100:101], v8 offset:57344
    v_mfma_f32_16x16x32_bf16 v[100:103], a[16:19], a[60:63], v[100:103]
    ds_read_b64_tr_b16 a[102:103], v8 offset:58368
    v_and_b32 v23, 0x38, v0
    v_mfma_f32_16x16x32_bf16 v[104:107], a[16:19], a[64:67], v[104:107]
    ds_read_b64_tr_b16 a[104:105], v9 offset:57344
    v_mfma_f32_16x16x32_bf16 v[108:111], a[16:19], a[68:71], v[108:111]
    ds_read_b64_tr_b16 a[106:107], v9 offset:58368
    buffer_load_dwordx4 v7, s[8:11], s79 offen offset:3072 lds
    v_mfma_f32_16x16x32_bf16 v[124:127], a[20:23], a[68:71], v[124:127]
    ds_read_b64_tr_b16 a[108:109], v10 offset:57344
    s_add_u32 s77, s77, 128
    v_mfma_f32_16x16x32_bf16 v[120:123], a[20:23], a[64:67], v[120:123]
    ds_read_b64_tr_b16 a[110:111], v10 offset:58368
    s_and_b32 s77, s77, 0x7ff
    v_mfma_f32_16x16x32_bf16 v[116:119], a[20:23], a[60:63], v[116:119]
    ds_read_b64_tr_b16 a[112:113], v11 offset:57344
    s_add_u32 s76, s76, 8192
    v_mfma_f32_16x16x32_bf16 v[112:115], a[20:23], a[56:59], v[112:115]
    s_cmp_eq_u32 s76, s91
    s_cselect_b32 s76, s70, s76
    v_sub_u32 v22, v22, v23
    v_mfma_f32_16x16x32_bf16 a[180:183], a[24:27], a[56:59], a[180:183]
    ds_read_b64_tr_b16 a[114:115], v11 offset:58368
    s_add_u32 m0, s71, 32768
    v_mfma_f32_16x16x32_bf16 a[184:187], a[24:27], a[60:63], a[184:187]
    ds_read_b64_tr_b16 a[116:117], v12 offset:57344
    buffer_load_dwordx4 v3, s[12:15], s72 offen lds
    v_mfma_f32_16x16x32_bf16 a[188:191], a[24:27], a[64:67], a[188:191]
    ds_read_b64_tr_b16 a[118:119], v12 offset:58368
    s_lshl_b32 s6, s4, 7
    v_mfma_f32_16x16x32_bf16 a[192:195], a[24:27], a[68:71], a[192:195]
    ds_read_b64_tr_b16 a[120:121], v13 offset:57344
    s_sub_u32 s6, 4088, s6
    v_mfma_f32_16x16x32_bf16 v[140:143], a[28:31], a[68:71], v[140:143]
    ds_read_b64_tr_b16 a[122:123], v13 offset:58368
    s_lshr_b32 s3, s64, 1
    v_mfma_f32_16x16x32_bf16 v[136:139], a[28:31], a[64:67], v[136:139]
    ds_read_b64_tr_b16 a[124:125], v14 offset:57344
    s_lshl_b32 s3, s3, 6
    v_mfma_f32_16x16x32_bf16 v[132:135], a[28:31], a[60:63], v[132:135]
    ds_read_b64_tr_b16 a[126:127], v14 offset:58368
    s_sub_u32 s6, s6, s3
    v_mfma_f32_16x16x32_bf16 v[128:131], a[28:31], a[56:59], v[128:131]
    ds_read_b64_tr_b16 a[144:145], v18 offset:49152
    buffer_load_dwordx4 v3, s[12:15], s73 offen offset:1024 lds
    v_mfma_f32_16x16x32_bf16 v[144:147], a[32:35], a[56:59], v[144:147]
    ds_read_b64_tr_b16 a[146:147], v18 offset:50176
    v_add_u32 v22, s6, v22
    v_mfma_f32_16x16x32_bf16 v[148:151], a[32:35], a[60:63], v[148:151]
    ds_read_b64_tr_b16 a[148:149], v19 offset:49152
    s_lshl_b32 s3, s5, 7
    v_mfma_f32_16x16x32_bf16 v[152:155], a[32:35], a[64:67], v[152:155]
    ds_read_b64_tr_b16 a[150:151], v19 offset:50176
    v_add_u32 v23, s3, v29
    v_mfma_f32_16x16x32_bf16 v[156:159], a[32:35], a[68:71], v[156:159]
    v_mfma_f32_16x16x32_bf16 v[172:175], a[36:39], a[68:71], v[172:175]
    s_add_u32 m0, s71, 40960
    v_mul_u32_u24 v23, 4224, v23
    v_mfma_f32_16x16x32_bf16 v[168:171], a[36:39], a[64:67], v[168:171]
    buffer_load_dwordx4 v3, s[16:19], s72 offen lds
    v_mfma_f32_16x16x32_bf16 v[164:167], a[36:39], a[60:63], v[164:167]
    v_add_u32 v23, 0x1000, v23
    v_mfma_f32_16x16x32_bf16 v[160:163], a[36:39], a[56:59], v[160:163]
    v_mfma_f32_16x16x32_bf16 v[176:179], a[40:43], a[56:59], v[176:179]
    s_lshl_b32 s6, s4, 8
    v_mfma_f32_16x16x32_bf16 v[180:183], a[40:43], a[60:63], v[180:183]
    v_mfma_f32_16x16x32_bf16 v[184:187], a[40:43], a[64:67], v[184:187]
    v_add_u32 v24, s6, v29
    v_mfma_f32_16x16x32_bf16 v[188:191], a[40:43], a[68:71], v[188:191]
    buffer_load_dwordx4 v3, s[16:19], s73 offen offset:1024 lds
    v_mfma_f32_16x16x32_bf16 v[204:207], a[44:47], a[68:71], v[204:207]
    s_movk_i32 s6, 128
    v_mfma_f32_16x16x32_bf16 v[200:203], a[44:47], a[64:67], v[200:203]
    v_mfma_f32_16x16x32_bf16 v[196:199], a[44:47], a[60:63], v[196:199]
    s_add_u32 s72, s72, 229376
    v_cmp_gt_u32 vcc, s6, v24
    v_mfma_f32_16x16x32_bf16 v[192:195], a[44:47], a[56:59], v[192:195]
    s_cmp_eq_u32 s72, 7340032
    s_cselect_b32 s72, 0, s72
    v_mfma_f32_16x16x32_bf16 v[208:211], a[48:51], a[56:59], v[208:211]
    s_add_u32 s73, s72, 27648
    v_mov_b32 v25, 0x80000000
    v_mfma_f32_16x16x32_bf16 v[212:215], a[48:51], a[60:63], v[212:215]
    buffer_store_dword v228, v227, s[36:39], 0 offen sc1
    v_mfma_f32_16x16x32_bf16 v[216:219], a[48:51], a[64:67], v[216:219]
    s_nop 0
    v_mfma_f32_16x16x32_bf16 v[220:223], a[48:51], a[68:71], v[220:223]
    v_mfma_f32_16x16x32_bf16 a[208:211], a[52:55], a[68:71], a[208:211]
    v_cndmask_b32 v23, v25, v23, vcc
    v_mfma_f32_16x16x32_bf16 a[204:207], a[52:55], a[64:67], a[204:207]
    v_mfma_f32_16x16x32_bf16 a[200:203], a[52:55], a[60:63], a[200:203]
    v_mfma_f32_16x16x32_bf16 a[196:199], a[52:55], a[56:59], a[196:199]
    s_waitcnt vmcnt(17) lgkmcnt(0)
    s_barrier
    v_mfma_f32_16x16x32_bf16 a[176:179], a[144:147], a[160:163], a[176:179]
    ds_read_b64_tr_b16 a[0:1], v8 offset:0
    s_add_u32 s75, s75, 8192
    v_mfma_f32_16x16x32_bf16 a[176:179], a[148:151], a[164:167], a[176:179]
    s_cmp_eq_u32 s75, 24576
    s_cselect_b32 s75, 0, s75
    v_mfma_f32_16x16x32_bf16 v[32:35], a[72:75], a[128:131], v[32:35]
    ds_read_b64_tr_b16 a[2:3], v8 offset:1024
    v_add_u32 v17, s75, v15
    v_mfma_f32_16x16x32_bf16 v[36:39], a[72:75], a[132:135], v[36:39]
    ds_read_b64_tr_b16 a[4:5], v9 offset:0
    s_mov_b32 m0, s76
    v_mfma_f32_16x16x32_bf16 v[40:43], a[72:75], a[136:139], v[40:43]
    ds_read_b64_tr_b16 a[6:7], v9 offset:1024
    buffer_load_dwordx4 v4, s[8:11], s77 offen lds
    v_mfma_f32_16x16x32_bf16 v[44:47], a[72:75], a[140:143], v[44:47]
    ds_read_b128 a[56:59], v17 offset:0
    v_mfma_f32_16x16x32_bf16 v[60:63], a[76:79], a[140:143], v[60:63]
    ds_read_b128 a[60:63], v17 offset:2048
    v_mfma_f32_16x16x32_bf16 v[56:59], a[76:79], a[136:139], v[56:59]
    ds_read_b128 a[64:67], v17 offset:4096
    v_mfma_f32_16x16x32_bf16 v[52:55], a[76:79], a[132:135], v[52:55]
    ds_read_b128 a[68:71], v17 offset:6144
    v_mfma_f32_16x16x32_bf16 v[48:51], a[76:79], a[128:131], v[48:51]
    ds_read_b64_tr_b16 a[8:9], v10 offset:0
    v_mfma_f32_16x16x32_bf16 v[64:67], a[80:83], a[128:131], v[64:67]
    ds_read_b64_tr_b16 a[10:11], v10 offset:1024
    buffer_load_dwordx4 v5, s[8:11], s77 offen offset:1024 lds
    v_mfma_f32_16x16x32_bf16 v[68:71], a[80:83], a[132:135], v[68:71]
    ds_read_b64_tr_b16 a[12:13], v11 offset:0
    v_mfma_f32_16x16x32_bf16 v[72:75], a[80:83], a[136:139], v[72:75]
    ds_read_b64_tr_b16 a[14:15], v11 offset:1024
    v_mfma_f32_16x16x32_bf16 v[76:79], a[80:83], a[140:143], v[76:79]
    ds_read_b64_tr_b16 a[16:17], v12 offset:0
    v_mfma_f32_16x16x32_bf16 v[92:95], a[84:87], a[140:143], v[92:95]
    ds_read_b64_tr_b16 a[18:19], v12 offset:1024
    v_mfma_f32_16x16x32_bf16 v[88:91], a[84:87], a[136:139], v[88:91]
    ds_read_b64_tr_b16 a[20:21], v13 offset:0
    v_mfma_f32_16x16x32_bf16 v[84:87], a[84:87], a[132:135], v[84:87]
    ds_read_b64_tr_b16 a[22:23], v13 offset:1024
    v_mfma_f32_16x16x32_bf16 v[80:83], a[84:87], a[128:131], v[80:83]
    ds_read_b64_tr_b16 a[24:25], v14 offset:0
    buffer_load_dwordx4 v6, s[8:11], s77 offen offset:2048 lds
    v_mfma_f32_16x16x32_bf16 v[96:99], a[88:91], a[128:131], v[96:99]
    ds_read_b64_tr_b16 a[26:27], v14 offset:1024
    v_mfma_f32_16x16x32_bf16 v[100:103], a[88:91], a[132:135], v[100:103]
    ds_read_b64_tr_b16 a[28:29], v8 offset:8192
    v_mfma_f32_16x16x32_bf16 v[104:107], a[88:91], a[136:139], v[104:107]
    ds_read_b64_tr_b16 a[30:31], v8 offset:9216
    v_mfma_f32_16x16x32_bf16 v[108:111], a[88:91], a[140:143], v[108:111]
    ds_read_b64_tr_b16 a[32:33], v9 offset:8192
    v_mfma_f32_16x16x32_bf16 v[124:127], a[92:95], a[140:143], v[124:127]
    ds_read_b64_tr_b16 a[34:35], v9 offset:9216
    v_mfma_f32_16x16x32_bf16 v[120:123], a[92:95], a[136:139], v[120:123]
    ds_read_b64_tr_b16 a[36:37], v10 offset:8192
    buffer_load_dwordx4 v7, s[8:11], s77 offen offset:3072 lds
    v_mfma_f32_16x16x32_bf16 v[116:119], a[92:95], a[132:135], v[116:119]
    ds_read_b64_tr_b16 a[38:39], v10 offset:9216
    v_mfma_f32_16x16x32_bf16 v[112:115], a[92:95], a[128:131], v[112:115]
    ds_read_b64_tr_b16 a[40:41], v11 offset:8192
    v_mfma_f32_16x16x32_bf16 a[180:183], a[96:99], a[128:131], a[180:183]
    ds_read_b64_tr_b16 a[42:43], v11 offset:9216
    v_mfma_f32_16x16x32_bf16 a[184:187], a[96:99], a[132:135], a[184:187]
    ds_read_b64_tr_b16 a[44:45], v12 offset:8192
    v_mfma_f32_16x16x32_bf16 a[188:191], a[96:99], a[136:139], a[188:191]
    ds_read_b64_tr_b16 a[46:47], v12 offset:9216
    v_mfma_f32_16x16x32_bf16 a[192:195], a[96:99], a[140:143], a[192:195]
    ds_read_b64_tr_b16 a[48:49], v13 offset:8192
    s_add_u32 m0, s71, 49152
    v_mfma_f32_16x16x32_bf16 v[140:143], a[100:103], a[140:143], v[140:143]
    ds_read_b64_tr_b16 a[50:51], v13 offset:9216
    buffer_load_dwordx4 v3, s[12:15], s72 offen lds
    v_mfma_f32_16x16x32_bf16 v[136:139], a[100:103], a[136:139], v[136:139]
    ds_read_b64_tr_b16 a[52:53], v14 offset:8192
    v_mfma_f32_16x16x32_bf16 v[132:135], a[100:103], a[132:135], v[132:135]
    ds_read_b64_tr_b16 a[54:55], v14 offset:9216
    v_mfma_f32_16x16x32_bf16 v[128:131], a[100:103], a[128:131], v[128:131]
    ds_read_b64_tr_b16 a[144:145], v18 offset:0
    v_mfma_f32_16x16x32_bf16 v[144:147], a[104:107], a[128:131], v[144:147]
    ds_read_b64_tr_b16 a[146:147], v18 offset:1024
    v_mfma_f32_16x16x32_bf16 v[148:151], a[104:107], a[132:135], v[148:151]
    ds_read_b64_tr_b16 a[148:149], v19 offset:0
    v_mfma_f32_16x16x32_bf16 v[152:155], a[104:107], a[136:139], v[152:155]
    ds_read_b64_tr_b16 a[150:151], v19 offset:1024
    v_mfma_f32_16x16x32_bf16 v[156:159], a[104:107], a[140:143], v[156:159]
    buffer_load_dwordx4 v3, s[12:15], s73 offen offset:1024 lds
    v_mfma_f32_16x16x32_bf16 v[172:175], a[108:111], a[140:143], v[172:175]
    v_mfma_f32_16x16x32_bf16 v[168:171], a[108:111], a[136:139], v[168:171]
    v_mfma_f32_16x16x32_bf16 v[164:167], a[108:111], a[132:135], v[164:167]
    v_mfma_f32_16x16x32_bf16 v[160:163], a[108:111], a[128:131], v[160:163]
    v_mfma_f32_16x16x32_bf16 v[176:179], a[112:115], a[128:131], v[176:179]
    s_add_u32 m0, s71, 57344
    v_mfma_f32_16x16x32_bf16 v[180:183], a[112:115], a[132:135], v[180:183]
    buffer_load_dwordx4 v3, s[16:19], s72 offen lds
    v_mfma_f32_16x16x32_bf16 v[184:187], a[112:115], a[136:139], v[184:187]
    v_mfma_f32_16x16x32_bf16 v[188:191], a[112:115], a[140:143], v[188:191]
    v_mfma_f32_16x16x32_bf16 v[204:207], a[116:119], a[140:143], v[204:207]
    v_mfma_f32_16x16x32_bf16 v[200:203], a[116:119], a[136:139], v[200:203]
    v_mfma_f32_16x16x32_bf16 v[196:199], a[116:119], a[132:135], v[196:199]
    v_mfma_f32_16x16x32_bf16 v[192:195], a[116:119], a[128:131], v[192:195]
    v_mfma_f32_16x16x32_bf16 v[208:211], a[120:123], a[128:131], v[208:211]
    buffer_load_dwordx4 v3, s[16:19], s73 offen offset:1024 lds
    v_mfma_f32_16x16x32_bf16 v[212:215], a[120:123], a[132:135], v[212:215]
    s_add_u32 s72, s72, 229376
    v_mfma_f32_16x16x32_bf16 v[216:219], a[120:123], a[136:139], v[216:219]
    s_cmp_eq_u32 s72, 7340032
    s_cselect_b32 s72, 0, s72
    v_mfma_f32_16x16x32_bf16 v[220:223], a[120:123], a[140:143], v[220:223]
    s_add_u32 s73, s72, 27648
    v_mfma_f32_16x16x32_bf16 a[208:211], a[124:127], a[140:143], a[208:211]
    v_mfma_f32_16x16x32_bf16 a[204:207], a[124:127], a[136:139], a[204:207]
    v_mfma_f32_16x16x32_bf16 a[200:203], a[124:127], a[132:135], a[200:203]
    v_mfma_f32_16x16x32_bf16 a[196:199], a[124:127], a[128:131], a[196:199]
    s_waitcnt vmcnt(17) lgkmcnt(0)
    s_barrier
    v_mfma_f32_16x16x32_bf16 a[176:179], a[144:147], a[160:163], a[176:179]
    ds_read_b64_tr_b16 a[72:73], v8 offset:16384
    v_add_u32 v17, s75, v16
    v_mfma_f32_16x16x32_bf16 a[176:179], a[148:151], a[164:167], a[176:179]
    ds_read_b64_tr_b16 a[74:75], v8 offset:17408
    v_mfma_f32_16x16x32_bf16 v[32:35], a[0:3], a[56:59], v[32:35]
    ds_read_b64_tr_b16 a[76:77], v9 offset:16384
    s_add_u32 m0, s76, 4096
    v_mfma_f32_16x16x32_bf16 v[36:39], a[0:3], a[60:63], v[36:39]
    ds_read_b64_tr_b16 a[78:79], v9 offset:17408
    s_add_u32 s79, s77, 0x10000
    v_mfma_f32_16x16x32_bf16 v[40:43], a[0:3], a[64:67], v[40:43]
    ds_read_b128 a[128:131], v17 offset:0
    buffer_load_dwordx4 v4, s[8:11], s79 offen lds
    v_mfma_f32_16x16x32_bf16 v[44:47], a[0:3], a[68:71], v[44:47]
    ds_read_b128 a[132:135], v17 offset:2048
    v_mfma_f32_16x16x32_bf16 v[60:63], a[4:7], a[68:71], v[60:63]
    ds_read_b128 a[136:139], v17 offset:4096
    v_mfma_f32_16x16x32_bf16 v[56:59], a[4:7], a[64:67], v[56:59]
    ds_read_b128 a[140:143], v17 offset:6144
    v_mfma_f32_16x16x32_bf16 v[52:55], a[4:7], a[60:63], v[52:55]
    ds_read_b64_tr_b16 a[80:81], v10 offset:16384
    buffer_load_dwordx4 v5, s[8:11], s79 offen offset:1024 lds
    v_mfma_f32_16x16x32_bf16 v[48:51], a[4:7], a[56:59], v[48:51]
    ds_read_b64_tr_b16 a[82:83], v10 offset:17408
    v_mfma_f32_16x16x32_bf16 v[64:67], a[8:11], a[56:59], v[64:67]
    ds_read_b64_tr_b16 a[84:85], v11 offset:16384
    v_mfma_f32_16x16x32_bf16 v[68:71], a[8:11], a[60:63], v[68:71]
    ds_read_b64_tr_b16 a[86:87], v11 offset:17408
    v_mfma_f32_16x16x32_bf16 v[72:75], a[8:11], a[64:67], v[72:75]
    ds_read_b64_tr_b16 a[88:89], v12 offset:16384
    buffer_load_dwordx4 v6, s[8:11], s79 offen offset:2048 lds
    v_mfma_f32_16x16x32_bf16 v[76:79], a[8:11], a[68:71], v[76:79]
    ds_read_b64_tr_b16 a[90:91], v12 offset:17408
    v_mfma_f32_16x16x32_bf16 v[92:95], a[12:15], a[68:71], v[92:95]
    ds_read_b64_tr_b16 a[92:93], v13 offset:16384
    v_mfma_f32_16x16x32_bf16 v[88:91], a[12:15], a[64:67], v[88:91]
    ds_read_b64_tr_b16 a[94:95], v13 offset:17408
    v_mfma_f32_16x16x32_bf16 v[84:87], a[12:15], a[60:63], v[84:87]
    ds_read_b64_tr_b16 a[96:97], v14 offset:16384
    v_mfma_f32_16x16x32_bf16 v[80:83], a[12:15], a[56:59], v[80:83]
    ds_read_b64_tr_b16 a[98:99], v14 offset:17408
    buffer_load_dwordx4 v7, s[8:11], s79 offen offset:3072 lds
    v_mfma_f32_16x16x32_bf16 v[96:99], a[16:19], a[56:59], v[96:99]
    ds_read_b64_tr_b16 a[100:101], v8 offset:24576
    s_add_u32 s77, s77, 128
    v_mfma_f32_16x16x32_bf16 v[100:103], a[16:19], a[60:63], v[100:103]
    ds_read_b64_tr_b16 a[102:103], v8 offset:25600
    s_and_b32 s77, s77, 0x7ff
    v_mfma_f32_16x16x32_bf16 v[104:107], a[16:19], a[64:67], v[104:107]
    ds_read_b64_tr_b16 a[104:105], v9 offset:24576
    s_add_u32 s76, s76, 8192
    v_mfma_f32_16x16x32_bf16 v[108:111], a[16:19], a[68:71], v[108:111]
    s_cmp_eq_u32 s76, s91
    s_cselect_b32 s76, s70, s76
    v_mfma_f32_16x16x32_bf16 v[124:127], a[20:23], a[68:71], v[124:127]
    ds_read_b64_tr_b16 a[106:107], v9 offset:25600
    s_add_u32 m0, s71, 0
    v_mfma_f32_16x16x32_bf16 v[120:123], a[20:23], a[64:67], v[120:123]
    ds_read_b64_tr_b16 a[108:109], v10 offset:24576
    buffer_load_dwordx4 v3, s[12:15], s72 offen lds
    v_mfma_f32_16x16x32_bf16 v[116:119], a[20:23], a[60:63], v[116:119]
    ds_read_b64_tr_b16 a[110:111], v10 offset:25600
    v_mfma_f32_16x16x32_bf16 v[112:115], a[20:23], a[56:59], v[112:115]
    ds_read_b64_tr_b16 a[112:113], v11 offset:24576
    v_mfma_f32_16x16x32_bf16 a[180:183], a[24:27], a[56:59], a[180:183]
    ds_read_b64_tr_b16 a[114:115], v11 offset:25600
    v_mfma_f32_16x16x32_bf16 a[184:187], a[24:27], a[60:63], a[184:187]
    ds_read_b64_tr_b16 a[116:117], v12 offset:24576
    buffer_load_dwordx4 v3, s[12:15], s73 offen offset:1024 lds
    v_mfma_f32_16x16x32_bf16 a[188:191], a[24:27], a[64:67], a[188:191]
    ds_read_b64_tr_b16 a[118:119], v12 offset:25600
    v_mfma_f32_16x16x32_bf16 a[192:195], a[24:27], a[68:71], a[192:195]
    ds_read_b64_tr_b16 a[120:121], v13 offset:24576
    s_add_u32 m0, s71, 8192
    v_mfma_f32_16x16x32_bf16 v[140:143], a[28:31], a[68:71], v[140:143]
    ds_read_b64_tr_b16 a[122:123], v13 offset:25600
    v_mfma_f32_16x16x32_bf16 v[136:139], a[28:31], a[64:67], v[136:139]
    ds_read_b64_tr_b16 a[124:125], v14 offset:24576
    buffer_load_dwordx4 v3, s[16:19], s72 offen lds
    v_mfma_f32_16x16x32_bf16 v[132:135], a[28:31], a[60:63], v[132:135]
    ds_read_b64_tr_b16 a[126:127], v14 offset:25600
    v_mfma_f32_16x16x32_bf16 v[128:131], a[28:31], a[56:59], v[128:131]
    ds_read_b64_tr_b16 a[144:145], v18 offset:16384
    v_mfma_f32_16x16x32_bf16 v[144:147], a[32:35], a[56:59], v[144:147]
    ds_read_b64_tr_b16 a[146:147], v18 offset:17408
    v_mfma_f32_16x16x32_bf16 v[148:151], a[32:35], a[60:63], v[148:151]
    ds_read_b64_tr_b16 a[148:149], v19 offset:16384
    buffer_load_dwordx4 v3, s[16:19], s73 offen offset:1024 lds
    v_mfma_f32_16x16x32_bf16 v[152:155], a[32:35], a[64:67], v[152:155]
    ds_read_b64_tr_b16 a[150:151], v19 offset:17408
    s_add_u32 s72, s72, 229376
    v_mfma_f32_16x16x32_bf16 v[156:159], a[32:35], a[68:71], v[156:159]
    s_cmp_eq_u32 s72, 7340032
    s_cselect_b32 s72, 0, s72
    v_mfma_f32_16x16x32_bf16 v[172:175], a[36:39], a[68:71], v[172:175]
    s_add_u32 s73, s72, 27648
    v_mfma_f32_16x16x32_bf16 v[168:171], a[36:39], a[64:67], v[168:171]
    buffer_load_dwordx4 a[152:155], v26, s[60:63], s74 offen offset:0
    v_mfma_f32_16x16x32_bf16 v[164:167], a[36:39], a[60:63], v[164:167]
    v_mfma_f32_16x16x32_bf16 v[160:163], a[36:39], a[56:59], v[160:163]
    v_mfma_f32_16x16x32_bf16 v[176:179], a[40:43], a[56:59], v[176:179]
    v_mfma_f32_16x16x32_bf16 v[180:183], a[40:43], a[60:63], v[180:183]
    buffer_load_dwordx4 a[156:159], v26, s[60:63], s74 offen offset:16
    v_mfma_f32_16x16x32_bf16 v[184:187], a[40:43], a[64:67], v[184:187]
    v_mfma_f32_16x16x32_bf16 v[188:191], a[40:43], a[68:71], v[188:191]
    v_mfma_f32_16x16x32_bf16 v[204:207], a[44:47], a[68:71], v[204:207]
    v_mfma_f32_16x16x32_bf16 v[200:203], a[44:47], a[64:67], v[200:203]
    v_mfma_f32_16x16x32_bf16 v[196:199], a[44:47], a[60:63], v[196:199]
    buffer_load_dwordx4 a[168:171], v26, s[60:63], s74 offen offset:32
    v_mfma_f32_16x16x32_bf16 v[192:195], a[44:47], a[56:59], v[192:195]
    v_mfma_f32_16x16x32_bf16 v[208:211], a[48:51], a[56:59], v[208:211]
    v_mfma_f32_16x16x32_bf16 v[212:215], a[48:51], a[60:63], v[212:215]
    v_mfma_f32_16x16x32_bf16 v[216:219], a[48:51], a[64:67], v[216:219]
    buffer_load_dwordx4 a[172:175], v26, s[60:63], s74 offen offset:48
    v_mfma_f32_16x16x32_bf16 v[220:223], a[48:51], a[68:71], v[220:223]
    v_mfma_f32_16x16x32_bf16 a[208:211], a[52:55], a[68:71], a[208:211]
    v_mfma_f32_16x16x32_bf16 a[204:207], a[52:55], a[64:67], a[204:207]
    v_mfma_f32_16x16x32_bf16 a[200:203], a[52:55], a[60:63], a[200:203]
    v_mfma_f32_16x16x32_bf16 a[196:199], a[52:55], a[56:59], a[196:199]
    s_waitcnt vmcnt(21) lgkmcnt(0)
    s_barrier
    v_mfma_f32_16x16x32_bf16 a[176:179], a[144:147], a[160:163], a[176:179]
    ds_read_b64_tr_b16 a[0:1], v8 offset:32768
    s_add_u32 s75, s75, 8192
    v_mfma_f32_16x16x32_bf16 a[176:179], a[148:151], a[164:167], a[176:179]
    s_cmp_eq_u32 s75, 24576
    s_cselect_b32 s75, 0, s75
    v_mfma_f32_16x16x32_bf16 v[32:35], a[72:75], a[128:131], v[32:35]
    ds_read_b64_tr_b16 a[2:3], v8 offset:33792
    v_add_u32 v17, s75, v15
    v_mfma_f32_16x16x32_bf16 v[36:39], a[72:75], a[132:135], v[36:39]
    ds_read_b64_tr_b16 a[4:5], v9 offset:32768
    s_mov_b32 m0, s76
    v_mfma_f32_16x16x32_bf16 v[40:43], a[72:75], a[136:139], v[40:43]
    ds_read_b64_tr_b16 a[6:7], v9 offset:33792
    buffer_load_dwordx4 v4, s[8:11], s77 offen lds
    v_mfma_f32_16x16x32_bf16 v[44:47], a[72:75], a[140:143], v[44:47]
    ds_read_b128 a[56:59], v17 offset:0
    v_mfma_f32_16x16x32_bf16 v[60:63], a[76:79], a[140:143], v[60:63]
    ds_read_b128 a[60:63], v17 offset:2048
    v_mfma_f32_16x16x32_bf16 v[56:59], a[76:79], a[136:139], v[56:59]
    ds_read_b128 a[64:67], v17 offset:4096
    v_mfma_f32_16x16x32_bf16 v[52:55], a[76:79], a[132:135], v[52:55]
    ds_read_b128 a[68:71], v17 offset:6144
    buffer_load_dwordx4 v5, s[8:11], s77 offen offset:1024 lds
    v_mfma_f32_16x16x32_bf16 v[48:51], a[76:79], a[128:131], v[48:51]
    ds_read_b64_tr_b16 a[8:9], v10 offset:32768
    v_mfma_f32_16x16x32_bf16 v[64:67], a[80:83], a[128:131], v[64:67]
    ds_read_b64_tr_b16 a[10:11], v10 offset:33792
    v_mfma_f32_16x16x32_bf16 v[68:71], a[80:83], a[132:135], v[68:71]
    ds_read_b64_tr_b16 a[12:13], v11 offset:32768
    v_mfma_f32_16x16x32_bf16 v[72:75], a[80:83], a[136:139], v[72:75]
    ds_read_b64_tr_b16 a[14:15], v11 offset:33792
    buffer_load_dwordx4 v6, s[8:11], s77 offen offset:2048 lds
    v_mfma_f32_16x16x32_bf16 v[76:79], a[80:83], a[140:143], v[76:79]
    ds_read_b64_tr_b16 a[16:17], v12 offset:32768
    v_mfma_f32_16x16x32_bf16 v[92:95], a[84:87], a[140:143], v[92:95]
    ds_read_b64_tr_b16 a[18:19], v12 offset:33792
    v_mfma_f32_16x16x32_bf16 v[88:91], a[84:87], a[136:139], v[88:91]
    ds_read_b64_tr_b16 a[20:21], v13 offset:32768
    v_mfma_f32_16x16x32_bf16 v[84:87], a[84:87], a[132:135], v[84:87]
    ds_read_b64_tr_b16 a[22:23], v13 offset:33792
    v_mfma_f32_16x16x32_bf16 v[80:83], a[84:87], a[128:131], v[80:83]
    ds_read_b64_tr_b16 a[24:25], v14 offset:32768
    buffer_load_dwordx4 v7, s[8:11], s77 offen offset:3072 lds
    v_mfma_f32_16x16x32_bf16 v[96:99], a[88:91], a[128:131], v[96:99]
    ds_read_b64_tr_b16 a[26:27], v14 offset:33792
    v_mfma_f32_16x16x32_bf16 v[100:103], a[88:91], a[132:135], v[100:103]
    ds_read_b64_tr_b16 a[28:29], v8 offset:40960
    v_mfma_f32_16x16x32_bf16 v[104:107], a[88:91], a[136:139], v[104:107]
    ds_read_b64_tr_b16 a[30:31], v8 offset:41984
    s_add_u32 m0, s71, 16384
    v_mfma_f32_16x16x32_bf16 v[108:111], a[88:91], a[140:143], v[108:111]
    ds_read_b64_tr_b16 a[32:33], v9 offset:40960
    buffer_load_dwordx4 v3, s[12:15], s72 offen lds
    v_mfma_f32_16x16x32_bf16 v[124:127], a[92:95], a[140:143], v[124:127]
    ds_read_b64_tr_b16 a[34:35], v9 offset:41984
    v_mfma_f32_16x16x32_bf16 v[120:123], a[92:95], a[136:139], v[120:123]
    ds_read_b64_tr_b16 a[36:37], v10 offset:40960
    v_mfma_f32_16x16x32_bf16 v[116:119], a[92:95], a[132:135], v[116:119]
    ds_read_b64_tr_b16 a[38:39], v10 offset:41984
    v_mfma_f32_16x16x32_bf16 v[112:115], a[92:95], a[128:131], v[112:115]
    ds_read_b64_tr_b16 a[40:41], v11 offset:40960
    v_mfma_f32_16x16x32_bf16 a[180:183], a[96:99], a[128:131], a[180:183]
    ds_read_b64_tr_b16 a[42:43], v11 offset:41984
    buffer_load_dwordx4 v3, s[12:15], s73 offen offset:1024 lds
    v_mfma_f32_16x16x32_bf16 a[184:187], a[96:99], a[132:135], a[184:187]
    ds_read_b64_tr_b16 a[44:45], v12 offset:40960
    v_mfma_f32_16x16x32_bf16 a[188:191], a[96:99], a[136:139], a[188:191]
    ds_read_b64_tr_b16 a[46:47], v12 offset:41984
    v_mfma_f32_16x16x32_bf16 a[192:195], a[96:99], a[140:143], a[192:195]
    ds_read_b64_tr_b16 a[48:49], v13 offset:40960
    s_add_u32 m0, s71, 24576
    v_mfma_f32_16x16x32_bf16 v[140:143], a[100:103], a[140:143], v[140:143]
    ds_read_b64_tr_b16 a[50:51], v13 offset:41984
    buffer_load_dwordx4 v3, s[16:19], s72 offen lds
    v_mfma_f32_16x16x32_bf16 v[136:139], a[100:103], a[136:139], v[136:139]
    ds_read_b64_tr_b16 a[52:53], v14 offset:40960
    v_mfma_f32_16x16x32_bf16 v[132:135], a[100:103], a[132:135], v[132:135]
    ds_read_b64_tr_b16 a[54:55], v14 offset:41984
    v_mfma_f32_16x16x32_bf16 v[128:131], a[100:103], a[128:131], v[128:131]
    ds_read_b64_tr_b16 a[144:145], v18 offset:32768
    v_mfma_f32_16x16x32_bf16 v[144:147], a[104:107], a[128:131], v[144:147]
    ds_read_b64_tr_b16 a[146:147], v18 offset:33792
    buffer_load_dwordx4 v3, s[16:19], s73 offen offset:1024 lds
    v_mfma_f32_16x16x32_bf16 v[148:151], a[104:107], a[132:135], v[148:151]
    ds_read_b64_tr_b16 a[148:149], v19 offset:32768
    v_mfma_f32_16x16x32_bf16 v[152:155], a[104:107], a[136:139], v[152:155]
    ds_read_b64_tr_b16 a[150:151], v19 offset:33792
    s_add_u32 s72, s72, 229376
    v_mfma_f32_16x16x32_bf16 v[156:159], a[104:107], a[140:143], v[156:159]
    s_cmp_eq_u32 s72, 7340032
    s_cselect_b32 s72, 0, s72
    v_mfma_f32_16x16x32_bf16 v[172:175], a[108:111], a[140:143], v[172:175]
    s_add_u32 s73, s72, 27648
    v_mfma_f32_16x16x32_bf16 v[168:171], a[108:111], a[136:139], v[168:171]
    buffer_load_dwordx4 v[224:227], v245, s[8:11], 0 offen offset:0
    v_mfma_f32_16x16x32_bf16 v[164:167], a[108:111], a[132:135], v[164:167]
    v_mfma_f32_16x16x32_bf16 v[160:163], a[108:111], a[128:131], v[160:163]
    v_mfma_f32_16x16x32_bf16 v[176:179], a[112:115], a[128:131], v[176:179]
    v_mfma_f32_16x16x32_bf16 v[180:183], a[112:115], a[132:135], v[180:183]
    buffer_load_dwordx4 v[228:231], v245, s[8:11], 0 offen offset:512
    v_mfma_f32_16x16x32_bf16 v[184:187], a[112:115], a[136:139], v[184:187]
    v_mfma_f32_16x16x32_bf16 v[188:191], a[112:115], a[140:143], v[188:191]
    v_mfma_f32_16x16x32_bf16 v[204:207], a[116:119], a[140:143], v[204:207]
    v_mfma_f32_16x16x32_bf16 v[200:203], a[116:119], a[136:139], v[200:203]
    v_mfma_f32_16x16x32_bf16 v[196:199], a[116:119], a[132:135], v[196:199]
    buffer_load_dwordx4 v[232:235], v245, s[8:11], 0 offen offset:1024
    v_mfma_f32_16x16x32_bf16 v[192:195], a[116:119], a[128:131], v[192:195]
    v_mfma_f32_16x16x32_bf16 v[208:211], a[120:123], a[128:131], v[208:211]
    v_mfma_f32_16x16x32_bf16 v[212:215], a[120:123], a[132:135], v[212:215]
    v_mfma_f32_16x16x32_bf16 v[216:219], a[120:123], a[136:139], v[216:219]
    buffer_load_dwordx4 v[236:239], v245, s[8:11], 0 offen offset:1536
    v_mfma_f32_16x16x32_bf16 v[220:223], a[120:123], a[140:143], v[220:223]
    v_mfma_f32_16x16x32_bf16 a[208:211], a[124:127], a[140:143], a[208:211]
    v_mfma_f32_16x16x32_bf16 a[204:207], a[124:127], a[136:139], a[204:207]
    v_mfma_f32_16x16x32_bf16 a[200:203], a[124:127], a[132:135], a[200:203]
    v_mfma_f32_16x16x32_bf16 a[196:199], a[124:127], a[128:131], a[196:199]
    s_waitcnt vmcnt(24) lgkmcnt(0)
    s_barrier
    v_mfma_f32_16x16x32_bf16 a[176:179], a[144:147], a[160:163], a[176:179]
    ds_read_b64_tr_b16 a[72:73], v8 offset:49152
    v_add_u32 v17, s75, v16
    v_mfma_f32_16x16x32_bf16 a[176:179], a[148:151], a[164:167], a[176:179]
    ds_read_b64_tr_b16 a[74:75], v8 offset:50176
    v_mfma_f32_16x16x32_bf16 v[32:35], a[0:3], a[56:59], v[32:35]
    ds_read_b64_tr_b16 a[76:77], v9 offset:49152
    s_add_u32 m0, s76, 4096
    v_mfma_f32_16x16x32_bf16 v[36:39], a[0:3], a[60:63], v[36:39]
    ds_read_b64_tr_b16 a[78:79], v9 offset:50176
    s_add_u32 s79, s77, 0x10000
    v_mfma_f32_16x16x32_bf16 v[40:43], a[0:3], a[64:67], v[40:43]
    ds_read_b128 a[128:131], v17 offset:0
    buffer_load_dwordx4 v4, s[8:11], s79 offen lds
    v_mfma_f32_16x16x32_bf16 v[44:47], a[0:3], a[68:71], v[44:47]
    ds_read_b128 a[132:135], v17 offset:2048
    s_mul_i32 s3, s66, 12288
    v_mfma_f32_16x16x32_bf16 v[60:63], a[4:7], a[68:71], v[60:63]
    ds_read_b128 a[136:139], v17 offset:4096
    s_lshr_b32 s6, s64, 1
    v_mfma_f32_16x16x32_bf16 v[56:59], a[4:7], a[64:67], v[56:59]
    ds_read_b128 a[140:143], v17 offset:6144
    s_mul_i32 s6, s6, 6144
    v_mfma_f32_16x16x32_bf16 v[52:55], a[4:7], a[60:63], v[52:55]
    ds_read_b64_tr_b16 a[80:81], v10 offset:49152
    s_add_u32 s3, s3, s6
    v_mfma_f32_16x16x32_bf16 v[48:51], a[4:7], a[56:59], v[48:51]
    ds_read_b64_tr_b16 a[82:83], v10 offset:50176
    v_mfma_f32_16x16x32_bf16 v[64:67], a[8:11], a[56:59], v[64:67]
    ds_read_b64_tr_b16 a[84:85], v11 offset:49152
    buffer_load_dwordx4 v5, s[8:11], s79 offen offset:1024 lds
    v_mfma_f32_16x16x32_bf16 v[68:71], a[8:11], a[60:63], v[68:71]
    ds_read_b64_tr_b16 a[86:87], v11 offset:50176
    s_lshr_b32 s6, s65, 1
    v_mfma_f32_16x16x32_bf16 v[72:75], a[8:11], a[64:67], v[72:75]
    ds_read_b64_tr_b16 a[88:89], v12 offset:49152
    v_mfma_f32_16x16x32_bf16 v[76:79], a[8:11], a[68:71], v[76:79]
    ds_read_b64_tr_b16 a[90:91], v12 offset:50176
    v_mfma_f32_16x16x32_bf16 v[92:95], a[12:15], a[68:71], v[92:95]
    ds_read_b64_tr_b16 a[92:93], v13 offset:49152
    s_lshl_b32 s6, s6, 8
    v_mfma_f32_16x16x32_bf16 v[88:91], a[12:15], a[64:67], v[88:91]
    ds_read_b64_tr_b16 a[94:95], v13 offset:50176
    v_mfma_f32_16x16x32_bf16 v[84:87], a[12:15], a[60:63], v[84:87]
    ds_read_b64_tr_b16 a[96:97], v14 offset:49152
    s_add_u32 s3, s3, s6
    v_mfma_f32_16x16x32_bf16 v[80:83], a[12:15], a[56:59], v[80:83]
    ds_read_b64_tr_b16 a[98:99], v14 offset:50176
    buffer_load_dwordx4 v6, s[8:11], s79 offen offset:2048 lds
    v_mfma_f32_16x16x32_bf16 v[96:99], a[16:19], a[56:59], v[96:99]
    ds_read_b64_tr_b16 a[100:101], v8 offset:57344
    v_mfma_f32_16x16x32_bf16 v[100:103], a[16:19], a[60:63], v[100:103]
    ds_read_b64_tr_b16 a[102:103], v8 offset:58368
    s_lshl_b32 s6, s85, 5
    v_mfma_f32_16x16x32_bf16 v[104:107], a[16:19], a[64:67], v[104:107]
    ds_read_b64_tr_b16 a[104:105], v9 offset:57344
    v_mfma_f32_16x16x32_bf16 v[108:111], a[16:19], a[68:71], v[108:111]
    ds_read_b64_tr_b16 a[106:107], v9 offset:58368
    v_mfma_f32_16x16x32_bf16 v[124:127], a[20:23], a[68:71], v[124:127]
    ds_read_b64_tr_b16 a[108:109], v10 offset:57344
    s_add_u32 s3, s3, s6
    v_mfma_f32_16x16x32_bf16 v[120:123], a[20:23], a[64:67], v[120:123]
    ds_read_b64_tr_b16 a[110:111], v10 offset:58368
    buffer_load_dwordx4 v7, s[8:11], s79 offen offset:3072 lds
    v_mfma_f32_16x16x32_bf16 v[116:119], a[20:23], a[60:63], v[116:119]
    ds_read_b64_tr_b16 a[112:113], v11 offset:57344
    v_mfma_f32_16x16x32_bf16 v[112:115], a[20:23], a[56:59], v[112:115]
    ds_read_b64_tr_b16 a[114:115], v11 offset:58368
    s_add_u32 s77, s77, 128
    v_mfma_f32_16x16x32_bf16 a[180:183], a[24:27], a[56:59], a[180:183]
    ds_read_b64_tr_b16 a[116:117], v12 offset:57344
    s_and_b32 s77, s77, 0x7ff
    v_mfma_f32_16x16x32_bf16 a[184:187], a[24:27], a[60:63], a[184:187]
    ds_read_b64_tr_b16 a[118:119], v12 offset:58368
    s_add_u32 s76, s76, 8192
    v_mfma_f32_16x16x32_bf16 a[188:191], a[24:27], a[64:67], a[188:191]
    s_cmp_eq_u32 s76, s91
    s_cselect_b32 s76, s70, s76
    s_add_u32 s3, s3, 32768
    v_mfma_f32_16x16x32_bf16 a[192:195], a[24:27], a[68:71], a[192:195]
    ds_read_b64_tr_b16 a[120:121], v13 offset:57344
    s_add_u32 m0, s71, 32768
    v_mfma_f32_16x16x32_bf16 v[140:143], a[28:31], a[68:71], v[140:143]
    ds_read_b64_tr_b16 a[122:123], v13 offset:58368
    buffer_load_dwordx4 v3, s[12:15], s72 offen lds
    v_mfma_f32_16x16x32_bf16 v[136:139], a[28:31], a[64:67], v[136:139]
    ds_read_b64_tr_b16 a[124:125], v14 offset:57344
    v_bfe_u32 v1, v0, 1, 3
    v_mfma_f32_16x16x32_bf16 v[132:135], a[28:31], a[60:63], v[132:135]
    ds_read_b64_tr_b16 a[126:127], v14 offset:58368
    v_lshlrev_b32 v254, 10, v1
    v_mfma_f32_16x16x32_bf16 v[128:131], a[28:31], a[56:59], v[128:131]
    ds_read_b64_tr_b16 a[144:145], v18 offset:49152
    v_and_b32 v255, 1, v0
    v_mfma_f32_16x16x32_bf16 v[144:147], a[32:35], a[56:59], v[144:147]
    ds_read_b64_tr_b16 a[146:147], v18 offset:50176
    v_mfma_f32_16x16x32_bf16 v[148:151], a[32:35], a[60:63], v[148:151]
    ds_read_b64_tr_b16 a[148:149], v19 offset:49152
    v_mfma_f32_16x16x32_bf16 v[152:155], a[32:35], a[64:67], v[152:155]
    ds_read_b64_tr_b16 a[150:151], v19 offset:50176
    v_lshl_add_u32 v254, v255, 5, v254
    v_mfma_f32_16x16x32_bf16 v[156:159], a[32:35], a[68:71], v[156:159]
    buffer_load_dwordx4 v3, s[12:15], s73 offen offset:1024 lds
    v_mfma_f32_16x16x32_bf16 v[172:175], a[36:39], a[68:71], v[172:175]
    v_mfma_f32_16x16x32_bf16 v[168:171], a[36:39], a[64:67], v[168:171]
    v_lshrrev_b32 v255, 4, v0
    v_mfma_f32_16x16x32_bf16 v[164:167], a[36:39], a[60:63], v[164:167]
    v_mfma_f32_16x16x32_bf16 v[160:163], a[36:39], a[56:59], v[160:163]
    v_mfma_f32_16x16x32_bf16 v[176:179], a[40:43], a[56:59], v[176:179]
    s_add_u32 m0, s71, 40960
    v_lshl_add_u32 v254, v255, 3, v254
    v_mfma_f32_16x16x32_bf16 v[180:183], a[40:43], a[60:63], v[180:183]
    buffer_load_dwordx4 v3, s[16:19], s72 offen lds
    v_mfma_f32_16x16x32_bf16 v[184:187], a[40:43], a[64:67], v[184:187]
    v_cmp_le_u32 vcc, 6, v1
    v_mfma_f32_16x16x32_bf16 v[188:191], a[40:43], a[68:71], v[188:191]
    v_mfma_f32_16x16x32_bf16 v[204:207], a[44:47], a[68:71], v[204:207]
    v_mfma_f32_16x16x32_bf16 v[200:203], a[44:47], a[64:67], v[200:203]
    v_mov_b32 v255, 0x80000000
    v_mfma_f32_16x16x32_bf16 v[196:199], a[44:47], a[60:63], v[196:199]
    v_mfma_f32_16x16x32_bf16 v[192:195], a[44:47], a[56:59], v[192:195]
    v_mfma_f32_16x16x32_bf16 v[208:211], a[48:51], a[56:59], v[208:211]
    buffer_load_dwordx4 v3, s[16:19], s73 offen offset:1024 lds
    v_add_u32 v254, s3, v254
    v_mfma_f32_16x16x32_bf16 v[212:215], a[48:51], a[60:63], v[212:215]
    s_add_u32 s72, s72, 229376
    v_mfma_f32_16x16x32_bf16 v[216:219], a[48:51], a[64:67], v[216:219]
    s_cmp_eq_u32 s72, 7340032
    s_cselect_b32 s72, 0, s72
    v_mfma_f32_16x16x32_bf16 v[220:223], a[48:51], a[68:71], v[220:223]
    s_add_u32 s73, s72, 27648
    v_cndmask_b32 v254, v254, v255, vcc
    v_mfma_f32_16x16x32_bf16 a[208:211], a[52:55], a[68:71], a[208:211]
    v_mfma_f32_16x16x32_bf16 a[204:207], a[52:55], a[64:67], a[204:207]
    v_mfma_f32_16x16x32_bf16 a[200:203], a[52:55], a[60:63], a[200:203]
    v_mfma_f32_16x16x32_bf16 a[196:199], a[52:55], a[56:59], a[196:199]
    s_waitcnt vmcnt(24) lgkmcnt(0)
    s_barrier
    v_mfma_f32_16x16x32_bf16 a[176:179], a[144:147], a[160:163], a[176:179]
    ds_read_b64_tr_b16 a[0:1], v8 offset:0
    s_add_u32 s75, s75, 8192
    v_mfma_f32_16x16x32_bf16 a[176:179], a[148:151], a[164:167], a[176:179]
    s_cmp_eq_u32 s75, 24576
    s_cselect_b32 s75, 0, s75
    v_mfma_f32_16x16x32_bf16 v[32:35], a[72:75], a[128:131], v[32:35]
    ds_read_b64_tr_b16 a[2:3], v8 offset:1024
    v_add_u32 v17, s75, v15
    v_mfma_f32_16x16x32_bf16 v[36:39], a[72:75], a[132:135], v[36:39]
    ds_read_b64_tr_b16 a[4:5], v9 offset:0
    s_mov_b32 m0, s76
    v_mfma_f32_16x16x32_bf16 v[40:43], a[72:75], a[136:139], v[40:43]
    ds_read_b64_tr_b16 a[6:7], v9 offset:1024
    buffer_load_dwordx4 v4, s[8:11], s77 offen lds
    v_mfma_f32_16x16x32_bf16 v[44:47], a[72:75], a[140:143], v[44:47]
    ds_read_b128 a[56:59], v17 offset:0
    s_nop 0
    v_mfma_f32_16x16x32_bf16 v[60:63], a[76:79], a[140:143], v[60:63]
    ds_read_b128 a[60:63], v17 offset:2048
    s_nop 0
    v_mfma_f32_16x16x32_bf16 v[56:59], a[76:79], a[136:139], v[56:59]
    ds_read_b128 a[64:67], v17 offset:4096
    s_nop 0
    v_mfma_f32_16x16x32_bf16 v[52:55], a[76:79], a[132:135], v[52:55]
    ds_read_b128 a[68:71], v17 offset:6144
    s_nop 0
    v_mfma_f32_16x16x32_bf16 v[48:51], a[76:79], a[128:131], v[48:51]
    ds_read_b64_tr_b16 a[8:9], v10 offset:0
    s_nop 0
    v_mfma_f32_16x16x32_bf16 v[64:67], a[80:83], a[128:131], v[64:67]
    ds_read_b64_tr_b16 a[10:11], v10 offset:1024
    buffer_load_dwordx4 v5, s[8:11], s77 offen offset:1024 lds
    v_mfma_f32_16x16x32_bf16 v[68:71], a[80:83], a[132:135], v[68:71]
    ds_read_b64_tr_b16 a[12:13], v11 offset:0
    v_accvgpr_read_b32 v240, a176
    v_mfma_f32_16x16x32_bf16 v[72:75], a[80:83], a[136:139], v[72:75]
    ds_read_b64_tr_b16 a[14:15], v11 offset:1024
    v_accvgpr_read_b32 v241, a177
    v_mfma_f32_16x16x32_bf16 v[76:79], a[80:83], a[140:143], v[76:79]
    ds_read_b64_tr_b16 a[16:17], v12 offset:0
    v_accvgpr_read_b32 v242, a178
    v_mfma_f32_16x16x32_bf16 v[92:95], a[84:87], a[140:143], v[92:95]
    ds_read_b64_tr_b16 a[18:19], v12 offset:1024
    v_accvgpr_read_b32 v243, a179
    v_mfma_f32_16x16x32_bf16 v[88:91], a[84:87], a[136:139], v[88:91]
    ds_read_b64_tr_b16 a[20:21], v13 offset:0
    v_cvt_pk_bf16_f32 v252, v240, v241
    v_mfma_f32_16x16x32_bf16 v[84:87], a[84:87], a[132:135], v[84:87]
    ds_read_b64_tr_b16 a[22:23], v13 offset:1024
    v_cvt_pk_bf16_f32 v253, v242, v243
    v_mfma_f32_16x16x32_bf16 v[80:83], a[84:87], a[128:131], v[80:83]
    ds_read_b64_tr_b16 a[24:25], v14 offset:0
    buffer_load_dwordx4 v6, s[8:11], s77 offen offset:2048 lds
    v_mfma_f32_16x16x32_bf16 v[96:99], a[88:91], a[128:131], v[96:99]
    ds_read_b64_tr_b16 a[26:27], v14 offset:1024
    v_lshlrev_b32 v246, 16, v252
    v_mfma_f32_16x16x32_bf16 v[100:103], a[88:91], a[132:135], v[100:103]
    ds_read_b64_tr_b16 a[28:29], v8 offset:8192
    v_and_b32 v247, 0xffff0000, v252
    v_mfma_f32_16x16x32_bf16 v[104:107], a[88:91], a[136:139], v[104:107]
    ds_read_b64_tr_b16 a[30:31], v8 offset:9216
    v_lshlrev_b32 v20, 16, v253
    v_mfma_f32_16x16x32_bf16 v[108:111], a[88:91], a[140:143], v[108:111]
    ds_read_b64_tr_b16 a[32:33], v9 offset:8192
    v_and_b32 v21, 0xffff0000, v253
    v_mfma_f32_16x16x32_bf16 v[124:127], a[92:95], a[140:143], v[124:127]
    ds_read_b64_tr_b16 a[34:35], v9 offset:9216
    v_sub_f32 v240, v240, v246
    v_mfma_f32_16x16x32_bf16 v[120:123], a[92:95], a[136:139], v[120:123]
    ds_read_b64_tr_b16 a[36:37], v10 offset:8192
    buffer_load_dwordx4 v7, s[8:11], s77 offen offset:3072 lds
    v_mfma_f32_16x16x32_bf16 v[116:119], a[92:95], a[132:135], v[116:119]
    ds_read_b64_tr_b16 a[38:39], v10 offset:9216
    v_sub_f32 v241, v241, v247
    v_mfma_f32_16x16x32_bf16 v[112:115], a[92:95], a[128:131], v[112:115]
    ds_read_b64_tr_b16 a[40:41], v11 offset:8192
    v_sub_f32 v242, v242, v20
    v_mfma_f32_16x16x32_bf16 a[180:183], a[96:99], a[128:131], a[180:183]
    ds_read_b64_tr_b16 a[42:43], v11 offset:9216
    v_sub_f32 v243, v243, v21
    v_mfma_f32_16x16x32_bf16 a[184:187], a[96:99], a[132:135], a[184:187]
    ds_read_b64_tr_b16 a[44:45], v12 offset:8192
    v_mfma_f32_16x16x32_bf16 a[188:191], a[96:99], a[136:139], a[188:191]
    ds_read_b64_tr_b16 a[46:47], v12 offset:9216
    v_bfe_u32 v1, v0, 2, 2
    v_mfma_f32_16x16x32_bf16 a[192:195], a[96:99], a[140:143], a[192:195]
    ds_read_b64_tr_b16 a[48:49], v13 offset:8192
    s_add_u32 m0, s71, 49152
    v_mfma_f32_16x16x32_bf16 v[140:143], a[100:103], a[140:143], v[140:143]
    ds_read_b64_tr_b16 a[50:51], v13 offset:9216
    buffer_load_dwordx4 v3, s[12:15], s72 offen lds
    v_mfma_f32_16x16x32_bf16 v[136:139], a[100:103], a[136:139], v[136:139]
    ds_read_b64_tr_b16 a[52:53], v14 offset:8192
    v_cmp_eq_u32 vcc, 1, v1
    v_mfma_f32_16x16x32_bf16 v[132:135], a[100:103], a[132:135], v[132:135]
    ds_read_b64_tr_b16 a[54:55], v14 offset:9216
    v_cvt_pk_bf16_f32 v24, v240, v241
    v_mfma_f32_16x16x32_bf16 v[128:131], a[100:103], a[128:131], v[128:131]
    v_cvt_pk_bf16_f32 v25, v242, v243
    v_cndmask_b32 v252, v252, v24, vcc
    v_mfma_f32_16x16x32_bf16 v[144:147], a[104:107], a[128:131], v[144:147]
    v_mfma_f32_16x16x32_bf16 v[148:151], a[104:107], a[132:135], v[148:151]
    v_cndmask_b32 v253, v253, v25, vcc
    v_mfma_f32_16x16x32_bf16 v[152:155], a[104:107], a[136:139], v[152:155]
    v_lshlrev_b32 v246, 16, v24
    v_mfma_f32_16x16x32_bf16 v[156:159], a[104:107], a[140:143], v[156:159]
    buffer_load_dwordx4 v3, s[12:15], s73 offen offset:1024 lds
    v_mfma_f32_16x16x32_bf16 v[172:175], a[108:111], a[140:143], v[172:175]
    v_and_b32 v247, 0xffff0000, v24
    v_mfma_f32_16x16x32_bf16 v[168:171], a[108:111], a[136:139], v[168:171]
    v_lshlrev_b32 v20, 16, v25
    v_mfma_f32_16x16x32_bf16 v[164:167], a[108:111], a[132:135], v[164:167]
    v_mfma_f32_16x16x32_bf16 v[160:163], a[108:111], a[128:131], v[160:163]
    v_and_b32 v21, 0xffff0000, v25
    v_mfma_f32_16x16x32_bf16 v[176:179], a[112:115], a[128:131], v[176:179]
    s_add_u32 m0, s71, 57344
    v_sub_f32 v240, v240, v246
    v_mfma_f32_16x16x32_bf16 v[180:183], a[112:115], a[132:135], v[180:183]
    buffer_load_dwordx4 v3, s[16:19], s72 offen lds
    v_mfma_f32_16x16x32_bf16 v[184:187], a[112:115], a[136:139], v[184:187]
    v_sub_f32 v241, v241, v247
    v_mfma_f32_16x16x32_bf16 v[188:191], a[112:115], a[140:143], v[188:191]
    v_sub_f32 v242, v242, v20
    v_mfma_f32_16x16x32_bf16 v[204:207], a[116:119], a[140:143], v[204:207]
    v_mfma_f32_16x16x32_bf16 v[200:203], a[116:119], a[136:139], v[200:203]
    v_sub_f32 v243, v243, v21
    v_mfma_f32_16x16x32_bf16 v[196:199], a[116:119], a[132:135], v[196:199]
    v_cmp_eq_u32 vcc, 2, v1
    v_mfma_f32_16x16x32_bf16 v[192:195], a[116:119], a[128:131], v[192:195]
    v_mfma_f32_16x16x32_bf16 v[208:211], a[120:123], a[128:131], v[208:211]
    buffer_load_dwordx4 v3, s[16:19], s73 offen offset:1024 lds
    v_cvt_pk_bf16_f32 v24, v240, v241
    v_mfma_f32_16x16x32_bf16 v[212:215], a[120:123], a[132:135], v[212:215]
    s_add_u32 s72, s72, 229376
    v_cvt_pk_bf16_f32 v25, v242, v243
    v_mfma_f32_16x16x32_bf16 v[216:219], a[120:123], a[136:139], v[216:219]
    s_cmp_eq_u32 s72, 7340032
    s_cselect_b32 s72, 0, s72
    v_mfma_f32_16x16x32_bf16 v[220:223], a[120:123], a[140:143], v[220:223]
    s_add_u32 s73, s72, 27648
    v_cndmask_b32 v252, v252, v24, vcc
    v_mfma_f32_16x16x32_bf16 a[208:211], a[124:127], a[140:143], a[208:211]
    v_cndmask_b32 v253, v253, v25, vcc
    v_mfma_f32_16x16x32_bf16 a[204:207], a[124:127], a[136:139], a[204:207]
    v_mfma_f32_16x16x32_bf16 a[200:203], a[124:127], a[132:135], a[200:203]
    v_mfma_f32_16x16x32_bf16 a[196:199], a[124:127], a[128:131], a[196:199]
    s_waitcnt vmcnt(16) lgkmcnt(0)
    s_barrier
    v_mfma_f32_16x16x32_bf16 v[32:35], a[0:3], a[56:59], v[32:35]
    ds_read_b64_tr_b16 a[72:73], v8 offset:16384
    v_add_u32 v17, s75, v16
    v_mfma_f32_16x16x32_bf16 v[36:39], a[0:3], a[60:63], v[36:39]
    ds_read_b64_tr_b16 a[74:75], v8 offset:17408
    v_mfma_f32_16x16x32_bf16 v[40:43], a[0:3], a[64:67], v[40:43]
    ds_read_b64_tr_b16 a[76:77], v9 offset:16384
    s_add_u32 m0, s76, 4096
    v_mfma_f32_16x16x32_bf16 v[44:47], a[0:3], a[68:71], v[44:47]
    ds_read_b64_tr_b16 a[78:79], v9 offset:17408
    s_add_u32 s79, s77, 0x10000
    v_mfma_f32_16x16x32_bf16 v[60:63], a[4:7], a[68:71], v[60:63]
    ds_read_b128 a[128:131], v17 offset:0
    buffer_load_dwordx4 v4, s[8:11], s79 offen lds
    v_mfma_f32_16x16x32_bf16 v[56:59], a[4:7], a[64:67], v[56:59]
    ds_read_b128 a[132:135], v17 offset:2048
    v_lshlrev_b32 v240, 16, v224
    v_and_b32 v241, 0xffff0000, v224
    v_mfma_f32_16x16x32_bf16 v[52:55], a[4:7], a[60:63], v[52:55]
    ds_read_b128 a[136:139], v17 offset:4096
    v_lshlrev_b32 v242, 16, v225
    v_mfma_f32_16x16x32_bf16 v[48:51], a[4:7], a[56:59], v[48:51]
    ds_read_b128 a[140:143], v17 offset:6144
    v_and_b32 v243, 0xffff0000, v225
    v_mfma_f32_16x16x32_bf16 v[64:67], a[8:11], a[56:59], v[64:67]
    ds_read_b64_tr_b16 a[80:81], v10 offset:16384
    v_add_f32 v240, v240, v242
    v_add_f32 v241, v241, v243
    v_lshlrev_b32 v242, 16, v226
    v_mfma_f32_16x16x32_bf16 v[68:71], a[8:11], a[60:63], v[68:71]
    ds_read_b64_tr_b16 a[82:83], v10 offset:17408
    buffer_load_dwordx4 v5, s[8:11], s79 offen offset:1024 lds
    v_mfma_f32_16x16x32_bf16 v[72:75], a[8:11], a[64:67], v[72:75]
    ds_read_b64_tr_b16 a[84:85], v11 offset:16384
    v_and_b32 v243, 0xffff0000, v226
    v_mfma_f32_16x16x32_bf16 v[76:79], a[8:11], a[68:71], v[76:79]
    ds_read_b64_tr_b16 a[86:87], v11 offset:17408
    v_add_f32 v240, v240, v242
    v_mfma_f32_16x16x32_bf16 v[92:95], a[12:15], a[68:71], v[92:95]
    ds_read_b64_tr_b16 a[88:89], v12 offset:16384
    v_add_f32 v241, v241, v243
    v_mfma_f32_16x16x32_bf16 v[88:91], a[12:15], a[64:67], v[88:91]
    ds_read_b64_tr_b16 a[90:91], v12 offset:17408
    v_lshlrev_b32 v242, 16, v227
    v_and_b32 v243, 0xffff0000, v227
    v_mfma_f32_16x16x32_bf16 v[84:87], a[12:15], a[60:63], v[84:87]
    ds_read_b64_tr_b16 a[92:93], v13 offset:16384
    v_add_f32 v240, v240, v242
    v_add_f32 v241, v241, v243
    v_mfma_f32_16x16x32_bf16 v[80:83], a[12:15], a[56:59], v[80:83]
    ds_read_b64_tr_b16 a[94:95], v13 offset:17408
    buffer_load_dwordx4 v6, s[8:11], s79 offen offset:2048 lds
    v_mfma_f32_16x16x32_bf16 v[96:99], a[16:19], a[56:59], v[96:99]
    ds_read_b64_tr_b16 a[96:97], v14 offset:16384
    v_lshlrev_b32 v242, 16, v228
    v_mfma_f32_16x16x32_bf16 v[100:103], a[16:19], a[60:63], v[100:103]
    ds_read_b64_tr_b16 a[98:99], v14 offset:17408
    v_and_b32 v243, 0xffff0000, v228
    v_add_f32 v240, v240, v242
    v_mfma_f32_16x16x32_bf16 v[104:107], a[16:19], a[64:67], v[104:107]
    ds_read_b64_tr_b16 a[100:101], v8 offset:24576
    v_add_f32 v241, v241, v243
    v_mfma_f32_16x16x32_bf16 v[108:111], a[16:19], a[68:71], v[108:111]
    ds_read_b64_tr_b16 a[102:103], v8 offset:25600
    v_lshlrev_b32 v242, 16, v229
    v_mfma_f32_16x16x32_bf16 v[124:127], a[20:23], a[68:71], v[124:127]
    ds_read_b64_tr_b16 a[104:105], v9 offset:24576
    v_and_b32 v243, 0xffff0000, v229
    v_add_f32 v240, v240, v242
    v_add_f32 v241, v241, v243
    v_lshlrev_b32 v242, 16, v230
    v_and_b32 v243, 0xffff0000, v230
    v_add_f32 v240, v240, v242
    v_mfma_f32_16x16x32_bf16 v[120:123], a[20:23], a[64:67], v[120:123]
    ds_read_b64_tr_b16 a[106:107], v9 offset:25600
    buffer_load_dwordx4 v7, s[8:11], s79 offen offset:3072 lds
    v_mfma_f32_16x16x32_bf16 v[116:119], a[20:23], a[60:63], v[116:119]
    ds_read_b64_tr_b16 a[108:109], v10 offset:24576
    s_add_u32 s77, s77, 128
    v_mfma_f32_16x16x32_bf16 v[112:115], a[20:23], a[56:59], v[112:115]
    ds_read_b64_tr_b16 a[110:111], v10 offset:25600
    s_and_b32 s77, s77, 0x7ff
    v_mfma_f32_16x16x32_bf16 a[180:183], a[24:27], a[56:59], a[180:183]
    ds_read_b64_tr_b16 a[112:113], v11 offset:24576
    s_add_u32 s76, s76, 8192
    v_mfma_f32_16x16x32_bf16 a[184:187], a[24:27], a[60:63], a[184:187]
    s_cmp_eq_u32 s76, s91
    s_cselect_b32 s76, s70, s76
    v_add_f32 v241, v241, v243
    v_lshlrev_b32 v242, 16, v231
    v_and_b32 v243, 0xffff0000, v231
    v_add_f32 v240, v240, v242
    v_mfma_f32_16x16x32_bf16 a[188:191], a[24:27], a[64:67], a[188:191]
    ds_read_b64_tr_b16 a[114:115], v11 offset:25600
    s_add_u32 m0, s71, 0
    v_mfma_f32_16x16x32_bf16 a[192:195], a[24:27], a[68:71], a[192:195]
    ds_read_b64_tr_b16 a[116:117], v12 offset:24576
    buffer_load_dwordx4 v3, s[12:15], s72 offen lds
    v_mfma_f32_16x16x32_bf16 v[140:143], a[28:31], a[68:71], v[140:143]
    ds_read_b64_tr_b16 a[118:119], v12 offset:25600
    v_add_f32 v241, v241, v243
    v_mfma_f32_16x16x32_bf16 v[136:139], a[28:31], a[64:67], v[136:139]
    ds_read_b64_tr_b16 a[120:121], v13 offset:24576
    v_lshlrev_b32 v242, 16, v232
    v_and_b32 v243, 0xffff0000, v232
    v_mfma_f32_16x16x32_bf16 v[132:135], a[28:31], a[60:63], v[132:135]
    ds_read_b64_tr_b16 a[122:123], v13 offset:25600
    v_add_f32 v240, v240, v242
    v_mfma_f32_16x16x32_bf16 v[128:131], a[28:31], a[56:59], v[128:131]
    ds_read_b64_tr_b16 a[124:125], v14 offset:24576
    v_add_f32 v241, v241, v243
    v_lshlrev_b32 v242, 16, v233
    v_mfma_f32_16x16x32_bf16 v[144:147], a[32:35], a[56:59], v[144:147]
    ds_read_b64_tr_b16 a[126:127], v14 offset:25600
    buffer_load_dwordx4 v3, s[12:15], s73 offen offset:1024 lds
    v_mfma_f32_16x16x32_bf16 v[148:151], a[32:35], a[60:63], v[148:151]
    v_and_b32 v243, 0xffff0000, v233
    v_add_f32 v240, v240, v242
    v_mfma_f32_16x16x32_bf16 v[152:155], a[32:35], a[64:67], v[152:155]
    v_add_f32 v241, v241, v243
    v_lshlrev_b32 v242, 16, v234
    v_mfma_f32_16x16x32_bf16 v[156:159], a[32:35], a[68:71], v[156:159]
    v_and_b32 v243, 0xffff0000, v234
    v_add_f32 v240, v240, v242
    v_mfma_f32_16x16x32_bf16 v[172:175], a[36:39], a[68:71], v[172:175]
    v_add_f32 v241, v241, v243
    v_lshlrev_b32 v242, 16, v235
    v_mfma_f32_16x16x32_bf16 v[168:171], a[36:39], a[64:67], v[168:171]
    s_add_u32 m0, s71, 8192
    v_and_b32 v243, 0xffff0000, v235
    v_add_f32 v240, v240, v242
    v_mfma_f32_16x16x32_bf16 v[164:167], a[36:39], a[60:63], v[164:167]
    buffer_load_dwordx4 v3, s[16:19], s72 offen lds
    v_add_f32 v241, v241, v243
    v_lshlrev_b32 v242, 16, v236
    v_mfma_f32_16x16x32_bf16 v[160:163], a[36:39], a[56:59], v[160:163]
    v_and_b32 v243, 0xffff0000, v236
    v_add_f32 v240, v240, v242
    v_mfma_f32_16x16x32_bf16 v[176:179], a[40:43], a[56:59], v[176:179]
    v_add_f32 v241, v241, v243
    v_lshlrev_b32 v242, 16, v237
    v_mfma_f32_16x16x32_bf16 v[180:183], a[40:43], a[60:63], v[180:183]
    v_and_b32 v243, 0xffff0000, v237
    v_add_f32 v240, v240, v242
    v_mfma_f32_16x16x32_bf16 v[184:187], a[40:43], a[64:67], v[184:187]
    v_add_f32 v241, v241, v243
    v_mfma_f32_16x16x32_bf16 v[188:191], a[40:43], a[68:71], v[188:191]
    buffer_load_dwordx4 v3, s[16:19], s73 offen offset:1024 lds
    v_lshlrev_b32 v242, 16, v238
    v_mfma_f32_16x16x32_bf16 v[204:207], a[44:47], a[68:71], v[204:207]
    v_and_b32 v243, 0xffff0000, v238
    v_mfma_f32_16x16x32_bf16 v[200:203], a[44:47], a[64:67], v[200:203]
    v_add_f32 v240, v240, v242
    v_add_f32 v241, v241, v243
    v_mfma_f32_16x16x32_bf16 v[196:199], a[44:47], a[60:63], v[196:199]
    s_add_u32 s72, s72, 229376
    v_lshlrev_b32 v242, 16, v239
    v_mfma_f32_16x16x32_bf16 v[192:195], a[44:47], a[56:59], v[192:195]
    s_cmp_eq_u32 s72, 7340032
    s_cselect_b32 s72, 0, s72
    v_and_b32 v243, 0xffff0000, v239
    v_mfma_f32_16x16x32_bf16 v[208:211], a[48:51], a[56:59], v[208:211]
    s_add_u32 s73, s72, 27648
    v_add_f32 v240, v240, v242
    v_mfma_f32_16x16x32_bf16 v[212:215], a[48:51], a[60:63], v[212:215]
    buffer_store_dwordx2 v[252:253], v254, s[36:39], 0 offen sc1
    v_add_f32 v241, v241, v243
    v_add_f32 v246, v240, v241
    v_mfma_f32_16x16x32_bf16 v[216:219], a[48:51], a[64:67], v[216:219]
    s_nop 1
    v_mfma_f32_16x16x32_bf16 v[220:223], a[48:51], a[68:71], v[220:223]
    v_add_f32_dpp v246, v246, v246 quad_perm:[1,0,3,2] row_mask:0xf bank_mask:0xf
    v_mfma_f32_16x16x32_bf16 a[208:211], a[52:55], a[68:71], a[208:211]
    s_nop 1
    v_mfma_f32_16x16x32_bf16 a[204:207], a[52:55], a[64:67], a[204:207]
    v_add_f32_dpp v246, v246, v246 quad_perm:[2,3,0,1] row_mask:0xf bank_mask:0xf
    v_mfma_f32_16x16x32_bf16 a[200:203], a[52:55], a[60:63], a[200:203]
    v_mfma_f32_16x16x32_bf16 a[196:199], a[52:55], a[56:59], a[196:199]
    s_waitcnt vmcnt(17) lgkmcnt(0)
    s_barrier
    v_mfma_f32_16x16x32_bf16 v[32:35], a[72:75], a[128:131], v[32:35]
    ds_read_b64_tr_b16 a[0:1], v8 offset:32768
    s_add_u32 s75, s75, 8192
    v_mfma_f32_16x16x32_bf16 v[36:39], a[72:75], a[132:135], v[36:39]
    s_cmp_eq_u32 s75, 24576
    s_cselect_b32 s75, 0, s75
    v_mfma_f32_16x16x32_bf16 v[40:43], a[72:75], a[136:139], v[40:43]
    ds_read_b64_tr_b16 a[2:3], v8 offset:33792
    v_add_u32 v17, s75, v15
    v_mfma_f32_16x16x32_bf16 v[44:47], a[72:75], a[140:143], v[44:47]
    ds_read_b64_tr_b16 a[4:5], v9 offset:32768
    s_mov_b32 m0, s76
    v_mfma_f32_16x16x32_bf16 v[60:63], a[76:79], a[140:143], v[60:63]
    ds_read_b64_tr_b16 a[6:7], v9 offset:33792
    buffer_load_dwordx4 v4, s[8:11], s77 offen lds
    v_mfma_f32_16x16x32_bf16 v[56:59], a[76:79], a[136:139], v[56:59]
    ds_read_b128 a[56:59], v17 offset:0
    s_nop 1
    v_add_f32_dpp v246, v246, v246 row_half_mirror row_mask:0xf bank_mask:0xf
    s_nop 1
    v_mfma_f32_16x16x32_bf16 v[52:55], a[76:79], a[132:135], v[52:55]
    ds_read_b128 a[60:63], v17 offset:2048
    buffer_load_dwordx4 v5, s[8:11], s77 offen offset:1024 lds
    v_mfma_f32_16x16x32_bf16 v[48:51], a[76:79], a[128:131], v[48:51]
    ds_read_b128 a[64:67], v17 offset:4096
    v_add_f32_dpp v246, v246, v246 row_mirror row_mask:0xf bank_mask:0xf
    v_mfma_f32_16x16x32_bf16 v[64:67], a[80:83], a[128:131], v[64:67]
    ds_read_b128 a[68:71], v17 offset:6144
    v_mov_b32 v242, v246
    s_nop 1
    v_permlane16_swap_b32 v246, v242
    v_mfma_f32_16x16x32_bf16 v[68:71], a[80:83], a[132:135], v[68:71]
    ds_read_b64_tr_b16 a[8:9], v10 offset:32768
    buffer_load_dwordx4 v6, s[8:11], s77 offen offset:2048 lds
    v_mfma_f32_16x16x32_bf16 v[72:75], a[80:83], a[136:139], v[72:75]
    ds_read_b64_tr_b16 a[10:11], v10 offset:33792
    s_nop 1
    v_mfma_f32_16x16x32_bf16 v[76:79], a[80:83], a[140:143], v[76:79]
    ds_read_b64_tr_b16 a[12:13], v11 offset:32768
    v_add_f32 v246, v246, v242
    v_mul_f32 v246, 0xba800000, v246
    v_lshlrev_b32 v242, 16, v224
    v_and_b32 v243, 0xffff0000, v224
    v_add_f32 v242, v242, v246
    v_mfma_f32_16x16x32_bf16 v[92:95], a[84:87], a[140:143], v[92:95]
    ds_read_b64_tr_b16 a[14:15], v11 offset:33792
    buffer_load_dwordx4 v7, s[8:11], s77 offen offset:3072 lds
    v_mfma_f32_16x16x32_bf16 v[88:91], a[84:87], a[136:139], v[88:91]
    ds_read_b64_tr_b16 a[16:17], v12 offset:32768
    s_add_u32 m0, s71, 16384
    v_mfma_f32_16x16x32_bf16 v[84:87], a[84:87], a[132:135], v[84:87]
    ds_read_b64_tr_b16 a[18:19], v12 offset:33792
    buffer_load_dwordx4 v3, s[12:15], s72 offen lds
    v_mfma_f32_16x16x32_bf16 v[80:83], a[84:87], a[128:131], v[80:83]
    ds_read_b64_tr_b16 a[20:21], v13 offset:32768
    v_add_f32 v243, v243, v246
    v_mfma_f32_16x16x32_bf16 v[96:99], a[88:91], a[128:131], v[96:99]
    ds_read_b64_tr_b16 a[22:23], v13 offset:33792
    v_mul_f32 v240, v242, v242
    v_mul_f32 v241, v243, v243
    v_lshlrev_b32 v242, 16, v225
    v_mfma_f32_16x16x32_bf16 v[100:103], a[88:91], a[132:135], v[100:103]
    ds_read_b64_tr_b16 a[24:25], v14 offset:32768
    buffer_load_dwordx4 v3, s[12:15], s73 offen offset:1024 lds
    v_mfma_f32_16x16x32_bf16 v[104:107], a[88:91], a[136:139], v[104:107]
    ds_read_b64_tr_b16 a[26:27], v14 offset:33792
    v_and_b32 v243, 0xffff0000, v225
    v_add_f32 v242, v242, v246
    v_add_f32 v243, v243, v246
    v_mfma_f32_16x16x32_bf16 v[108:111], a[88:91], a[140:143], v[108:111]
    ds_read_b64_tr_b16 a[28:29], v8 offset:40960
    s_add_u32 m0, s71, 24576
    v_mfma_f32_16x16x32_bf16 v[124:127], a[92:95], a[140:143], v[124:127]
    ds_read_b64_tr_b16 a[30:31], v8 offset:41984
    buffer_load_dwordx4 v3, s[16:19], s72 offen lds
    v_mfma_f32_16x16x32_bf16 v[120:123], a[92:95], a[136:139], v[120:123]
    ds_read_b64_tr_b16 a[32:33], v9 offset:40960
    v_fmac_f32 v240, v242, v242
    v_fmac_f32 v241, v243, v243
    v_lshlrev_b32 v242, 16, v226
    v_and_b32 v243, 0xffff0000, v226
    v_mfma_f32_16x16x32_bf16 v[116:119], a[92:95], a[132:135], v[116:119]
    ds_read_b64_tr_b16 a[34:35], v9 offset:41984
    buffer_load_dwordx4 v3, s[16:19], s73 offen offset:1024 lds
    v_mfma_f32_16x16x32_bf16 v[112:115], a[92:95], a[128:131], v[112:115]
    ds_read_b64_tr_b16 a[36:37], v10 offset:40960
    s_add_u32 s72, s72, 229376
    v_mfma_f32_16x16x32_bf16 a[180:183], a[96:99], a[128:131], a[180:183]
    s_cmp_eq_u32 s72, 7340032
    s_cselect_b32 s72, 0, s72
    v_add_f32 v242, v242, v246
    v_add_f32 v243, v243, v246
    v_fmac_f32 v240, v242, v242
    v_fmac_f32 v241, v243, v243
    v_mfma_f32_16x16x32_bf16 a[184:187], a[96:99], a[132:135], a[184:187]
    ds_read_b64_tr_b16 a[38:39], v10 offset:41984
    s_add_u32 s73, s72, 27648
    v_mfma_f32_16x16x32_bf16 a[188:191], a[96:99], a[136:139], a[188:191]
    ds_read_b64_tr_b16 a[40:41], v11 offset:40960
    buffer_load_dwordx4 a[240:243], v248, s[56:59], 0 offen offset:0 nt
    v_mfma_f32_16x16x32_bf16 a[192:195], a[96:99], a[140:143], a[192:195]
    ds_read_b64_tr_b16 a[42:43], v11 offset:41984
    v_lshlrev_b32 v242, 16, v227
    v_and_b32 v243, 0xffff0000, v227
    v_mfma_f32_16x16x32_bf16 v[140:143], a[100:103], a[140:143], v[140:143]
    ds_read_b64_tr_b16 a[44:45], v12 offset:40960
    buffer_load_dwordx4 a[244:247], v248, s[56:59], 0 offen offset:2048 nt
    v_mfma_f32_16x16x32_bf16 v[136:139], a[100:103], a[136:139], v[136:139]
    ds_read_b64_tr_b16 a[46:47], v12 offset:41984
    v_add_f32 v242, v242, v246
    v_add_f32 v243, v243, v246
    v_fmac_f32 v240, v242, v242
    v_mfma_f32_16x16x32_bf16 v[132:135], a[100:103], a[132:135], v[132:135]
    ds_read_b64_tr_b16 a[48:49], v13 offset:40960
    buffer_load_dwordx4 a[248:251], v251, s[56:59], 0 offen offset:0 nt
    v_mfma_f32_16x16x32_bf16 v[128:131], a[100:103], a[128:131], v[128:131]
    ds_read_b64_tr_b16 a[50:51], v13 offset:41984
    v_fmac_f32 v241, v243, v243
    v_mfma_f32_16x16x32_bf16 v[144:147], a[104:107], a[128:131], v[144:147]
    ds_read_b64_tr_b16 a[52:53], v14 offset:40960
    v_lshlrev_b32 v242, 16, v228
    v_and_b32 v243, 0xffff0000, v228
    v_mfma_f32_16x16x32_bf16 v[148:151], a[104:107], a[132:135], v[148:151]
    ds_read_b64_tr_b16 a[54:55], v14 offset:41984
    buffer_load_dwordx4 a[252:255], v251, s[56:59], 0 offen offset:2048 nt
    v_mfma_f32_16x16x32_bf16 v[152:155], a[104:107], a[136:139], v[152:155]
    v_add_f32 v242, v242, v246
    v_add_f32 v243, v243, v246
    v_mfma_f32_16x16x32_bf16 v[156:159], a[104:107], a[140:143], v[156:159]
    v_fmac_f32 v240, v242, v242
    v_fmac_f32 v241, v243, v243
    v_mfma_f32_16x16x32_bf16 v[172:175], a[108:111], a[140:143], v[172:175]
    buffer_load_dwordx4 a[212:215], v249, s[52:55], 0 offen offset:2048 nt
    v_lshlrev_b32 v242, 16, v229
    v_and_b32 v243, 0xffff0000, v229
    v_mfma_f32_16x16x32_bf16 v[168:171], a[108:111], a[136:139], v[168:171]
    v_add_f32 v242, v242, v246
    v_add_f32 v243, v243, v246
    v_mfma_f32_16x16x32_bf16 v[164:167], a[108:111], a[132:135], v[164:167]
    buffer_load_dwordx4 a[216:219], v250, s[52:55], 0 offen offset:0 nt
    v_fmac_f32 v240, v242, v242
    v_fmac_f32 v241, v243, v243
    v_mfma_f32_16x16x32_bf16 v[160:163], a[108:111], a[128:131], v[160:163]
    v_lshlrev_b32 v242, 16, v230
    v_and_b32 v243, 0xffff0000, v230
    v_mfma_f32_16x16x32_bf16 v[176:179], a[112:115], a[128:131], v[176:179]
    v_add_f32 v242, v242, v246
    v_add_f32 v243, v243, v246
    v_mfma_f32_16x16x32_bf16 v[180:183], a[112:115], a[132:135], v[180:183]
    buffer_load_dwordx4 a[220:223], v250, s[52:55], 0 offen offset:2048 nt
    v_fmac_f32 v240, v242, v242
    v_fmac_f32 v241, v243, v243
    v_mfma_f32_16x16x32_bf16 v[184:187], a[112:115], a[136:139], v[184:187]
    v_lshlrev_b32 v242, 16, v231
    v_and_b32 v243, 0xffff0000, v231
    v_mfma_f32_16x16x32_bf16 v[188:191], a[112:115], a[140:143], v[188:191]
    v_add_f32 v242, v242, v246
    v_mfma_f32_16x16x32_bf16 v[204:207], a[116:119], a[140:143], v[204:207]
    buffer_load_dwordx4 a[224:227], v248, s[52:55], 0 offen offset:0 nt
    v_add_f32 v243, v243, v246
    v_mfma_f32_16x16x32_bf16 v[200:203], a[116:119], a[136:139], v[200:203]
    v_fmac_f32 v240, v242, v242
    v_fmac_f32 v241, v243, v243
    v_mfma_f32_16x16x32_bf16 v[196:199], a[116:119], a[132:135], v[196:199]
    buffer_load_dwordx4 a[228:231], v248, s[52:55], 0 offen offset:2048 nt
    v_lshlrev_b32 v242, 16, v232
    v_mfma_f32_16x16x32_bf16 v[192:195], a[116:119], a[128:131], v[192:195]
    v_and_b32 v243, 0xffff0000, v232
    v_mfma_f32_16x16x32_bf16 v[208:211], a[120:123], a[128:131], v[208:211]
    v_add_f32 v242, v242, v246
    v_mfma_f32_16x16x32_bf16 v[212:215], a[120:123], a[132:135], v[212:215]
    buffer_load_dwordx4 a[232:235], v251, s[52:55], 0 offen offset:0 nt
    v_add_f32 v243, v243, v246
    v_fmac_f32 v240, v242, v242
    v_mfma_f32_16x16x32_bf16 v[216:219], a[120:123], a[136:139], v[216:219]
    v_fmac_f32 v241, v243, v243
    v_mfma_f32_16x16x32_bf16 v[220:223], a[120:123], a[140:143], v[220:223]
    v_lshlrev_b32 v242, 16, v233
    v_mfma_f32_16x16x32_bf16 a[208:211], a[124:127], a[140:143], a[208:211]
    buffer_load_dwordx4 a[236:239], v251, s[52:55], 0 offen offset:2048 nt
    v_and_b32 v243, 0xffff0000, v233
    v_mfma_f32_16x16x32_bf16 a[204:207], a[124:127], a[136:139], a[204:207]
    v_add_f32 v242, v242, v246
    v_mfma_f32_16x16x32_bf16 a[200:203], a[124:127], a[132:135], a[200:203]
    v_mfma_f32_16x16x32_bf16 a[196:199], a[124:127], a[128:131], a[196:199]
    s_waitcnt vmcnt(28) lgkmcnt(0)
    s_barrier
    v_mfma_f32_16x16x32_bf16 v[32:35], a[0:3], a[56:59], v[32:35]
    ds_read_b64_tr_b16 a[72:73], v8 offset:49152
    v_add_u32 v17, s75, v16
    v_mfma_f32_16x16x32_bf16 v[36:39], a[0:3], a[60:63], v[36:39]
    ds_read_b64_tr_b16 a[74:75], v8 offset:50176
    v_mfma_f32_16x16x32_bf16 v[40:43], a[0:3], a[64:67], v[40:43]
    ds_read_b64_tr_b16 a[76:77], v9 offset:49152
    s_add_u32 m0, s76, 4096
    v_mfma_f32_16x16x32_bf16 v[44:47], a[0:3], a[68:71], v[44:47]
    ds_read_b64_tr_b16 a[78:79], v9 offset:50176
    s_add_u32 s79, s77, 0x10000
    v_mfma_f32_16x16x32_bf16 v[60:63], a[4:7], a[68:71], v[60:63]
    ds_read_b128 a[128:131], v17 offset:0
    buffer_load_dwordx4 v4, s[8:11], s79 offen lds
    v_mfma_f32_16x16x32_bf16 v[56:59], a[4:7], a[64:67], v[56:59]
    ds_read_b128 a[132:135], v17 offset:2048
    v_add_f32 v243, v243, v246
    v_fmac_f32 v240, v242, v242
    v_mfma_f32_16x16x32_bf16 v[52:55], a[4:7], a[60:63], v[52:55]
    ds_read_b128 a[136:139], v17 offset:4096
    v_fmac_f32 v241, v243, v243
    v_mfma_f32_16x16x32_bf16 v[48:51], a[4:7], a[56:59], v[48:51]
    ds_read_b128 a[140:143], v17 offset:6144
    v_lshlrev_b32 v242, 16, v234
    v_mfma_f32_16x16x32_bf16 v[64:67], a[8:11], a[56:59], v[64:67]
    ds_read_b64_tr_b16 a[80:81], v10 offset:49152
    v_and_b32 v243, 0xffff0000, v234
    v_mfma_f32_16x16x32_bf16 v[68:71], a[8:11], a[60:63], v[68:71]
    ds_read_b64_tr_b16 a[82:83], v10 offset:50176
    v_add_f32 v242, v242, v246
    v_add_f32 v243, v243, v246
    v_fmac_f32 v240, v242, v242
    v_mfma_f32_16x16x32_bf16 v[72:75], a[8:11], a[64:67], v[72:75]
    ds_read_b64_tr_b16 a[84:85], v11 offset:49152
    buffer_load_dwordx4 v5, s[8:11], s79 offen offset:1024 lds
    v_mfma_f32_16x16x32_bf16 v[76:79], a[8:11], a[68:71], v[76:79]
    ds_read_b64_tr_b16 a[86:87], v11 offset:50176
    v_fmac_f32 v241, v243, v243
    v_mfma_f32_16x16x32_bf16 v[92:95], a[12:15], a[68:71], v[92:95]
    ds_read_b64_tr_b16 a[88:89], v12 offset:49152
    v_lshlrev_b32 v242, 16, v235
    v_mfma_f32_16x16x32_bf16 v[88:91], a[12:15], a[64:67], v[88:91]
    ds_read_b64_tr_b16 a[90:91], v12 offset:50176
    v_and_b32 v243, 0xffff0000, v235
    v_mfma_f32_16x16x32_bf16 v[84:87], a[12:15], a[60:63], v[84:87]
    ds_read_b64_tr_b16 a[92:93], v13 offset:49152
    v_add_f32 v242, v242, v246
    v_add_f32 v243, v243, v246
    v_mfma_f32_16x16x32_bf16 v[80:83], a[12:15], a[56:59], v[80:83]
    ds_read_b64_tr_b16 a[94:95], v13 offset:50176
    v_fmac_f32 v240, v242, v242
    v_fmac_f32 v241, v243, v243
    v_mfma_f32_16x16x32_bf16 v[96:99], a[16:19], a[56:59], v[96:99]
    ds_read_b64_tr_b16 a[96:97], v14 offset:49152
    buffer_load_dwordx4 v6, s[8:11], s79 offen offset:2048 lds
    v_mfma_f32_16x16x32_bf16 v[100:103], a[16:19], a[60:63], v[100:103]
    ds_read_b64_tr_b16 a[98:99], v14 offset:50176
    v_lshlrev_b32 v242, 16, v236
    v_mfma_f32_16x16x32_bf16 v[104:107], a[16:19], a[64:67], v[104:107]
    ds_read_b64_tr_b16 a[100:101], v8 offset:57344
    v_and_b32 v243, 0xffff0000, v236
    v_add_f32 v242, v242, v246
    v_mfma_f32_16x16x32_bf16 v[108:111], a[16:19], a[68:71], v[108:111]
    ds_read_b64_tr_b16 a[102:103], v8 offset:58368
    v_add_f32 v243, v243, v246
    v_mfma_f32_16x16x32_bf16 v[124:127], a[20:23], a[68:71], v[124:127]
    ds_read_b64_tr_b16 a[104:105], v9 offset:57344
    v_fmac_f32 v240, v242, v242
    v_mfma_f32_16x16x32_bf16 v[120:123], a[20:23], a[64:67], v[120:123]
    ds_read_b64_tr_b16 a[106:107], v9 offset:58368
    v_fmac_f32 v241, v243, v243
    v_mfma_f32_16x16x32_bf16 v[116:119], a[20:23], a[60:63], v[116:119]
    ds_read_b64_tr_b16 a[108:109], v10 offset:57344
    v_lshlrev_b32 v242, 16, v237
    v_and_b32 v243, 0xffff0000, v237
    v_add_f32 v242, v242, v246
    v_add_f32 v243, v243, v246
    v_fmac_f32 v240, v242, v242
    v_fmac_f32 v241, v243, v243
    v_mfma_f32_16x16x32_bf16 v[112:115], a[20:23], a[56:59], v[112:115]
    ds_read_b64_tr_b16 a[110:111], v10 offset:58368
    buffer_load_dwordx4 v7, s[8:11], s79 offen offset:3072 lds
    v_mfma_f32_16x16x32_bf16 a[180:183], a[24:27], a[56:59], a[180:183]
    ds_read_b64_tr_b16 a[112:113], v11 offset:57344
    s_add_u32 s77, s77, 128
    v_mfma_f32_16x16x32_bf16 a[184:187], a[24:27], a[60:63], a[184:187]
    ds_read_b64_tr_b16 a[114:115], v11 offset:58368
    s_and_b32 s77, s77, 0x7ff
    v_mfma_f32_16x16x32_bf16 a[188:191], a[24:27], a[64:67], a[188:191]
    ds_read_b64_tr_b16 a[116:117], v12 offset:57344
    s_add_u32 s76, s76, 8192
    v_mfma_f32_16x16x32_bf16 a[192:195], a[24:27], a[68:71], a[192:195]
    s_cmp_eq_u32 s76, s91
    s_cselect_b32 s76, s70, s76
    v_lshlrev_b32 v242, 16, v238
    v_and_b32 v243, 0xffff0000, v238
    v_add_f32 v242, v242, v246
    v_add_f32 v243, v243, v246
    v_mfma_f32_16x16x32_bf16 v[140:143], a[28:31], a[68:71], v[140:143]
    ds_read_b64_tr_b16 a[118:119], v12 offset:58368
    s_add_u32 m0, s71, 32768
    v_mfma_f32_16x16x32_bf16 v[136:139], a[28:31], a[64:67], v[136:139]
    ds_read_b64_tr_b16 a[120:121], v13 offset:57344
    buffer_load_dwordx4 v3, s[12:15], s72 offen lds
    v_mfma_f32_16x16x32_bf16 v[132:135], a[28:31], a[60:63], v[132:135]
    ds_read_b64_tr_b16 a[122:123], v13 offset:58368
    v_fmac_f32 v240, v242, v242
    v_mfma_f32_16x16x32_bf16 v[128:131], a[28:31], a[56:59], v[128:131]
    ds_read_b64_tr_b16 a[124:125], v14 offset:57344
    v_fmac_f32 v241, v243, v243
    v_mfma_f32_16x16x32_bf16 v[144:147], a[32:35], a[56:59], v[144:147]
    ds_read_b64_tr_b16 a[126:127], v14 offset:58368
    v_lshlrev_b32 v242, 16, v239
    v_and_b32 v243, 0xffff0000, v239
    v_mfma_f32_16x16x32_bf16 v[148:151], a[32:35], a[60:63], v[148:151]
    v_add_f32 v242, v242, v246
    v_add_f32 v243, v243, v246
    v_mfma_f32_16x16x32_bf16 v[152:155], a[32:35], a[64:67], v[152:155]
    v_fmac_f32 v240, v242, v242
    v_fmac_f32 v241, v243, v243
    v_mfma_f32_16x16x32_bf16 v[156:159], a[32:35], a[68:71], v[156:159]
    buffer_load_dwordx4 v3, s[12:15], s73 offen offset:1024 lds
    v_add_f32 v247, v240, v241
    v_mfma_f32_16x16x32_bf16 v[172:175], a[36:39], a[68:71], v[172:175]
    s_nop 1
    v_add_f32_dpp v247, v247, v247 quad_perm:[1,0,3,2] row_mask:0xf bank_mask:0xf
    v_mfma_f32_16x16x32_bf16 v[168:171], a[36:39], a[64:67], v[168:171]
    s_nop 1
    v_add_f32_dpp v247, v247, v247 quad_perm:[2,3,0,1] row_mask:0xf bank_mask:0xf
    v_mfma_f32_16x16x32_bf16 v[164:167], a[36:39], a[60:63], v[164:167]
    s_nop 1
    v_add_f32_dpp v247, v247, v247 row_half_mirror row_mask:0xf bank_mask:0xf
    v_mfma_f32_16x16x32_bf16 v[160:163], a[36:39], a[56:59], v[160:163]
    s_nop 1
    v_add_f32_dpp v247, v247, v247 row_mirror row_mask:0xf bank_mask:0xf
    v_mfma_f32_16x16x32_bf16 v[176:179], a[40:43], a[56:59], v[176:179]
    v_mov_b32 v242, v247
    s_nop 1
    v_mfma_f32_16x16x32_bf16 v[180:183], a[40:43], a[60:63], v[180:183]
    s_add_u32 m0, s71, 40960
    v_permlane16_swap_b32 v247, v242
    v_mfma_f32_16x16x32_bf16 v[184:187], a[40:43], a[64:67], v[184:187]
    buffer_load_dwordx4 v3, s[16:19], s72 offen lds
    s_nop 1
    v_mfma_f32_16x16x32_bf16 v[188:191], a[40:43], a[68:71], v[188:191]
    v_add_f32 v247, v247, v242
    v_mul_f32 v247, 0x3a800000, v247
    v_mfma_f32_16x16x32_bf16 v[204:207], a[44:47], a[68:71], v[204:207]
    v_cvt_pk_bf16_f32 v247, v247, v247
    v_mfma_f32_16x16x32_bf16 v[200:203], a[44:47], a[64:67], v[200:203]
    v_lshlrev_b32 v247, 16, v247
    v_add_f32 v247, 0x3727c5ac, v247
    v_mfma_f32_16x16x32_bf16 v[196:199], a[44:47], a[60:63], v[196:199]
    v_cvt_pk_bf16_f32 v247, v247, v247
    v_mfma_f32_16x16x32_bf16 v[192:195], a[44:47], a[56:59], v[192:195]
    v_lshlrev_b32 v247, 16, v247
    v_mfma_f32_16x16x32_bf16 v[208:211], a[48:51], a[56:59], v[208:211]
    buffer_load_dwordx4 v3, s[16:19], s73 offen offset:1024 lds
    v_sqrt_f32 v247, v247
    v_mfma_f32_16x16x32_bf16 v[212:215], a[48:51], a[60:63], v[212:215]
    s_add_u32 s72, s72, 229376
    v_cvt_pk_bf16_f32 v246, v246, v246
    v_lshlrev_b32 v246, 16, v246
    v_mfma_f32_16x16x32_bf16 v[216:219], a[48:51], a[64:67], v[216:219]
    s_cmp_eq_u32 s72, 7340032
    s_cselect_b32 s72, 0, s72
    v_cvt_pk_bf16_f32 v247, v247, v247
    v_mfma_f32_16x16x32_bf16 v[220:223], a[48:51], a[68:71], v[220:223]
    s_add_u32 s73, s72, 27648
    v_lshlrev_b32 v247, 16, v247
    v_mfma_f32_16x16x32_bf16 a[208:211], a[52:55], a[68:71], a[208:211]
    v_rcp_f32 v247, v247
    v_mfma_f32_16x16x32_bf16 a[204:207], a[52:55], a[64:67], a[204:207]
    s_nop 0
    v_mfma_f32_16x16x32_bf16 a[200:203], a[52:55], a[60:63], a[200:203]
    v_mfma_f32_16x16x32_bf16 a[196:199], a[52:55], a[56:59], a[196:199]
    s_waitcnt vmcnt(28) lgkmcnt(0)
    s_barrier
    v_mfma_f32_16x16x32_bf16 v[32:35], a[72:75], a[128:131], v[32:35]
    ds_read_b64_tr_b16 a[0:1], v8 offset:0
    s_add_u32 s75, s75, 8192
    v_mfma_f32_16x16x32_bf16 v[36:39], a[72:75], a[132:135], v[36:39]
    s_cmp_eq_u32 s75, 24576
    s_cselect_b32 s75, 0, s75
    v_mfma_f32_16x16x32_bf16 v[40:43], a[72:75], a[136:139], v[40:43]
    ds_read_b64_tr_b16 a[2:3], v8 offset:1024
    v_add_u32 v17, s75, v15
    v_mfma_f32_16x16x32_bf16 v[44:47], a[72:75], a[140:143], v[44:47]
    ds_read_b64_tr_b16 a[4:5], v9 offset:0
    s_mov_b32 m0, s76
    v_mfma_f32_16x16x32_bf16 v[60:63], a[76:79], a[140:143], v[60:63]
    ds_read_b64_tr_b16 a[6:7], v9 offset:1024
    buffer_load_dwordx4 v4, s[8:11], s77 offen lds
    v_mfma_f32_16x16x32_bf16 v[56:59], a[76:79], a[136:139], v[56:59]
    ds_read_b128 a[56:59], v17 offset:0
    v_mfma_f32_16x16x32_bf16 v[52:55], a[76:79], a[132:135], v[52:55]
    ds_read_b128 a[60:63], v17 offset:2048
    v_mfma_f32_16x16x32_bf16 v[48:51], a[76:79], a[128:131], v[48:51]
    ds_read_b128 a[64:67], v17 offset:4096
    v_mfma_f32_16x16x32_bf16 v[64:67], a[80:83], a[128:131], v[64:67]
    ds_read_b128 a[68:71], v17 offset:6144
    v_mfma_f32_16x16x32_bf16 v[68:71], a[80:83], a[132:135], v[68:71]
    ds_read_b64_tr_b16 a[8:9], v10 offset:0
    buffer_load_dwordx4 v5, s[8:11], s77 offen offset:1024 lds
    v_mfma_f32_16x16x32_bf16 v[72:75], a[80:83], a[136:139], v[72:75]
    ds_read_b64_tr_b16 a[10:11], v10 offset:1024
    v_mfma_f32_16x16x32_bf16 v[76:79], a[80:83], a[140:143], v[76:79]
    ds_read_b64_tr_b16 a[12:13], v11 offset:0
    v_mfma_f32_16x16x32_bf16 v[92:95], a[84:87], a[140:143], v[92:95]
    ds_read_b64_tr_b16 a[14:15], v11 offset:1024
    v_mfma_f32_16x16x32_bf16 v[88:91], a[84:87], a[136:139], v[88:91]
    ds_read_b64_tr_b16 a[16:17], v12 offset:0
    v_mfma_f32_16x16x32_bf16 v[84:87], a[84:87], a[132:135], v[84:87]
    ds_read_b64_tr_b16 a[18:19], v12 offset:1024
    v_mfma_f32_16x16x32_bf16 v[80:83], a[84:87], a[128:131], v[80:83]
    ds_read_b64_tr_b16 a[20:21], v13 offset:0
    buffer_load_dwordx4 v6, s[8:11], s77 offen offset:2048 lds
    v_mfma_f32_16x16x32_bf16 v[96:99], a[88:91], a[128:131], v[96:99]
    ds_read_b64_tr_b16 a[22:23], v13 offset:1024
    v_mfma_f32_16x16x32_bf16 v[100:103], a[88:91], a[132:135], v[100:103]
    ds_read_b64_tr_b16 a[24:25], v14 offset:0
    v_mfma_f32_16x16x32_bf16 v[104:107], a[88:91], a[136:139], v[104:107]
    ds_read_b64_tr_b16 a[26:27], v14 offset:1024
    v_mfma_f32_16x16x32_bf16 v[108:111], a[88:91], a[140:143], v[108:111]
    ds_read_b64_tr_b16 a[28:29], v8 offset:8192
    v_mfma_f32_16x16x32_bf16 v[124:127], a[92:95], a[140:143], v[124:127]
    ds_read_b64_tr_b16 a[30:31], v8 offset:9216
    v_mfma_f32_16x16x32_bf16 v[120:123], a[92:95], a[136:139], v[120:123]
    ds_read_b64_tr_b16 a[32:33], v9 offset:8192
    buffer_load_dwordx4 v7, s[8:11], s77 offen offset:3072 lds
    v_mfma_f32_16x16x32_bf16 v[116:119], a[92:95], a[132:135], v[116:119]
    ds_read_b64_tr_b16 a[34:35], v9 offset:9216
    v_mfma_f32_16x16x32_bf16 v[112:115], a[92:95], a[128:131], v[112:115]
    ds_read_b64_tr_b16 a[36:37], v10 offset:8192
    v_mfma_f32_16x16x32_bf16 a[180:183], a[96:99], a[128:131], a[180:183]
    ds_read_b64_tr_b16 a[38:39], v10 offset:9216
    v_mfma_f32_16x16x32_bf16 a[184:187], a[96:99], a[132:135], a[184:187]
    ds_read_b64_tr_b16 a[40:41], v11 offset:8192
    s_add_u32 m0, s71, 49152
    v_mfma_f32_16x16x32_bf16 a[188:191], a[96:99], a[136:139], a[188:191]
    ds_read_b64_tr_b16 a[42:43], v11 offset:9216
    buffer_load_dwordx4 v3, s[12:15], s72 offen lds
    v_mfma_f32_16x16x32_bf16 a[192:195], a[96:99], a[140:143], a[192:195]
    ds_read_b64_tr_b16 a[44:45], v12 offset:8192
    v_mfma_f32_16x16x32_bf16 v[140:143], a[100:103], a[140:143], v[140:143]
    ds_read_b64_tr_b16 a[46:47], v12 offset:9216
    v_mfma_f32_16x16x32_bf16 v[136:139], a[100:103], a[136:139], v[136:139]
    ds_read_b64_tr_b16 a[48:49], v13 offset:8192
    v_mfma_f32_16x16x32_bf16 v[132:135], a[100:103], a[132:135], v[132:135]
    ds_read_b64_tr_b16 a[50:51], v13 offset:9216
    v_mfma_f32_16x16x32_bf16 v[128:131], a[100:103], a[128:131], v[128:131]
    ds_read_b64_tr_b16 a[52:53], v14 offset:8192
    v_mfma_f32_16x16x32_bf16 v[144:147], a[104:107], a[128:131], v[144:147]
    ds_read_b64_tr_b16 a[54:55], v14 offset:9216
    buffer_load_dwordx4 v3, s[12:15], s73 offen offset:1024 lds
    v_mfma_f32_16x16x32_bf16 v[148:151], a[104:107], a[132:135], v[148:151]
    v_mfma_f32_16x16x32_bf16 v[152:155], a[104:107], a[136:139], v[152:155]
    v_mfma_f32_16x16x32_bf16 v[156:159], a[104:107], a[140:143], v[156:159]
    v_mfma_f32_16x16x32_bf16 v[172:175], a[108:111], a[140:143], v[172:175]
    v_mfma_f32_16x16x32_bf16 v[168:171], a[108:111], a[136:139], v[168:171]
    s_add_u32 m0, s71, 57344
    v_mfma_f32_16x16x32_bf16 v[164:167], a[108:111], a[132:135], v[164:167]
    buffer_load_dwordx4 v3, s[16:19], s72 offen lds
    v_mfma_f32_16x16x32_bf16 v[160:163], a[108:111], a[128:131], v[160:163]
    v_mfma_f32_16x16x32_bf16 v[176:179], a[112:115], a[128:131], v[176:179]
    v_mfma_f32_16x16x32_bf16 v[180:183], a[112:115], a[132:135], v[180:183]
    v_mfma_f32_16x16x32_bf16 v[184:187], a[112:115], a[136:139], v[184:187]
    v_mfma_f32_16x16x32_bf16 v[188:191], a[112:115], a[140:143], v[188:191]
    buffer_load_dwordx4 v3, s[16:19], s73 offen offset:1024 lds
    v_mfma_f32_16x16x32_bf16 v[204:207], a[116:119], a[140:143], v[204:207]
    v_mfma_f32_16x16x32_bf16 v[200:203], a[116:119], a[136:139], v[200:203]
    v_mfma_f32_16x16x32_bf16 v[196:199], a[116:119], a[132:135], v[196:199]
    s_add_u32 s72, s72, 229376
    v_mfma_f32_16x16x32_bf16 v[192:195], a[116:119], a[128:131], v[192:195]
    s_cmp_eq_u32 s72, 7340032
    s_cselect_b32 s72, 0, s72
    v_mfma_f32_16x16x32_bf16 v[208:211], a[120:123], a[128:131], v[208:211]
    s_add_u32 s73, s72, 27648
    v_mfma_f32_16x16x32_bf16 v[212:215], a[120:123], a[132:135], v[212:215]
    buffer_store_dwordx2 v[246:247], v244, s[36:39], 0 offen offset:0 sc1
    v_mfma_f32_16x16x32_bf16 v[216:219], a[120:123], a[136:139], v[216:219]
    v_mfma_f32_16x16x32_bf16 v[220:223], a[120:123], a[140:143], v[220:223]
    v_mfma_f32_16x16x32_bf16 a[208:211], a[124:127], a[140:143], a[208:211]
    v_mfma_f32_16x16x32_bf16 a[204:207], a[124:127], a[136:139], a[204:207]
    v_mfma_f32_16x16x32_bf16 a[200:203], a[124:127], a[132:135], a[200:203]
    v_mfma_f32_16x16x32_bf16 a[196:199], a[124:127], a[128:131], a[196:199]
    s_waitcnt vmcnt(17) lgkmcnt(0)
    s_barrier
    v_mfma_f32_16x16x32_bf16 v[32:35], a[0:3], a[56:59], v[32:35]
    ds_read_b64_tr_b16 a[72:73], v8 offset:16384
    v_add_u32 v17, s75, v16
    v_mfma_f32_16x16x32_bf16 v[36:39], a[0:3], a[60:63], v[36:39]
    ds_read_b64_tr_b16 a[74:75], v8 offset:17408
    v_accvgpr_read_b32 v1, a152
    v_lshlrev_b32 v224, 16, v1
    v_and_b32 v226, 0xffff0000, v1
    v_accvgpr_read_b32 v1, a153
    v_mfma_f32_16x16x32_bf16 v[40:43], a[0:3], a[64:67], v[40:43]
    ds_read_b64_tr_b16 a[76:77], v9 offset:16384
    s_add_u32 m0, s76, 4096
    v_mfma_f32_16x16x32_bf16 v[44:47], a[0:3], a[68:71], v[44:47]
    ds_read_b64_tr_b16 a[78:79], v9 offset:17408
    s_add_u32 s79, s77, 0x10000
    v_mfma_f32_16x16x32_bf16 v[60:63], a[4:7], a[68:71], v[60:63]
    ds_read_b128 a[128:131], v17 offset:0
    buffer_load_dwordx4 v4, s[8:11], s79 offen lds
    v_mfma_f32_16x16x32_bf16 v[56:59], a[4:7], a[64:67], v[56:59]
    ds_read_b128 a[132:135], v17 offset:2048
    v_lshlrev_b32 v228, 16, v1
    v_mfma_f32_16x16x32_bf16 v[52:55], a[4:7], a[60:63], v[52:55]
    ds_read_b128 a[136:139], v17 offset:4096
    v_and_b32 v230, 0xffff0000, v1
    v_accvgpr_read_b32 v1, a154
    v_mfma_f32_16x16x32_bf16 v[48:51], a[4:7], a[56:59], v[48:51]
    ds_read_b128 a[140:143], v17 offset:6144
    v_lshlrev_b32 v225, 16, v1
    v_mfma_f32_16x16x32_bf16 v[64:67], a[8:11], a[56:59], v[64:67]
    ds_read_b64_tr_b16 a[80:81], v10 offset:16384
    v_and_b32 v227, 0xffff0000, v1
    v_accvgpr_read_b32 v1, a155
    v_mfma_f32_16x16x32_bf16 v[68:71], a[8:11], a[60:63], v[68:71]
    ds_read_b64_tr_b16 a[82:83], v10 offset:17408
    v_lshlrev_b32 v229, 16, v1
    v_and_b32 v231, 0xffff0000, v1
    v_accvgpr_read_b32 v233, a212
    v_mfma_f32_16x16x32_bf16 v[72:75], a[8:11], a[64:67], v[72:75]
    ds_read_b64_tr_b16 a[84:85], v11 offset:16384
    buffer_load_dwordx4 v5, s[8:11], s79 offen offset:1024 lds
    v_mfma_f32_16x16x32_bf16 v[76:79], a[8:11], a[68:71], v[76:79]
    ds_read_b64_tr_b16 a[86:87], v11 offset:17408
    v_lshlrev_b32 v232, 16, v233
    v_and_b32 v233, 0xffff0000, v233
    v_mfma_f32_16x16x32_bf16 v[92:95], a[12:15], a[68:71], v[92:95]
    ds_read_b64_tr_b16 a[88:89], v12 offset:16384
    v_accvgpr_read_b32 v235, a216
    v_mfma_f32_16x16x32_bf16 v[88:91], a[12:15], a[64:67], v[88:91]
    ds_read_b64_tr_b16 a[90:91], v12 offset:17408
    v_lshlrev_b32 v234, 16, v235
    v_and_b32 v235, 0xffff0000, v235
    v_mfma_f32_16x16x32_bf16 v[84:87], a[12:15], a[60:63], v[84:87]
    ds_read_b64_tr_b16 a[92:93], v13 offset:16384
    v_accvgpr_read_b32 v237, a220
    v_lshlrev_b32 v236, 16, v237
    v_mfma_f32_16x16x32_bf16 v[80:83], a[12:15], a[56:59], v[80:83]
    ds_read_b64_tr_b16 a[94:95], v13 offset:17408
    v_and_b32 v237, 0xffff0000, v237
    v_accvgpr_read_b32 v239, a224
    v_lshlrev_b32 v238, 16, v239
    v_mfma_f32_16x16x32_bf16 v[96:99], a[16:19], a[56:59], v[96:99]
    ds_read_b64_tr_b16 a[96:97], v14 offset:16384
    buffer_load_dwordx4 v6, s[8:11], s79 offen offset:2048 lds
    v_mfma_f32_16x16x32_bf16 v[100:103], a[16:19], a[60:63], v[100:103]
    ds_read_b64_tr_b16 a[98:99], v14 offset:17408
    v_and_b32 v239, 0xffff0000, v239
    v_mfma_f32_16x16x32_bf16 v[104:107], a[16:19], a[64:67], v[104:107]
    ds_read_b64_tr_b16 a[100:101], v8 offset:24576
    v_accvgpr_read_b32 v241, a228
    v_lshlrev_b32 v240, 16, v241
    v_mfma_f32_16x16x32_bf16 v[108:111], a[16:19], a[68:71], v[108:111]
    ds_read_b64_tr_b16 a[102:103], v8 offset:25600
    v_and_b32 v241, 0xffff0000, v241
    v_accvgpr_read_b32 v243, a232
    v_mfma_f32_16x16x32_bf16 v[124:127], a[20:23], a[68:71], v[124:127]
    ds_read_b64_tr_b16 a[104:105], v9 offset:24576
    v_lshlrev_b32 v242, 16, v243
    v_mfma_f32_16x16x32_bf16 v[120:123], a[20:23], a[64:67], v[120:123]
    ds_read_b64_tr_b16 a[106:107], v9 offset:25600
    v_and_b32 v243, 0xffff0000, v243
    v_accvgpr_read_b32 v245, a236
    v_mfma_f32_16x16x32_bf16 v[116:119], a[20:23], a[60:63], v[116:119]
    ds_read_b64_tr_b16 a[108:109], v10 offset:24576
    v_lshlrev_b32 v244, 16, v245
    v_and_b32 v245, 0xffff0000, v245
    v_accvgpr_read_b32 v247, a240
    v_mul_f32 v232, v232, v230
    v_mul_f32 v233, v233, v231
    v_lshlrev_b32 v246, 16, v247
    v_and_b32 v247, 0xffff0000, v247
    v_fmac_f32 v232, v234, v228
    v_mfma_f32_16x16x32_bf16 v[112:115], a[20:23], a[56:59], v[112:115]
    ds_read_b64_tr_b16 a[110:111], v10 offset:25600
    buffer_load_dwordx4 v7, s[8:11], s79 offen offset:3072 lds
    v_mfma_f32_16x16x32_bf16 a[180:183], a[24:27], a[56:59], a[180:183]
    ds_read_b64_tr_b16 a[112:113], v11 offset:24576
    s_add_u32 s77, s77, 128
    v_mfma_f32_16x16x32_bf16 a[184:187], a[24:27], a[60:63], a[184:187]
    ds_read_b64_tr_b16 a[114:115], v11 offset:25600
    s_and_b32 s77, s77, 0x7ff
    v_mfma_f32_16x16x32_bf16 a[188:191], a[24:27], a[64:67], a[188:191]
    ds_read_b64_tr_b16 a[116:117], v12 offset:24576
    s_add_u32 s76, s76, 8192
    v_mfma_f32_16x16x32_bf16 a[192:195], a[24:27], a[68:71], a[192:195]
    s_cmp_eq_u32 s76, s91
    s_cselect_b32 s76, s70, s76
    v_fmac_f32 v233, v235, v229
    v_fmac_f32 v232, v236, v226
    v_fmac_f32 v233, v237, v227
    v_fmac_f32 v232, v238, v224
    v_mfma_f32_16x16x32_bf16 v[140:143], a[28:31], a[68:71], v[140:143]
    ds_read_b64_tr_b16 a[118:119], v12 offset:25600
    s_add_u32 m0, s71, 0
    v_mfma_f32_16x16x32_bf16 v[136:139], a[28:31], a[64:67], v[136:139]
    ds_read_b64_tr_b16 a[120:121], v13 offset:24576
    buffer_load_dwordx4 v3, s[12:15], s72 offen lds
    v_mfma_f32_16x16x32_bf16 v[132:135], a[28:31], a[60:63], v[132:135]
    ds_read_b64_tr_b16 a[122:123], v13 offset:25600
    v_fmac_f32 v233, v239, v225
    v_mul_f32 v232, v232, v246
    v_mfma_f32_16x16x32_bf16 v[128:131], a[28:31], a[56:59], v[128:131]
    ds_read_b64_tr_b16 a[124:125], v14 offset:24576
    v_mul_f32 v233, v233, v247
    v_accvgpr_read_b32 v247, a244
    v_mfma_f32_16x16x32_bf16 v[144:147], a[32:35], a[56:59], v[144:147]
    ds_read_b64_tr_b16 a[126:127], v14 offset:25600
    v_mul_f32 v234, v234, v230
    v_mfma_f32_16x16x32_bf16 v[148:151], a[32:35], a[60:63], v[148:151]
    v_mul_f32 v235, v235, v231
    v_lshlrev_b32 v246, 16, v247
    v_mfma_f32_16x16x32_bf16 v[152:155], a[32:35], a[64:67], v[152:155]
    v_and_b32 v247, 0xffff0000, v247
    v_fmac_f32 v234, v236, v228
    v_mfma_f32_16x16x32_bf16 v[156:159], a[32:35], a[68:71], v[156:159]
    buffer_load_dwordx4 v3, s[12:15], s73 offen offset:1024 lds
    v_fmac_f32 v235, v237, v229
    v_fmac_f32 v234, v238, v226
    v_mfma_f32_16x16x32_bf16 v[172:175], a[36:39], a[68:71], v[172:175]
    v_fmac_f32 v235, v239, v227
    v_fmac_f32 v234, v240, v224
    v_mfma_f32_16x16x32_bf16 v[168:171], a[36:39], a[64:67], v[168:171]
    v_fmac_f32 v235, v241, v225
    v_mul_f32 v234, v234, v246
    v_mfma_f32_16x16x32_bf16 v[164:167], a[36:39], a[60:63], v[164:167]
    v_mul_f32 v235, v235, v247
    v_accvgpr_read_b32 v247, a248
    v_mfma_f32_16x16x32_bf16 v[160:163], a[36:39], a[56:59], v[160:163]
    v_mul_f32 v236, v236, v230
    v_mul_f32 v237, v237, v231
    v_mfma_f32_16x16x32_bf16 v[176:179], a[40:43], a[56:59], v[176:179]
    v_lshlrev_b32 v246, 16, v247
    v_and_b32 v247, 0xffff0000, v247
    v_mfma_f32_16x16x32_bf16 v[180:183], a[40:43], a[60:63], v[180:183]
    s_add_u32 m0, s71, 8192
    v_fmac_f32 v236, v238, v228
    v_fmac_f32 v237, v239, v229
    v_mfma_f32_16x16x32_bf16 v[184:187], a[40:43], a[64:67], v[184:187]
    buffer_load_dwordx4 v3, s[16:19], s72 offen lds
    v_fmac_f32 v236, v240, v226
    v_fmac_f32 v237, v241, v227
    v_mfma_f32_16x16x32_bf16 v[188:191], a[40:43], a[68:71], v[188:191]
    v_fmac_f32 v236, v242, v224
    v_fmac_f32 v237, v243, v225
    v_mfma_f32_16x16x32_bf16 v[204:207], a[44:47], a[68:71], v[204:207]
    v_mul_f32 v236, v236, v246
    v_mul_f32 v237, v237, v247
    v_mfma_f32_16x16x32_bf16 v[200:203], a[44:47], a[64:67], v[200:203]
    v_accvgpr_read_b32 v247, a252
    v_mul_f32 v238, v238, v230
    v_mfma_f32_16x16x32_bf16 v[196:199], a[44:47], a[60:63], v[196:199]
    v_mul_f32 v239, v239, v231
    v_lshlrev_b32 v246, 16, v247
    v_mfma_f32_16x16x32_bf16 v[192:195], a[44:47], a[56:59], v[192:195]
    v_and_b32 v247, 0xffff0000, v247
    v_fmac_f32 v238, v240, v228
    v_mfma_f32_16x16x32_bf16 v[208:211], a[48:51], a[56:59], v[208:211]
    buffer_load_dwordx4 v3, s[16:19], s73 offen offset:1024 lds
    v_fmac_f32 v239, v241, v229
    v_fmac_f32 v238, v242, v226
    v_mfma_f32_16x16x32_bf16 v[212:215], a[48:51], a[60:63], v[212:215]
    s_add_u32 s72, s72, 229376
    v_fmac_f32 v239, v243, v227
    v_fmac_f32 v238, v244, v224
    v_mfma_f32_16x16x32_bf16 v[216:219], a[48:51], a[64:67], v[216:219]
    s_cmp_eq_u32 s72, 7340032
    s_cselect_b32 s72, 0, s72
    v_fmac_f32 v239, v245, v225
    v_mfma_f32_16x16x32_bf16 v[220:223], a[48:51], a[68:71], v[220:223]
    s_add_u32 s73, s72, 27648
    v_mul_f32 v238, v238, v246
    v_mul_f32 v239, v239, v247
    v_mfma_f32_16x16x32_bf16 a[208:211], a[52:55], a[68:71], a[208:211]
    v_cvt_pk_bf16_f32 v248, v238, v236
    v_cvt_pk_bf16_f32 v249, v234, v232
    v_mfma_f32_16x16x32_bf16 a[204:207], a[52:55], a[64:67], a[204:207]
    v_cvt_pk_bf16_f32 v250, v239, v237
    v_cvt_pk_bf16_f32 v251, v235, v233
    v_mfma_f32_16x16x32_bf16 a[200:203], a[52:55], a[60:63], a[200:203]
    v_mfma_f32_16x16x32_bf16 a[196:199], a[52:55], a[56:59], a[196:199]
    s_waitcnt vmcnt(17) lgkmcnt(0)
    s_barrier
    v_mfma_f32_16x16x32_bf16 v[32:35], a[72:75], a[128:131], v[32:35]
    ds_read_b64_tr_b16 a[0:1], v8 offset:32768
    s_add_u32 s75, s75, 8192
    v_mfma_f32_16x16x32_bf16 v[36:39], a[72:75], a[132:135], v[36:39]
    s_cmp_eq_u32 s75, 24576
    s_cselect_b32 s75, 0, s75
    v_accvgpr_read_b32 v1, a156
    v_lshlrev_b32 v224, 16, v1
    v_and_b32 v226, 0xffff0000, v1
    v_accvgpr_read_b32 v1, a157
    v_mfma_f32_16x16x32_bf16 v[40:43], a[72:75], a[136:139], v[40:43]
    ds_read_b64_tr_b16 a[2:3], v8 offset:33792
    v_add_u32 v17, s75, v15
    v_mfma_f32_16x16x32_bf16 v[44:47], a[72:75], a[140:143], v[44:47]
    ds_read_b64_tr_b16 a[4:5], v9 offset:32768
    s_mov_b32 m0, s76
    v_mfma_f32_16x16x32_bf16 v[60:63], a[76:79], a[140:143], v[60:63]
    ds_read_b64_tr_b16 a[6:7], v9 offset:33792
    buffer_load_dwordx4 v4, s[8:11], s77 offen lds
    v_mfma_f32_16x16x32_bf16 v[56:59], a[76:79], a[136:139], v[56:59]
    ds_read_b128 a[56:59], v17 offset:0
    v_lshlrev_b32 v228, 16, v1
    v_mfma_f32_16x16x32_bf16 v[52:55], a[76:79], a[132:135], v[52:55]
    ds_read_b128 a[60:63], v17 offset:2048
    v_and_b32 v230, 0xffff0000, v1
    v_accvgpr_read_b32 v1, a158
    v_mfma_f32_16x16x32_bf16 v[48:51], a[76:79], a[128:131], v[48:51]
    ds_read_b128 a[64:67], v17 offset:4096
    v_lshlrev_b32 v225, 16, v1
    v_mfma_f32_16x16x32_bf16 v[64:67], a[80:83], a[128:131], v[64:67]
    ds_read_b128 a[68:71], v17 offset:6144
    v_and_b32 v227, 0xffff0000, v1
    v_accvgpr_read_b32 v1, a159
    v_lshlrev_b32 v229, 16, v1
    v_and_b32 v231, 0xffff0000, v1
    v_mfma_f32_16x16x32_bf16 v[68:71], a[80:83], a[132:135], v[68:71]
    ds_read_b64_tr_b16 a[8:9], v10 offset:32768
    buffer_load_dwordx4 v5, s[8:11], s77 offen offset:1024 lds
    v_mfma_f32_16x16x32_bf16 v[72:75], a[80:83], a[136:139], v[72:75]
    ds_read_b64_tr_b16 a[10:11], v10 offset:33792
    v_accvgpr_read_b32 v233, a213
    v_mfma_f32_16x16x32_bf16 v[76:79], a[80:83], a[140:143], v[76:79]
    ds_read_b64_tr_b16 a[12:13], v11 offset:32768
    v_lshlrev_b32 v232, 16, v233
    v_and_b32 v233, 0xffff0000, v233
    v_mfma_f32_16x16x32_bf16 v[92:95], a[84:87], a[140:143], v[92:95]
    ds_read_b64_tr_b16 a[14:15], v11 offset:33792
    v_accvgpr_read_b32 v235, a217
    v_mfma_f32_16x16x32_bf16 v[88:91], a[84:87], a[136:139], v[88:91]
    ds_read_b64_tr_b16 a[16:17], v12 offset:32768
    v_lshlrev_b32 v234, 16, v235
    v_and_b32 v235, 0xffff0000, v235
    v_accvgpr_read_b32 v237, a221
    v_lshlrev_b32 v236, 16, v237
    v_mfma_f32_16x16x32_bf16 v[84:87], a[84:87], a[132:135], v[84:87]
    ds_read_b64_tr_b16 a[18:19], v12 offset:33792
    buffer_load_dwordx4 v6, s[8:11], s77 offen offset:2048 lds
    v_mfma_f32_16x16x32_bf16 v[80:83], a[84:87], a[128:131], v[80:83]
    ds_read_b64_tr_b16 a[20:21], v13 offset:32768
    v_and_b32 v237, 0xffff0000, v237
    v_mfma_f32_16x16x32_bf16 v[96:99], a[88:91], a[128:131], v[96:99]
    ds_read_b64_tr_b16 a[22:23], v13 offset:33792
    v_accvgpr_read_b32 v239, a225
    v_lshlrev_b32 v238, 16, v239
    v_mfma_f32_16x16x32_bf16 v[100:103], a[88:91], a[132:135], v[100:103]
    ds_read_b64_tr_b16 a[24:25], v14 offset:32768
    v_and_b32 v239, 0xffff0000, v239
    v_mfma_f32_16x16x32_bf16 v[104:107], a[88:91], a[136:139], v[104:107]
    ds_read_b64_tr_b16 a[26:27], v14 offset:33792
    v_accvgpr_read_b32 v241, a229
    v_lshlrev_b32 v240, 16, v241
    v_and_b32 v241, 0xffff0000, v241
    v_accvgpr_read_b32 v243, a233
    v_mfma_f32_16x16x32_bf16 v[108:111], a[88:91], a[140:143], v[108:111]
    ds_read_b64_tr_b16 a[28:29], v8 offset:40960
    buffer_load_dwordx4 v7, s[8:11], s77 offen offset:3072 lds
    v_mfma_f32_16x16x32_bf16 v[124:127], a[92:95], a[140:143], v[124:127]
    ds_read_b64_tr_b16 a[30:31], v8 offset:41984
    v_lshlrev_b32 v242, 16, v243
    v_mfma_f32_16x16x32_bf16 v[120:123], a[92:95], a[136:139], v[120:123]
    ds_read_b64_tr_b16 a[32:33], v9 offset:40960
    v_and_b32 v243, 0xffff0000, v243
    v_accvgpr_read_b32 v245, a237
    v_mfma_f32_16x16x32_bf16 v[116:119], a[92:95], a[132:135], v[116:119]
    ds_read_b64_tr_b16 a[34:35], v9 offset:41984
    v_lshlrev_b32 v244, 16, v245
    v_and_b32 v245, 0xffff0000, v245
    v_accvgpr_read_b32 v247, a241
    v_mul_f32 v232, v232, v230
    v_mfma_f32_16x16x32_bf16 v[112:115], a[92:95], a[128:131], v[112:115]
    ds_read_b64_tr_b16 a[36:37], v10 offset:40960
    s_add_u32 m0, s71, 16384
    v_mfma_f32_16x16x32_bf16 a[180:183], a[96:99], a[128:131], a[180:183]
    ds_read_b64_tr_b16 a[38:39], v10 offset:41984
    buffer_load_dwordx4 v3, s[12:15], s72 offen lds
    v_mfma_f32_16x16x32_bf16 a[184:187], a[96:99], a[132:135], a[184:187]
    ds_read_b64_tr_b16 a[40:41], v11 offset:40960
    v_mul_f32 v233, v233, v231
    v_lshlrev_b32 v246, 16, v247
    v_mfma_f32_16x16x32_bf16 a[188:191], a[96:99], a[136:139], a[188:191]
    ds_read_b64_tr_b16 a[42:43], v11 offset:41984
    v_and_b32 v247, 0xffff0000, v247
    v_fmac_f32 v232, v234, v228
    v_mfma_f32_16x16x32_bf16 a[192:195], a[96:99], a[140:143], a[192:195]
    ds_read_b64_tr_b16 a[44:45], v12 offset:40960
    v_fmac_f32 v233, v235, v229
    v_mfma_f32_16x16x32_bf16 v[140:143], a[100:103], a[140:143], v[140:143]
    ds_read_b64_tr_b16 a[46:47], v12 offset:41984
    v_fmac_f32 v232, v236, v226
    v_fmac_f32 v233, v237, v227
    v_fmac_f32 v232, v238, v224
    v_mfma_f32_16x16x32_bf16 v[136:139], a[100:103], a[136:139], v[136:139]
    ds_read_b64_tr_b16 a[48:49], v13 offset:40960
    buffer_load_dwordx4 v3, s[12:15], s73 offen offset:1024 lds
    v_mfma_f32_16x16x32_bf16 v[132:135], a[100:103], a[132:135], v[132:135]
    ds_read_b64_tr_b16 a[50:51], v13 offset:41984
    v_fmac_f32 v233, v239, v225
    v_mul_f32 v232, v232, v246
    v_mfma_f32_16x16x32_bf16 v[128:131], a[100:103], a[128:131], v[128:131]
    ds_read_b64_tr_b16 a[52:53], v14 offset:40960
    v_mul_f32 v233, v233, v247
    v_accvgpr_read_b32 v247, a245
    v_mfma_f32_16x16x32_bf16 v[144:147], a[104:107], a[128:131], v[144:147]
    ds_read_b64_tr_b16 a[54:55], v14 offset:41984
    v_mul_f32 v234, v234, v230
    v_mfma_f32_16x16x32_bf16 v[148:151], a[104:107], a[132:135], v[148:151]
    s_add_u32 m0, s71, 24576
    v_mul_f32 v235, v235, v231
    v_lshlrev_b32 v246, 16, v247
    v_mfma_f32_16x16x32_bf16 v[152:155], a[104:107], a[136:139], v[152:155]
    buffer_load_dwordx4 v3, s[16:19], s72 offen lds
    v_and_b32 v247, 0xffff0000, v247
    v_fmac_f32 v234, v236, v228
    v_mfma_f32_16x16x32_bf16 v[156:159], a[104:107], a[140:143], v[156:159]
    v_fmac_f32 v235, v237, v229
    v_fmac_f32 v234, v238, v226
    v_mfma_f32_16x16x32_bf16 v[172:175], a[108:111], a[140:143], v[172:175]
    v_fmac_f32 v235, v239, v227
    v_fmac_f32 v234, v240, v224
    v_mfma_f32_16x16x32_bf16 v[168:171], a[108:111], a[136:139], v[168:171]
    v_fmac_f32 v235, v241, v225
    v_mul_f32 v234, v234, v246
    v_mfma_f32_16x16x32_bf16 v[164:167], a[108:111], a[132:135], v[164:167]
    v_mul_f32 v235, v235, v247
    v_accvgpr_read_b32 v247, a249
    v_mfma_f32_16x16x32_bf16 v[160:163], a[108:111], a[128:131], v[160:163]
    buffer_load_dwordx4 v3, s[16:19], s73 offen offset:1024 lds
    v_mul_f32 v236, v236, v230
    v_mul_f32 v237, v237, v231
    v_mfma_f32_16x16x32_bf16 v[176:179], a[112:115], a[128:131], v[176:179]
    s_add_u32 s72, s72, 229376
    v_lshlrev_b32 v246, 16, v247
    v_and_b32 v247, 0xffff0000, v247
    v_mfma_f32_16x16x32_bf16 v[180:183], a[112:115], a[132:135], v[180:183]
    s_cmp_eq_u32 s72, 7340032
    s_cselect_b32 s72, 0, s72
    v_fmac_f32 v236, v238, v228
    v_mfma_f32_16x16x32_bf16 v[184:187], a[112:115], a[136:139], v[184:187]
    s_add_u32 s73, s72, 27648
    v_fmac_f32 v237, v239, v229
    v_fmac_f32 v236, v240, v226
    v_mfma_f32_16x16x32_bf16 v[188:191], a[112:115], a[140:143], v[188:191]
    s_mov_b32 s3, 0
    v_fmac_f32 v237, v241, v227
    v_fmac_f32 v236, v242, v224
    v_mfma_f32_16x16x32_bf16 v[204:207], a[116:119], a[140:143], v[204:207]
    buffer_store_dwordx2 v[248:249], v22, s[24:27], s3 offen sc1
    v_fmac_f32 v237, v243, v225
    v_mul_f32 v236, v236, v246
    v_mfma_f32_16x16x32_bf16 v[200:203], a[116:119], a[136:139], v[200:203]
    v_mul_f32 v237, v237, v247
    v_accvgpr_read_b32 v247, a253
    v_mfma_f32_16x16x32_bf16 v[196:199], a[116:119], a[132:135], v[196:199]
    v_mul_f32 v238, v238, v230
    v_mul_f32 v239, v239, v231
    v_mfma_f32_16x16x32_bf16 v[192:195], a[116:119], a[128:131], v[192:195]
    v_lshlrev_b32 v246, 16, v247
    v_and_b32 v247, 0xffff0000, v247
    v_mfma_f32_16x16x32_bf16 v[208:211], a[120:123], a[128:131], v[208:211]
    s_mov_b32 s3, 4224
    v_fmac_f32 v238, v240, v228
    v_fmac_f32 v239, v241, v229
    v_mfma_f32_16x16x32_bf16 v[212:215], a[120:123], a[132:135], v[212:215]
    buffer_store_dwordx2 v[250:251], v22, s[24:27], s3 offen sc1
    v_fmac_f32 v238, v242, v226
    v_fmac_f32 v239, v243, v227
    v_mfma_f32_16x16x32_bf16 v[216:219], a[120:123], a[136:139], v[216:219]
    v_fmac_f32 v238, v244, v224
    v_fmac_f32 v239, v245, v225
    v_mfma_f32_16x16x32_bf16 v[220:223], a[120:123], a[140:143], v[220:223]
    v_mul_f32 v238, v238, v246
    v_mul_f32 v239, v239, v247
    v_mfma_f32_16x16x32_bf16 a[208:211], a[124:127], a[140:143], a[208:211]
    v_cvt_pk_bf16_f32 v252, v238, v236
    v_cvt_pk_bf16_f32 v253, v234, v232
    v_mfma_f32_16x16x32_bf16 a[204:207], a[124:127], a[136:139], a[204:207]
    v_cvt_pk_bf16_f32 v254, v239, v237
    v_cvt_pk_bf16_f32 v255, v235, v233
    v_mfma_f32_16x16x32_bf16 a[200:203], a[124:127], a[132:135], a[200:203]
    v_mfma_f32_16x16x32_bf16 a[196:199], a[124:127], a[128:131], a[196:199]
    s_waitcnt vmcnt(19) lgkmcnt(0)
    s_barrier
    v_mfma_f32_16x16x32_bf16 v[32:35], a[0:3], a[56:59], v[32:35]
    ds_read_b64_tr_b16 a[72:73], v8 offset:49152
    v_add_u32 v17, s75, v16
    v_mfma_f32_16x16x32_bf16 v[36:39], a[0:3], a[60:63], v[36:39]
    ds_read_b64_tr_b16 a[74:75], v8 offset:50176
    v_accvgpr_read_b32 v1, a168
    v_lshlrev_b32 v224, 16, v1
    v_and_b32 v226, 0xffff0000, v1
    v_accvgpr_read_b32 v1, a169
    v_mfma_f32_16x16x32_bf16 v[40:43], a[0:3], a[64:67], v[40:43]
    ds_read_b64_tr_b16 a[76:77], v9 offset:49152
    s_add_u32 m0, s76, 4096
    v_mfma_f32_16x16x32_bf16 v[44:47], a[0:3], a[68:71], v[44:47]
    ds_read_b64_tr_b16 a[78:79], v9 offset:50176
    s_add_u32 s79, s77, 0x10000
    v_mfma_f32_16x16x32_bf16 v[60:63], a[4:7], a[68:71], v[60:63]
    ds_read_b128 a[128:131], v17 offset:0
    buffer_load_dwordx4 v4, s[8:11], s79 offen lds
    v_mfma_f32_16x16x32_bf16 v[56:59], a[4:7], a[64:67], v[56:59]
    ds_read_b128 a[132:135], v17 offset:2048
    v_lshlrev_b32 v228, 16, v1
    v_mfma_f32_16x16x32_bf16 v[52:55], a[4:7], a[60:63], v[52:55]
    ds_read_b128 a[136:139], v17 offset:4096
    v_and_b32 v230, 0xffff0000, v1
    v_accvgpr_read_b32 v1, a170
    v_mfma_f32_16x16x32_bf16 v[48:51], a[4:7], a[56:59], v[48:51]
    ds_read_b128 a[140:143], v17 offset:6144
    v_lshlrev_b32 v225, 16, v1
    v_mfma_f32_16x16x32_bf16 v[64:67], a[8:11], a[56:59], v[64:67]
    ds_read_b64_tr_b16 a[80:81], v10 offset:49152
    v_and_b32 v227, 0xffff0000, v1
    v_accvgpr_read_b32 v1, a171
    v_lshlrev_b32 v229, 16, v1
    v_and_b32 v231, 0xffff0000, v1
    v_mfma_f32_16x16x32_bf16 v[68:71], a[8:11], a[60:63], v[68:71]
    ds_read_b64_tr_b16 a[82:83], v10 offset:50176
    buffer_load_dwordx4 v5, s[8:11], s79 offen offset:1024 lds
    v_mfma_f32_16x16x32_bf16 v[72:75], a[8:11], a[64:67], v[72:75]
    ds_read_b64_tr_b16 a[84:85], v11 offset:49152
    v_accvgpr_read_b32 v233, a214
    v_mfma_f32_16x16x32_bf16 v[76:79], a[8:11], a[68:71], v[76:79]
    ds_read_b64_tr_b16 a[86:87], v11 offset:50176
    v_lshlrev_b32 v232, 16, v233
    v_and_b32 v233, 0xffff0000, v233
    v_mfma_f32_16x16x32_bf16 v[92:95], a[12:15], a[68:71], v[92:95]
    ds_read_b64_tr_b16 a[88:89], v12 offset:49152
    v_accvgpr_read_b32 v235, a218
    v_mfma_f32_16x16x32_bf16 v[88:91], a[12:15], a[64:67], v[88:91]
    ds_read_b64_tr_b16 a[90:91], v12 offset:50176
    v_lshlrev_b32 v234, 16, v235
    v_and_b32 v235, 0xffff0000, v235
    v_accvgpr_read_b32 v237, a222
    v_lshlrev_b32 v236, 16, v237
    v_mfma_f32_16x16x32_bf16 v[84:87], a[12:15], a[60:63], v[84:87]
    ds_read_b64_tr_b16 a[92:93], v13 offset:49152
    buffer_load_dwordx4 v6, s[8:11], s79 offen offset:2048 lds
    v_mfma_f32_16x16x32_bf16 v[80:83], a[12:15], a[56:59], v[80:83]
    ds_read_b64_tr_b16 a[94:95], v13 offset:50176
    v_and_b32 v237, 0xffff0000, v237
    v_mfma_f32_16x16x32_bf16 v[96:99], a[16:19], a[56:59], v[96:99]
    ds_read_b64_tr_b16 a[96:97], v14 offset:49152
    v_accvgpr_read_b32 v239, a226
    v_lshlrev_b32 v238, 16, v239
    v_mfma_f32_16x16x32_bf16 v[100:103], a[16:19], a[60:63], v[100:103]
    ds_read_b64_tr_b16 a[98:99], v14 offset:50176
    v_and_b32 v239, 0xffff0000, v239
    v_mfma_f32_16x16x32_bf16 v[104:107], a[16:19], a[64:67], v[104:107]
    ds_read_b64_tr_b16 a[100:101], v8 offset:57344
    v_accvgpr_read_b32 v241, a230
    v_lshlrev_b32 v240, 16, v241
    v_and_b32 v241, 0xffff0000, v241
    v_accvgpr_read_b32 v243, a234
    v_lshlrev_b32 v242, 16, v243
    v_and_b32 v243, 0xffff0000, v243
    v_accvgpr_read_b32 v245, a238
    v_lshlrev_b32 v244, 16, v245
    v_mfma_f32_16x16x32_bf16 v[108:111], a[16:19], a[68:71], v[108:111]
    ds_read_b64_tr_b16 a[102:103], v8 offset:58368
    buffer_load_dwordx4 v7, s[8:11], s79 offen offset:3072 lds
    v_mfma_f32_16x16x32_bf16 v[124:127], a[20:23], a[68:71], v[124:127]
    ds_read_b64_tr_b16 a[104:105], v9 offset:57344
    s_add_u32 s77, s77, 128
    v_mfma_f32_16x16x32_bf16 v[120:123], a[20:23], a[64:67], v[120:123]
    ds_read_b64_tr_b16 a[106:107], v9 offset:58368
    s_and_b32 s77, s77, 0x7ff
    v_mfma_f32_16x16x32_bf16 v[116:119], a[20:23], a[60:63], v[116:119]
    ds_read_b64_tr_b16 a[108:109], v10 offset:57344
    s_add_u32 s76, s76, 8192
    v_mfma_f32_16x16x32_bf16 v[112:115], a[20:23], a[56:59], v[112:115]
    s_cmp_eq_u32 s76, s91
    s_cselect_b32 s76, s70, s76
    v_and_b32 v245, 0xffff0000, v245
    v_accvgpr_read_b32 v247, a242
    v_mul_f32 v232, v232, v230
    v_mul_f32 v233, v233, v231
    v_lshlrev_b32 v246, 16, v247
    v_mfma_f32_16x16x32_bf16 a[180:183], a[24:27], a[56:59], a[180:183]
    ds_read_b64_tr_b16 a[110:111], v10 offset:58368
    s_add_u32 m0, s71, 32768
    v_mfma_f32_16x16x32_bf16 a[184:187], a[24:27], a[60:63], a[184:187]
    ds_read_b64_tr_b16 a[112:113], v11 offset:57344
    buffer_load_dwordx4 v3, s[12:15], s72 offen lds
    v_mfma_f32_16x16x32_bf16 a[188:191], a[24:27], a[64:67], a[188:191]
    ds_read_b64_tr_b16 a[114:115], v11 offset:58368
    v_and_b32 v247, 0xffff0000, v247
    v_fmac_f32 v232, v234, v228
    v_mfma_f32_16x16x32_bf16 a[192:195], a[24:27], a[68:71], a[192:195]
    ds_read_b64_tr_b16 a[116:117], v12 offset:57344
    v_fmac_f32 v233, v235, v229
    v_mfma_f32_16x16x32_bf16 v[140:143], a[28:31], a[68:71], v[140:143]
    ds_read_b64_tr_b16 a[118:119], v12 offset:58368
    v_fmac_f32 v232, v236, v226
    v_fmac_f32 v233, v237, v227
    v_fmac_f32 v232, v238, v224
    v_mfma_f32_16x16x32_bf16 v[136:139], a[28:31], a[64:67], v[136:139]
    ds_read_b64_tr_b16 a[120:121], v13 offset:57344
    buffer_load_dwordx4 v3, s[12:15], s73 offen offset:1024 lds
    v_mfma_f32_16x16x32_bf16 v[132:135], a[28:31], a[60:63], v[132:135]
    ds_read_b64_tr_b16 a[122:123], v13 offset:58368
    v_fmac_f32 v233, v239, v225
    v_mul_f32 v232, v232, v246
    v_mfma_f32_16x16x32_bf16 v[128:131], a[28:31], a[56:59], v[128:131]
    ds_read_b64_tr_b16 a[124:125], v14 offset:57344
    v_mul_f32 v233, v233, v247
    v_accvgpr_read_b32 v247, a246
    v_mfma_f32_16x16x32_bf16 v[144:147], a[32:35], a[56:59], v[144:147]
    ds_read_b64_tr_b16 a[126:127], v14 offset:58368
    v_mul_f32 v234, v234, v230
    v_mfma_f32_16x16x32_bf16 v[148:151], a[32:35], a[60:63], v[148:151]
    s_add_u32 m0, s71, 40960
    v_mul_f32 v235, v235, v231
    v_lshlrev_b32 v246, 16, v247
    v_mfma_f32_16x16x32_bf16 v[152:155], a[32:35], a[64:67], v[152:155]
    buffer_load_dwordx4 v3, s[16:19], s72 offen lds
    v_and_b32 v247, 0xffff0000, v247
    v_fmac_f32 v234, v236, v228
    v_mfma_f32_16x16x32_bf16 v[156:159], a[32:35], a[68:71], v[156:159]
    v_fmac_f32 v235, v237, v229
    v_fmac_f32 v234, v238, v226
    v_mfma_f32_16x16x32_bf16 v[172:175], a[36:39], a[68:71], v[172:175]
    v_fmac_f32 v235, v239, v227
    v_fmac_f32 v234, v240, v224
    v_mfma_f32_16x16x32_bf16 v[168:171], a[36:39], a[64:67], v[168:171]
    v_fmac_f32 v235, v241, v225
    v_mul_f32 v234, v234, v246
    v_mfma_f32_16x16x32_bf16 v[164:167], a[36:39], a[60:63], v[164:167]
    v_mul_f32 v235, v235, v247
    v_accvgpr_read_b32 v247, a250
    v_mfma_f32_16x16x32_bf16 v[160:163], a[36:39], a[56:59], v[160:163]
    buffer_load_dwordx4 v3, s[16:19], s73 offen offset:1024 lds
    v_mul_f32 v236, v236, v230
    v_mul_f32 v237, v237, v231
    v_mfma_f32_16x16x32_bf16 v[176:179], a[40:43], a[56:59], v[176:179]
    s_add_u32 s72, s72, 229376
    v_lshlrev_b32 v246, 16, v247
    v_and_b32 v247, 0xffff0000, v247
    v_mfma_f32_16x16x32_bf16 v[180:183], a[40:43], a[60:63], v[180:183]
    s_cmp_eq_u32 s72, 7340032
    s_cselect_b32 s72, 0, s72
    v_fmac_f32 v236, v238, v228
    v_mfma_f32_16x16x32_bf16 v[184:187], a[40:43], a[64:67], v[184:187]
    s_add_u32 s73, s72, 27648
    v_fmac_f32 v237, v239, v229
    v_fmac_f32 v236, v240, v226
    v_mfma_f32_16x16x32_bf16 v[188:191], a[40:43], a[68:71], v[188:191]
    s_mov_b32 s3, 8448
    v_fmac_f32 v237, v241, v227
    v_fmac_f32 v236, v242, v224
    v_mfma_f32_16x16x32_bf16 v[204:207], a[44:47], a[68:71], v[204:207]
    buffer_store_dwordx2 v[252:253], v22, s[24:27], s3 offen sc1
    v_fmac_f32 v237, v243, v225
    v_mul_f32 v236, v236, v246
    v_mfma_f32_16x16x32_bf16 v[200:203], a[44:47], a[64:67], v[200:203]
    v_mul_f32 v237, v237, v247
    v_accvgpr_read_b32 v247, a254
    v_mfma_f32_16x16x32_bf16 v[196:199], a[44:47], a[60:63], v[196:199]
    v_mul_f32 v238, v238, v230
    v_mul_f32 v239, v239, v231
    v_mfma_f32_16x16x32_bf16 v[192:195], a[44:47], a[56:59], v[192:195]
    v_lshlrev_b32 v246, 16, v247
    v_and_b32 v247, 0xffff0000, v247
    v_mfma_f32_16x16x32_bf16 v[208:211], a[48:51], a[56:59], v[208:211]
    s_mov_b32 s3, 12672
    v_fmac_f32 v238, v240, v228
    v_fmac_f32 v239, v241, v229
    v_mfma_f32_16x16x32_bf16 v[212:215], a[48:51], a[60:63], v[212:215]
    buffer_store_dwordx2 v[254:255], v22, s[24:27], s3 offen sc1
    v_fmac_f32 v238, v242, v226
    v_fmac_f32 v239, v243, v227
    v_mfma_f32_16x16x32_bf16 v[216:219], a[48:51], a[64:67], v[216:219]
    v_fmac_f32 v238, v244, v224
    v_fmac_f32 v239, v245, v225
    v_mfma_f32_16x16x32_bf16 v[220:223], a[48:51], a[68:71], v[220:223]
    v_mul_f32 v238, v238, v246
    v_mul_f32 v239, v239, v247
    v_mfma_f32_16x16x32_bf16 a[208:211], a[52:55], a[68:71], a[208:211]
    v_cvt_pk_bf16_f32 v24, v238, v236
    v_cvt_pk_bf16_f32 v25, v234, v232
    v_mfma_f32_16x16x32_bf16 a[204:207], a[52:55], a[64:67], a[204:207]
    v_cvt_pk_bf16_f32 v26, v239, v237
    v_cvt_pk_bf16_f32 v27, v235, v233
    v_mfma_f32_16x16x32_bf16 a[200:203], a[52:55], a[60:63], a[200:203]
    v_mfma_f32_16x16x32_bf16 a[196:199], a[52:55], a[56:59], a[196:199]
    s_waitcnt vmcnt(20) lgkmcnt(0)
    s_barrier
    v_mfma_f32_16x16x32_bf16 v[32:35], a[72:75], a[128:131], v[32:35]
    ds_read_b64_tr_b16 a[0:1], v8 offset:0
    s_add_u32 s75, s75, 8192
    v_mfma_f32_16x16x32_bf16 v[36:39], a[72:75], a[132:135], v[36:39]
    s_cmp_eq_u32 s75, 24576
    s_cselect_b32 s75, 0, s75
    v_accvgpr_read_b32 v1, a172
    v_lshlrev_b32 v224, 16, v1
    v_and_b32 v226, 0xffff0000, v1
    v_accvgpr_read_b32 v1, a173
    v_mfma_f32_16x16x32_bf16 v[40:43], a[72:75], a[136:139], v[40:43]
    ds_read_b64_tr_b16 a[2:3], v8 offset:1024
    v_add_u32 v17, s75, v15
    v_mfma_f32_16x16x32_bf16 v[44:47], a[72:75], a[140:143], v[44:47]
    ds_read_b64_tr_b16 a[4:5], v9 offset:0
    s_mov_b32 m0, s76
    v_mfma_f32_16x16x32_bf16 v[60:63], a[76:79], a[140:143], v[60:63]
    ds_read_b64_tr_b16 a[6:7], v9 offset:1024
    buffer_load_dwordx4 v4, s[8:11], s77 offen lds
    v_mfma_f32_16x16x32_bf16 v[56:59], a[76:79], a[136:139], v[56:59]
    ds_read_b128 a[56:59], v17 offset:0
    v_lshlrev_b32 v228, 16, v1
    v_mfma_f32_16x16x32_bf16 v[52:55], a[76:79], a[132:135], v[52:55]
    ds_read_b128 a[60:63], v17 offset:2048
    v_and_b32 v230, 0xffff0000, v1
    v_accvgpr_read_b32 v1, a174
    v_mfma_f32_16x16x32_bf16 v[48:51], a[76:79], a[128:131], v[48:51]
    ds_read_b128 a[64:67], v17 offset:4096
    v_lshlrev_b32 v225, 16, v1
    v_mfma_f32_16x16x32_bf16 v[64:67], a[80:83], a[128:131], v[64:67]
    ds_read_b128 a[68:71], v17 offset:6144
    v_and_b32 v227, 0xffff0000, v1
    v_accvgpr_read_b32 v1, a175
    v_lshlrev_b32 v229, 16, v1
    v_and_b32 v231, 0xffff0000, v1
    v_mfma_f32_16x16x32_bf16 v[68:71], a[80:83], a[132:135], v[68:71]
    ds_read_b64_tr_b16 a[8:9], v10 offset:0
    buffer_load_dwordx4 v5, s[8:11], s77 offen offset:1024 lds
    v_mfma_f32_16x16x32_bf16 v[72:75], a[80:83], a[136:139], v[72:75]
    ds_read_b64_tr_b16 a[10:11], v10 offset:1024
    v_accvgpr_read_b32 v233, a215
    v_mfma_f32_16x16x32_bf16 v[76:79], a[80:83], a[140:143], v[76:79]
    ds_read_b64_tr_b16 a[12:13], v11 offset:0
    v_lshlrev_b32 v232, 16, v233
    v_and_b32 v233, 0xffff0000, v233
    v_mfma_f32_16x16x32_bf16 v[92:95], a[84:87], a[140:143], v[92:95]
    ds_read_b64_tr_b16 a[14:15], v11 offset:1024
    v_accvgpr_read_b32 v235, a219
    v_mfma_f32_16x16x32_bf16 v[88:91], a[84:87], a[136:139], v[88:91]
    ds_read_b64_tr_b16 a[16:17], v12 offset:0
    v_lshlrev_b32 v234, 16, v235
    v_and_b32 v235, 0xffff0000, v235
    v_accvgpr_read_b32 v237, a223
    v_lshlrev_b32 v236, 16, v237
    v_mfma_f32_16x16x32_bf16 v[84:87], a[84:87], a[132:135], v[84:87]
    ds_read_b64_tr_b16 a[18:19], v12 offset:1024
    buffer_load_dwordx4 v6, s[8:11], s77 offen offset:2048 lds
    v_mfma_f32_16x16x32_bf16 v[80:83], a[84:87], a[128:131], v[80:83]
    ds_read_b64_tr_b16 a[20:21], v13 offset:0
    v_and_b32 v237, 0xffff0000, v237
    v_mfma_f32_16x16x32_bf16 v[96:99], a[88:91], a[128:131], v[96:99]
    ds_read_b64_tr_b16 a[22:23], v13 offset:1024
    v_accvgpr_read_b32 v239, a227
    v_lshlrev_b32 v238, 16, v239
    v_mfma_f32_16x16x32_bf16 v[100:103], a[88:91], a[132:135], v[100:103]
    ds_read_b64_tr_b16 a[24:25], v14 offset:0
    v_and_b32 v239, 0xffff0000, v239
    v_mfma_f32_16x16x32_bf16 v[104:107], a[88:91], a[136:139], v[104:107]
    ds_read_b64_tr_b16 a[26:27], v14 offset:1024
    v_accvgpr_read_b32 v241, a231
    v_lshlrev_b32 v240, 16, v241
    v_and_b32 v241, 0xffff0000, v241
    v_accvgpr_read_b32 v243, a235
    v_mfma_f32_16x16x32_bf16 v[108:111], a[88:91], a[140:143], v[108:111]
    ds_read_b64_tr_b16 a[28:29], v8 offset:8192
    buffer_load_dwordx4 v7, s[8:11], s77 offen offset:3072 lds
    v_mfma_f32_16x16x32_bf16 v[124:127], a[92:95], a[140:143], v[124:127]
    ds_read_b64_tr_b16 a[30:31], v8 offset:9216
    v_lshlrev_b32 v242, 16, v243
    v_mfma_f32_16x16x32_bf16 v[120:123], a[92:95], a[136:139], v[120:123]
    ds_read_b64_tr_b16 a[32:33], v9 offset:8192
    v_and_b32 v243, 0xffff0000, v243
    v_accvgpr_read_b32 v245, a239
    v_mfma_f32_16x16x32_bf16 v[116:119], a[92:95], a[132:135], v[116:119]
    ds_read_b64_tr_b16 a[34:35], v9 offset:9216
    v_lshlrev_b32 v244, 16, v245
    v_and_b32 v245, 0xffff0000, v245
    v_accvgpr_read_b32 v247, a243
    v_mul_f32 v232, v232, v230
    v_mfma_f32_16x16x32_bf16 v[112:115], a[92:95], a[128:131], v[112:115]
    ds_read_b64_tr_b16 a[36:37], v10 offset:8192
    s_add_u32 m0, s71, 49152
    v_mfma_f32_16x16x32_bf16 a[180:183], a[96:99], a[128:131], a[180:183]
    ds_read_b64_tr_b16 a[38:39], v10 offset:9216
    buffer_load_dwordx4 v3, s[12:15], s72 offen lds
    v_mfma_f32_16x16x32_bf16 a[184:187], a[96:99], a[132:135], a[184:187]
    ds_read_b64_tr_b16 a[40:41], v11 offset:8192
    v_mul_f32 v233, v233, v231
    v_lshlrev_b32 v246, 16, v247
    v_mfma_f32_16x16x32_bf16 a[188:191], a[96:99], a[136:139], a[188:191]
    ds_read_b64_tr_b16 a[42:43], v11 offset:9216
    v_and_b32 v247, 0xffff0000, v247
    v_fmac_f32 v232, v234, v228
    v_mfma_f32_16x16x32_bf16 a[192:195], a[96:99], a[140:143], a[192:195]
    ds_read_b64_tr_b16 a[44:45], v12 offset:8192
    v_fmac_f32 v233, v235, v229
    v_mfma_f32_16x16x32_bf16 v[140:143], a[100:103], a[140:143], v[140:143]
    ds_read_b64_tr_b16 a[46:47], v12 offset:9216
    v_fmac_f32 v232, v236, v226
    v_fmac_f32 v233, v237, v227
    v_fmac_f32 v232, v238, v224
    v_mfma_f32_16x16x32_bf16 v[136:139], a[100:103], a[136:139], v[136:139]
    ds_read_b64_tr_b16 a[48:49], v13 offset:8192
    buffer_load_dwordx4 v3, s[12:15], s73 offen offset:1024 lds
    v_mfma_f32_16x16x32_bf16 v[132:135], a[100:103], a[132:135], v[132:135]
    ds_read_b64_tr_b16 a[50:51], v13 offset:9216
    v_fmac_f32 v233, v239, v225
    v_mul_f32 v232, v232, v246
    v_mfma_f32_16x16x32_bf16 v[128:131], a[100:103], a[128:131], v[128:131]
    ds_read_b64_tr_b16 a[52:53], v14 offset:8192
    v_mul_f32 v233, v233, v247
    v_accvgpr_read_b32 v247, a247
    v_mfma_f32_16x16x32_bf16 v[144:147], a[104:107], a[128:131], v[144:147]
    ds_read_b64_tr_b16 a[54:55], v14 offset:9216
    v_mul_f32 v234, v234, v230
    v_mfma_f32_16x16x32_bf16 v[148:151], a[104:107], a[132:135], v[148:151]
    s_add_u32 m0, s71, 57344
    v_mul_f32 v235, v235, v231
    v_lshlrev_b32 v246, 16, v247
    v_mfma_f32_16x16x32_bf16 v[152:155], a[104:107], a[136:139], v[152:155]
    buffer_load_dwordx4 v3, s[16:19], s72 offen lds
    v_and_b32 v247, 0xffff0000, v247
    v_fmac_f32 v234, v236, v228
    v_mfma_f32_16x16x32_bf16 v[156:159], a[104:107], a[140:143], v[156:159]
    v_fmac_f32 v235, v237, v229
    v_fmac_f32 v234, v238, v226
    v_mfma_f32_16x16x32_bf16 v[172:175], a[108:111], a[140:143], v[172:175]
    v_fmac_f32 v235, v239, v227
    v_fmac_f32 v234, v240, v224
    v_mfma_f32_16x16x32_bf16 v[168:171], a[108:111], a[136:139], v[168:171]
    v_fmac_f32 v235, v241, v225
    v_mul_f32 v234, v234, v246
    v_mfma_f32_16x16x32_bf16 v[164:167], a[108:111], a[132:135], v[164:167]
    v_mul_f32 v235, v235, v247
    v_accvgpr_read_b32 v247, a251
    v_mfma_f32_16x16x32_bf16 v[160:163], a[108:111], a[128:131], v[160:163]
    buffer_load_dwordx4 v3, s[16:19], s73 offen offset:1024 lds
    v_mul_f32 v236, v236, v230
    v_mul_f32 v237, v237, v231
    v_mfma_f32_16x16x32_bf16 v[176:179], a[112:115], a[128:131], v[176:179]
    s_add_u32 s72, s72, 229376
    v_lshlrev_b32 v246, 16, v247
    v_and_b32 v247, 0xffff0000, v247
    v_mfma_f32_16x16x32_bf16 v[180:183], a[112:115], a[132:135], v[180:183]
    s_cmp_eq_u32 s72, 7340032
    s_cselect_b32 s72, 0, s72
    v_fmac_f32 v236, v238, v228
    v_mfma_f32_16x16x32_bf16 v[184:187], a[112:115], a[136:139], v[184:187]
    s_add_u32 s73, s72, 27648
    v_fmac_f32 v237, v239, v229
    v_fmac_f32 v236, v240, v226
    v_mfma_f32_16x16x32_bf16 v[188:191], a[112:115], a[140:143], v[188:191]
    s_mov_b32 s3, 16896
    v_fmac_f32 v237, v241, v227
    v_fmac_f32 v236, v242, v224
    v_mfma_f32_16x16x32_bf16 v[204:207], a[116:119], a[140:143], v[204:207]
    buffer_store_dwordx2 v[24:25], v22, s[24:27], s3 offen sc1
    v_fmac_f32 v237, v243, v225
    v_mul_f32 v236, v236, v246
    v_mfma_f32_16x16x32_bf16 v[200:203], a[116:119], a[136:139], v[200:203]
    v_mul_f32 v237, v237, v247
    v_accvgpr_read_b32 v247, a255
    v_mfma_f32_16x16x32_bf16 v[196:199], a[116:119], a[132:135], v[196:199]
    v_mul_f32 v238, v238, v230
    v_mul_f32 v239, v239, v231
    v_mfma_f32_16x16x32_bf16 v[192:195], a[116:119], a[128:131], v[192:195]
    v_lshlrev_b32 v246, 16, v247
    v_and_b32 v247, 0xffff0000, v247
    v_mfma_f32_16x16x32_bf16 v[208:211], a[120:123], a[128:131], v[208:211]
    s_mov_b32 s3, 21120
    v_fmac_f32 v238, v240, v228
    v_fmac_f32 v239, v241, v229
    v_mfma_f32_16x16x32_bf16 v[212:215], a[120:123], a[132:135], v[212:215]
    buffer_store_dwordx2 v[26:27], v22, s[24:27], s3 offen sc1
    v_fmac_f32 v238, v242, v226
    v_fmac_f32 v239, v243, v227
    v_mfma_f32_16x16x32_bf16 v[216:219], a[120:123], a[136:139], v[216:219]
    v_fmac_f32 v238, v244, v224
    v_fmac_f32 v239, v245, v225
    v_mfma_f32_16x16x32_bf16 v[220:223], a[120:123], a[140:143], v[220:223]
    v_mul_f32 v238, v238, v246
    v_mul_f32 v239, v239, v247
    v_mfma_f32_16x16x32_bf16 a[208:211], a[124:127], a[140:143], a[208:211]
    v_cvt_pk_bf16_f32 v18, v238, v236
    v_cvt_pk_bf16_f32 v19, v234, v232
    v_mfma_f32_16x16x32_bf16 a[204:207], a[124:127], a[136:139], a[204:207]
    v_cvt_pk_bf16_f32 v20, v239, v237
    v_cvt_pk_bf16_f32 v21, v235, v233
    v_mfma_f32_16x16x32_bf16 a[200:203], a[124:127], a[132:135], a[200:203]
    v_mfma_f32_16x16x32_bf16 a[196:199], a[124:127], a[128:131], a[196:199]
    s_mov_b32 s3, 25344
    buffer_store_dwordx2 v[18:19], v22, s[24:27], s3 offen sc1
    s_mov_b32 s3, 29568
    buffer_store_dwordx2 v[20:21], v22, s[24:27], s3 offen sc1
    v_mov_b32 v224, 0
    v_mov_b32 v225, 0
    v_mov_b32 v226, 0
    v_mov_b32 v227, 0
    buffer_store_dwordx4 v[224:227], v23, s[24:27], 0 offen sc1
    s_mov_b32 s82, 0
    s_and_b32 s74, s2, 1
    s_lshl_b32 s74, s74, 7
    s_getpc_b64 s[6:7]
L_pcb:
    s_lshr_b32 s3, s2, 3
    s_and_b32 s3, s3, 1
    s_lshl_b32 s3, s3, 2
    s_add_u32 s3, s3, s64
    s_lshl_b32 s3, s3, 12
    v_lshlrev_b32 v228, 6, v0
    v_add_u32 v228, s3, v228
    v_min_u32 v228, L_end-L_pcb, v228
    v_mov_b32 v229, s7
    v_add_co_u32 v228, vcc, s6, v228
    s_nop 1
    v_addc_co_u32 v229, vcc, 0, v229, vcc
    global_load_dword a255, v[228:229], off
L_g1_loop:
    s_waitcnt vmcnt(16) lgkmcnt(0)
    s_barrier
    v_mfma_f32_16x16x32_bf16 v[32:35], a[0:3], a[56:59], v[32:35]
    ds_read_b64_tr_b16 a[72:73], v8 offset:16384
    v_add_u32 v17, s75, v16
    v_mfma_f32_16x16x32_bf16 v[36:39], a[0:3], a[60:63], v[36:39]
    ds_read_b64_tr_b16 a[74:75], v8 offset:17408
    v_mfma_f32_16x16x32_bf16 v[40:43], a[0:3], a[64:67], v[40:43]
    ds_read_b64_tr_b16 a[76:77], v9 offset:16384
    s_add_u32 m0, s76, 4096
    v_mfma_f32_16x16x32_bf16 v[44:47], a[0:3], a[68:71], v[44:47]
    ds_read_b64_tr_b16 a[78:79], v9 offset:17408
    s_add_u32 s79, s77, 0x10000
    v_mfma_f32_16x16x32_bf16 v[60:63], a[4:7], a[68:71], v[60:63]
    ds_read_b128 a[128:131], v17 offset:0
    buffer_load_dwordx4 v4, s[8:11], s79 offen lds
    v_mfma_f32_16x16x32_bf16 v[56:59], a[4:7], a[64:67], v[56:59]
    ds_read_b128 a[132:135], v17 offset:2048
    v_mfma_f32_16x16x32_bf16 v[52:55], a[4:7], a[60:63], v[52:55]
    ds_read_b128 a[136:139], v17 offset:4096
    v_mfma_f32_16x16x32_bf16 v[48:51], a[4:7], a[56:59], v[48:51]
    ds_read_b128 a[140:143], v17 offset:6144
    v_mfma_f32_16x16x32_bf16 v[64:67], a[8:11], a[56:59], v[64:67]
    ds_read_b64_tr_b16 a[80:81], v10 offset:16384
    v_mfma_f32_16x16x32_bf16 v[68:71], a[8:11], a[60:63], v[68:71]
    ds_read_b64_tr_b16 a[82:83], v10 offset:17408
    v_mfma_f32_16x16x32_bf16 v[72:75], a[8:11], a[64:67], v[72:75]
    ds_read_b64_tr_b16 a[84:85], v11 offset:16384
    buffer_load_dwordx4 v5, s[8:11], s79 offen offset:1024 lds
    v_mfma_f32_16x16x32_bf16 v[76:79], a[8:11], a[68:71], v[76:79]
    ds_read_b64_tr_b16 a[86:87], v11 offset:17408
    v_mfma_f32_16x16x32_bf16 v[92:95], a[12:15], a[68:71], v[92:95]
    ds_read_b64_tr_b16 a[88:89], v12 offset:16384
    v_mfma_f32_16x16x32_bf16 v[88:91], a[12:15], a[64:67], v[88:91]
    ds_read_b64_tr_b16 a[90:91], v12 offset:17408
    v_mfma_f32_16x16x32_bf16 v[84:87], a[12:15], a[60:63], v[84:87]
    ds_read_b64_tr_b16 a[92:93], v13 offset:16384
    v_mfma_f32_16x16x32_bf16 v[80:83], a[12:15], a[56:59], v[80:83]
    ds_read_b64_tr_b16 a[94:95], v13 offset:17408
    v_mfma_f32_16x16x32_bf16 v[96:99], a[16:19], a[56:59], v[96:99]
    ds_read_b64_tr_b16 a[96:97], v14 offset:16384
    buffer_load_dwordx4 v6, s[8:11], s79 offen offset:2048 lds
    v_mfma_f32_16x16x32_bf16 v[100:103], a[16:19], a[60:63], v[100:103]
    ds_read_b64_tr_b16 a[98:99], v14 offset:17408
    v_mfma_f32_16x16x32_bf16 v[104:107], a[16:19], a[64:67], v[104:107]
    ds_read_b64_tr_b16 a[100:101], v8 offset:24576
    v_mfma_f32_16x16x32_bf16 v[108:111], a[16:19], a[68:71], v[108:111]
    ds_read_b64_tr_b16 a[102:103], v8 offset:25600
    v_mfma_f32_16x16x32_bf16 v[124:127], a[20:23], a[68:71], v[124:127]
    ds_read_b64_tr_b16 a[104:105], v9 offset:24576
    v_mfma_f32_16x16x32_bf16 v[120:123], a[20:23], a[64:67], v[120:123]
    ds_read_b64_tr_b16 a[106:107], v9 offset:25600
    v_mfma_f32_16x16x32_bf16 v[116:119], a[20:23], a[60:63], v[116:119]
    ds_read_b64_tr_b16 a[108:109], v10 offset:24576
    v_mfma_f32_16x16x32_bf16 v[112:115], a[20:23], a[56:59], v[112:115]
    ds_read_b64_tr_b16 a[110:111], v10 offset:25600
    buffer_load_dwordx4 v7, s[8:11], s79 offen offset:3072 lds
    v_mfma_f32_16x16x32_bf16 a[180:183], a[24:27], a[56:59], a[180:183]
    ds_read_b64_tr_b16 a[112:113], v11 offset:24576
    s_add_u32 s77, s77, 128
    v_mfma_f32_16x16x32_bf16 a[184:187], a[24:27], a[60:63], a[184:187]
    ds_read_b64_tr_b16 a[114:115], v11 offset:25600
    s_and_b32 s77, s77, 0x7ff
    v_mfma_f32_16x16x32_bf16 a[188:191], a[24:27], a[64:67], a[188:191]
    ds_read_b64_tr_b16 a[116:117], v12 offset:24576
    s_add_u32 s76, s76, 8192
    v_mfma_f32_16x16x32_bf16 a[192:195], a[24:27], a[68:71], a[192:195]
    s_cmp_eq_u32 s76, s91
    s_cselect_b32 s76, s70, s76
    v_mfma_f32_16x16x32_bf16 v[140:143], a[28:31], a[68:71], v[140:143]
    ds_read_b64_tr_b16 a[118:119], v12 offset:25600
    s_add_u32 m0, s71, 0
    v_mfma_f32_16x16x32_bf16 v[136:139], a[28:31], a[64:67], v[136:139]
    ds_read_b64_tr_b16 a[120:121], v13 offset:24576
    buffer_load_dwordx4 v3, s[12:15], s72 offen lds
    v_mfma_f32_16x16x32_bf16 v[132:135], a[28:31], a[60:63], v[132:135]
    ds_read_b64_tr_b16 a[122:123], v13 offset:25600
    v_mfma_f32_16x16x32_bf16 v[128:131], a[28:31], a[56:59], v[128:131]
    ds_read_b64_tr_b16 a[124:125], v14 offset:24576
    v_mfma_f32_16x16x32_bf16 v[144:147], a[32:35], a[56:59], v[144:147]
    ds_read_b64_tr_b16 a[126:127], v14 offset:25600
    v_mfma_f32_16x16x32_bf16 v[148:151], a[32:35], a[60:63], v[148:151]
    v_mfma_f32_16x16x32_bf16 v[152:155], a[32:35], a[64:67], v[152:155]
    v_mfma_f32_16x16x32_bf16 v[156:159], a[32:35], a[68:71], v[156:159]
    buffer_load_dwordx4 v3, s[12:15], s73 offen offset:1024 lds
    v_mfma_f32_16x16x32_bf16 v[172:175], a[36:39], a[68:71], v[172:175]
    v_mfma_f32_16x16x32_bf16 v[168:171], a[36:39], a[64:67], v[168:171]
    v_mfma_f32_16x16x32_bf16 v[164:167], a[36:39], a[60:63], v[164:167]
    v_mfma_f32_16x16x32_bf16 v[160:163], a[36:39], a[56:59], v[160:163]
    v_mfma_f32_16x16x32_bf16 v[176:179], a[40:43], a[56:59], v[176:179]
    v_mfma_f32_16x16x32_bf16 v[180:183], a[40:43], a[60:63], v[180:183]
    s_add_u32 m0, s71, 8192
    v_mfma_f32_16x16x32_bf16 v[184:187], a[40:43], a[64:67], v[184:187]
    buffer_load_dwordx4 v3, s[16:19], s72 offen lds
    v_mfma_f32_16x16x32_bf16 v[188:191], a[40:43], a[68:71], v[188:191]
    v_mfma_f32_16x16x32_bf16 v[204:207], a[44:47], a[68:71], v[204:207]
    v_mfma_f32_16x16x32_bf16 v[200:203], a[44:47], a[64:67], v[200:203]
    v_mfma_f32_16x16x32_bf16 v[196:199], a[44:47], a[60:63], v[196:199]
    v_mfma_f32_16x16x32_bf16 v[192:195], a[44:47], a[56:59], v[192:195]
    v_mfma_f32_16x16x32_bf16 v[208:211], a[48:51], a[56:59], v[208:211]
    buffer_load_dwordx4 v3, s[16:19], s73 offen offset:1024 lds
    v_mfma_f32_16x16x32_bf16 v[212:215], a[48:51], a[60:63], v[212:215]
    s_add_u32 s72, s72, 229376
    v_mfma_f32_16x16x32_bf16 v[216:219], a[48:51], a[64:67], v[216:219]
    s_cmp_eq_u32 s72, 7340032
    s_cselect_b32 s72, 0, s72
    v_mfma_f32_16x16x32_bf16 v[220:223], a[48:51], a[68:71], v[220:223]
    s_add_u32 s73, s72, 27648
    v_mfma_f32_16x16x32_bf16 a[208:211], a[52:55], a[68:71], a[208:211]
    v_mfma_f32_16x16x32_bf16 a[204:207], a[52:55], a[64:67], a[204:207]
    v_mfma_f32_16x16x32_bf16 a[200:203], a[52:55], a[60:63], a[200:203]
    v_mfma_f32_16x16x32_bf16 a[196:199], a[52:55], a[56:59], a[196:199]
    s_waitcnt vmcnt(16) lgkmcnt(0)
    s_barrier
    v_mfma_f32_16x16x32_bf16 v[32:35], a[72:75], a[128:131], v[32:35]
    ds_read_b64_tr_b16 a[0:1], v8 offset:32768
    s_add_u32 s75, s75, 8192
    v_mfma_f32_16x16x32_bf16 v[36:39], a[72:75], a[132:135], v[36:39]
    s_cmp_eq_u32 s75, 24576
    s_cselect_b32 s75, 0, s75
    v_mfma_f32_16x16x32_bf16 v[40:43], a[72:75], a[136:139], v[40:43]
    ds_read_b64_tr_b16 a[2:3], v8 offset:33792
    v_add_u32 v17, s75, v15
    v_mfma_f32_16x16x32_bf16 v[44:47], a[72:75], a[140:143], v[44:47]
    ds_read_b64_tr_b16 a[4:5], v9 offset:32768
    s_mov_b32 m0, s76
    v_mfma_f32_16x16x32_bf16 v[60:63], a[76:79], a[140:143], v[60:63]
    ds_read_b64_tr_b16 a[6:7], v9 offset:33792
    buffer_load_dwordx4 v4, s[8:11], s77 offen lds
    v_mfma_f32_16x16x32_bf16 v[56:59], a[76:79], a[136:139], v[56:59]
    ds_read_b128 a[56:59], v17 offset:0
    v_mfma_f32_16x16x32_bf16 v[52:55], a[76:79], a[132:135], v[52:55]
    ds_read_b128 a[60:63], v17 offset:2048
    v_mfma_f32_16x16x32_bf16 v[48:51], a[76:79], a[128:131], v[48:51]
    ds_read_b128 a[64:67], v17 offset:4096
    v_mfma_f32_16x16x32_bf16 v[64:67], a[80:83], a[128:131], v[64:67]
    ds_read_b128 a[68:71], v17 offset:6144
    v_mfma_f32_16x16x32_bf16 v[68:71], a[80:83], a[132:135], v[68:71]
    ds_read_b64_tr_b16 a[8:9], v10 offset:32768
    v_mfma_f32_16x16x32_bf16 v[72:75], a[80:83], a[136:139], v[72:75]
    ds_read_b64_tr_b16 a[10:11], v10 offset:33792
    buffer_load_dwordx4 v5, s[8:11], s77 offen offset:1024 lds
    v_mfma_f32_16x16x32_bf16 v[76:79], a[80:83], a[140:143], v[76:79]
    ds_read_b64_tr_b16 a[12:13], v11 offset:32768
    v_mfma_f32_16x16x32_bf16 v[92:95], a[84:87], a[140:143], v[92:95]
    ds_read_b64_tr_b16 a[14:15], v11 offset:33792
    v_mfma_f32_16x16x32_bf16 v[88:91], a[84:87], a[136:139], v[88:91]
    ds_read_b64_tr_b16 a[16:17], v12 offset:32768
    v_mfma_f32_16x16x32_bf16 v[84:87], a[84:87], a[132:135], v[84:87]
    ds_read_b64_tr_b16 a[18:19], v12 offset:33792
    v_mfma_f32_16x16x32_bf16 v[80:83], a[84:87], a[128:131], v[80:83]
    ds_read_b64_tr_b16 a[20:21], v13 offset:32768
    v_mfma_f32_16x16x32_bf16 v[96:99], a[88:91], a[128:131], v[96:99]
    ds_read_b64_tr_b16 a[22:23], v13 offset:33792
    buffer_load_dwordx4 v6, s[8:11], s77 offen offset:2048 lds
    v_mfma_f32_16x16x32_bf16 v[100:103], a[88:91], a[132:135], v[100:103]
    ds_read_b64_tr_b16 a[24:25], v14 offset:32768
    v_mfma_f32_16x16x32_bf16 v[104:107], a[88:91], a[136:139], v[104:107]
    ds_read_b64_tr_b16 a[26:27], v14 offset:33792
    v_mfma_f32_16x16x32_bf16 v[108:111], a[88:91], a[140:143], v[108:111]
    ds_read_b64_tr_b16 a[28:29], v8 offset:40960
    v_mfma_f32_16x16x32_bf16 v[124:127], a[92:95], a[140:143], v[124:127]
    ds_read_b64_tr_b16 a[30:31], v8 offset:41984
    v_mfma_f32_16x16x32_bf16 v[120:123], a[92:95], a[136:139], v[120:123]
    ds_read_b64_tr_b16 a[32:33], v9 offset:40960
    v_mfma_f32_16x16x32_bf16 v[116:119], a[92:95], a[132:135], v[116:119]
    ds_read_b64_tr_b16 a[34:35], v9 offset:41984
    v_mfma_f32_16x16x32_bf16 v[112:115], a[92:95], a[128:131], v[112:115]
    ds_read_b64_tr_b16 a[36:37], v10 offset:40960
    buffer_load_dwordx4 v7, s[8:11], s77 offen offset:3072 lds
    v_mfma_f32_16x16x32_bf16 a[180:183], a[96:99], a[128:131], a[180:183]
    ds_read_b64_tr_b16 a[38:39], v10 offset:41984
    v_mfma_f32_16x16x32_bf16 a[184:187], a[96:99], a[132:135], a[184:187]
    ds_read_b64_tr_b16 a[40:41], v11 offset:40960
    v_mfma_f32_16x16x32_bf16 a[188:191], a[96:99], a[136:139], a[188:191]
    ds_read_b64_tr_b16 a[42:43], v11 offset:41984
    v_mfma_f32_16x16x32_bf16 a[192:195], a[96:99], a[140:143], a[192:195]
    ds_read_b64_tr_b16 a[44:45], v12 offset:40960
    v_mfma_f32_16x16x32_bf16 v[140:143], a[100:103], a[140:143], v[140:143]
    ds_read_b64_tr_b16 a[46:47], v12 offset:41984
    s_add_u32 m0, s71, 16384
    v_mfma_f32_16x16x32_bf16 v[136:139], a[100:103], a[136:139], v[136:139]
    ds_read_b64_tr_b16 a[48:49], v13 offset:40960
    buffer_load_dwordx4 v3, s[12:15], s72 offen lds
    v_mfma_f32_16x16x32_bf16 v[132:135], a[100:103], a[132:135], v[132:135]
    ds_read_b64_tr_b16 a[50:51], v13 offset:41984
    v_mfma_f32_16x16x32_bf16 v[128:131], a[100:103], a[128:131], v[128:131]
    ds_read_b64_tr_b16 a[52:53], v14 offset:40960
    v_mfma_f32_16x16x32_bf16 v[144:147], a[104:107], a[128:131], v[144:147]
    ds_read_b64_tr_b16 a[54:55], v14 offset:41984
    v_mfma_f32_16x16x32_bf16 v[148:151], a[104:107], a[132:135], v[148:151]
    v_mfma_f32_16x16x32_bf16 v[152:155], a[104:107], a[136:139], v[152:155]
    v_mfma_f32_16x16x32_bf16 v[156:159], a[104:107], a[140:143], v[156:159]
    buffer_load_dwordx4 v3, s[12:15], s73 offen offset:1024 lds
    v_mfma_f32_16x16x32_bf16 v[172:175], a[108:111], a[140:143], v[172:175]
    v_mfma_f32_16x16x32_bf16 v[168:171], a[108:111], a[136:139], v[168:171]
    v_mfma_f32_16x16x32_bf16 v[164:167], a[108:111], a[132:135], v[164:167]
    v_mfma_f32_16x16x32_bf16 v[160:163], a[108:111], a[128:131], v[160:163]
    v_mfma_f32_16x16x32_bf16 v[176:179], a[112:115], a[128:131], v[176:179]
    v_mfma_f32_16x16x32_bf16 v[180:183], a[112:115], a[132:135], v[180:183]
    s_add_u32 m0, s71, 24576
    v_mfma_f32_16x16x32_bf16 v[184:187], a[112:115], a[136:139], v[184:187]
    buffer_load_dwordx4 v3, s[16:19], s72 offen lds
    v_mfma_f32_16x16x32_bf16 v[188:191], a[112:115], a[140:143], v[188:191]
    v_mfma_f32_16x16x32_bf16 v[204:207], a[116:119], a[140:143], v[204:207]
    v_mfma_f32_16x16x32_bf16 v[200:203], a[116:119], a[136:139], v[200:203]
    v_mfma_f32_16x16x32_bf16 v[196:199], a[116:119], a[132:135], v[196:199]
    v_mfma_f32_16x16x32_bf16 v[192:195], a[116:119], a[128:131], v[192:195]
    v_mfma_f32_16x16x32_bf16 v[208:211], a[120:123], a[128:131], v[208:211]
    buffer_load_dwordx4 v3, s[16:19], s73 offen offset:1024 lds
    v_mfma_f32_16x16x32_bf16 v[212:215], a[120:123], a[132:135], v[212:215]
    s_add_u32 s72, s72, 229376
    v_mfma_f32_16x16x32_bf16 v[216:219], a[120:123], a[136:139], v[216:219]
    s_cmp_eq_u32 s72, 7340032
    s_cselect_b32 s72, 0, s72
    v_mfma_f32_16x16x32_bf16 v[220:223], a[120:123], a[140:143], v[220:223]
    s_add_u32 s73, s72, 27648
    v_mfma_f32_16x16x32_bf16 a[208:211], a[124:127], a[140:143], a[208:211]
    v_mfma_f32_16x16x32_bf16 a[204:207], a[124:127], a[136:139], a[204:207]
    v_mfma_f32_16x16x32_bf16 a[200:203], a[124:127], a[132:135], a[200:203]
    v_mfma_f32_16x16x32_bf16 a[196:199], a[124:127], a[128:131], a[196:199]
    s_waitcnt vmcnt(16) lgkmcnt(0)
    s_barrier
    s_cmp_lg_u32 s82, 0
    s_cbranch_scc1 L_f0_nosig
    s_cmp_lg_u32 s64, 0
    s_cbranch_scc1 L_f0_nosig
    v_mov_b32 v1, 1
    s_mov_b64 exec, 1
    buffer_atomic_add v1, off, s[40:43], s74 sc1
    s_mov_b64 exec, -1
L_f0_nosig:
    v_mfma_f32_16x16x32_bf16 v[32:35], a[0:3], a[56:59], v[32:35]
    ds_read_b64_tr_b16 a[72:73], v8 offset:49152
    v_add_u32 v17, s75, v16
    v_mfma_f32_16x16x32_bf16 v[36:39], a[0:3], a[60:63], v[36:39]
    ds_read_b64_tr_b16 a[74:75], v8 offset:50176
    v_mfma_f32_16x16x32_bf16 v[40:43], a[0:3], a[64:67], v[40:43]
    ds_read_b64_tr_b16 a[76:77], v9 offset:49152
    s_add_u32 m0, s76, 4096
    v_mfma_f32_16x16x32_bf16 v[44:47], a[0:3], a[68:71], v[44:47]
    ds_read_b64_tr_b16 a[78:79], v9 offset:50176
    s_add_u32 s79, s77, 0x10000
    v_mfma_f32_16x16x32_bf16 v[60:63], a[4:7], a[68:71], v[60:63]
    ds_read_b128 a[128:131], v17 offset:0
    buffer_load_dwordx4 v4, s[8:11], s79 offen lds
    v_mfma_f32_16x16x32_bf16 v[56:59], a[4:7], a[64:67], v[56:59]
    ds_read_b128 a[132:135], v17 offset:2048
    v_mfma_f32_16x16x32_bf16 v[52:55], a[4:7], a[60:63], v[52:55]
    ds_read_b128 a[136:139], v17 offset:4096
    v_mfma_f32_16x16x32_bf16 v[48:51], a[4:7], a[56:59], v[48:51]
    ds_read_b128 a[140:143], v17 offset:6144
    v_mfma_f32_16x16x32_bf16 v[64:67], a[8:11], a[56:59], v[64:67]
    ds_read_b64_tr_b16 a[80:81], v10 offset:49152
    v_mfma_f32_16x16x32_bf16 v[68:71], a[8:11], a[60:63], v[68:71]
    ds_read_b64_tr_b16 a[82:83], v10 offset:50176
    v_mfma_f32_16x16x32_bf16 v[72:75], a[8:11], a[64:67], v[72:75]
    ds_read_b64_tr_b16 a[84:85], v11 offset:49152
    buffer_load_dwordx4 v5, s[8:11], s79 offen offset:1024 lds
    v_mfma_f32_16x16x32_bf16 v[76:79], a[8:11], a[68:71], v[76:79]
    ds_read_b64_tr_b16 a[86:87], v11 offset:50176
    v_mfma_f32_16x16x32_bf16 v[92:95], a[12:15], a[68:71], v[92:95]
    ds_read_b64_tr_b16 a[88:89], v12 offset:49152
    v_mfma_f32_16x16x32_bf16 v[88:91], a[12:15], a[64:67], v[88:91]
    ds_read_b64_tr_b16 a[90:91], v12 offset:50176
    v_mfma_f32_16x16x32_bf16 v[84:87], a[12:15], a[60:63], v[84:87]
    ds_read_b64_tr_b16 a[92:93], v13 offset:49152
    v_mfma_f32_16x16x32_bf16 v[80:83], a[12:15], a[56:59], v[80:83]
    ds_read_b64_tr_b16 a[94:95], v13 offset:50176
    v_mfma_f32_16x16x32_bf16 v[96:99], a[16:19], a[56:59], v[96:99]
    ds_read_b64_tr_b16 a[96:97], v14 offset:49152
    buffer_load_dwordx4 v6, s[8:11], s79 offen offset:2048 lds
    v_mfma_f32_16x16x32_bf16 v[100:103], a[16:19], a[60:63], v[100:103]
    ds_read_b64_tr_b16 a[98:99], v14 offset:50176
    v_mfma_f32_16x16x32_bf16 v[104:107], a[16:19], a[64:67], v[104:107]
    ds_read_b64_tr_b16 a[100:101], v8 offset:57344
    v_mfma_f32_16x16x32_bf16 v[108:111], a[16:19], a[68:71], v[108:111]
    ds_read_b64_tr_b16 a[102:103], v8 offset:58368
    v_mfma_f32_16x16x32_bf16 v[124:127], a[20:23], a[68:71], v[124:127]
    ds_read_b64_tr_b16 a[104:105], v9 offset:57344
    v_mfma_f32_16x16x32_bf16 v[120:123], a[20:23], a[64:67], v[120:123]
    ds_read_b64_tr_b16 a[106:107], v9 offset:58368
    v_mfma_f32_16x16x32_bf16 v[116:119], a[20:23], a[60:63], v[116:119]
    ds_read_b64_tr_b16 a[108:109], v10 offset:57344
    v_mfma_f32_16x16x32_bf16 v[112:115], a[20:23], a[56:59], v[112:115]
    ds_read_b64_tr_b16 a[110:111], v10 offset:58368
    buffer_load_dwordx4 v7, s[8:11], s79 offen offset:3072 lds
    v_mfma_f32_16x16x32_bf16 a[180:183], a[24:27], a[56:59], a[180:183]
    ds_read_b64_tr_b16 a[112:113], v11 offset:57344
    s_add_u32 s77, s77, 128
    v_mfma_f32_16x16x32_bf16 a[184:187], a[24:27], a[60:63], a[184:187]
    ds_read_b64_tr_b16 a[114:115], v11 offset:58368
    s_and_b32 s77, s77, 0x7ff
    v_mfma_f32_16x16x32_bf16 a[188:191], a[24:27], a[64:67], a[188:191]
    ds_read_b64_tr_b16 a[116:117], v12 offset:57344
    s_add_u32 s76, s76, 8192
    v_mfma_f32_16x16x32_bf16 a[192:195], a[24:27], a[68:71], a[192:195]
    s_cmp_eq_u32 s76, s91
    s_cselect_b32 s76, s70, s76
    v_mfma_f32_16x16x32_bf16 v[140:143], a[28:31], a[68:71], v[140:143]
    ds_read_b64_tr_b16 a[118:119], v12 offset:58368
    s_add_u32 m0, s71, 32768
    v_mfma_f32_16x16x32_bf16 v[136:139], a[28:31], a[64:67], v[136:139]
    ds_read_b64_tr_b16 a[120:121], v13 offset:57344
    buffer_load_dwordx4 v3, s[12:15], s72 offen lds
    v_mfma_f32_16x16x32_bf16 v[132:135], a[28:31], a[60:63], v[132:135]
    ds_read_b64_tr_b16 a[122:123], v13 offset:58368
    v_mfma_f32_16x16x32_bf16 v[128:131], a[28:31], a[56:59], v[128:131]
    ds_read_b64_tr_b16 a[124:125], v14 offset:57344
    v_mfma_f32_16x16x32_bf16 v[144:147], a[32:35], a[56:59], v[144:147]
    ds_read_b64_tr_b16 a[126:127], v14 offset:58368
    v_mfma_f32_16x16x32_bf16 v[148:151], a[32:35], a[60:63], v[148:151]
    v_mfma_f32_16x16x32_bf16 v[152:155], a[32:35], a[64:67], v[152:155]
    v_mfma_f32_16x16x32_bf16 v[156:159], a[32:35], a[68:71], v[156:159]
    buffer_load_dwordx4 v3, s[12:15], s73 offen offset:1024 lds
    v_mfma_f32_16x16x32_bf16 v[172:175], a[36:39], a[68:71], v[172:175]
    v_mfma_f32_16x16x32_bf16 v[168:171], a[36:39], a[64:67], v[168:171]
    v_mfma_f32_16x16x32_bf16 v[164:167], a[36:39], a[60:63], v[164:167]
    v_mfma_f32_16x16x32_bf16 v[160:163], a[36:39], a[56:59], v[160:163]
    v_mfma_f32_16x16x32_bf16 v[176:179], a[40:43], a[56:59], v[176:179]
    v_mfma_f32_16x16x32_bf16 v[180:183], a[40:43], a[60:63], v[180:183]
    s_add_u32 m0, s71, 40960
    v_mfma_f32_16x16x32_bf16 v[184:187], a[40:43], a[64:67], v[184:187]
    buffer_load_dwordx4 v3, s[16:19], s72 offen lds
    v_mfma_f32_16x16x32_bf16 v[188:191], a[40:43], a[68:71], v[188:191]
    v_mfma_f32_16x16x32_bf16 v[204:207], a[44:47], a[68:71], v[204:207]
    v_mfma_f32_16x16x32_bf16 v[200:203], a[44:47], a[64:67], v[200:203]
    v_mfma_f32_16x16x32_bf16 v[196:199], a[44:47], a[60:63], v[196:199]
    v_mfma_f32_16x16x32_bf16 v[192:195], a[44:47], a[56:59], v[192:195]
    v_mfma_f32_16x16x32_bf16 v[208:211], a[48:51], a[56:59], v[208:211]
    buffer_load_dwordx4 v3, s[16:19], s73 offen offset:1024 lds
    v_mfma_f32_16x16x32_bf16 v[212:215], a[48:51], a[60:63], v[212:215]
    s_add_u32 s72, s72, 229376
    v_mfma_f32_16x16x32_bf16 v[216:219], a[48:51], a[64:67], v[216:219]
    s_cmp_eq_u32 s72, 7340032
    s_cselect_b32 s72, 0, s72
    v_mfma_f32_16x16x32_bf16 v[220:223], a[48:51], a[68:71], v[220:223]
    s_add_u32 s73, s72, 27648
    v_mfma_f32_16x16x32_bf16 a[208:211], a[52:55], a[68:71], a[208:211]
    v_mfma_f32_16x16x32_bf16 a[204:207], a[52:55], a[64:67], a[204:207]
    v_mfma_f32_16x16x32_bf16 a[200:203], a[52:55], a[60:63], a[200:203]
    v_mfma_f32_16x16x32_bf16 a[196:199], a[52:55], a[56:59], a[196:199]
    s_waitcnt vmcnt(16) lgkmcnt(0)
    s_barrier
    v_mfma_f32_16x16x32_bf16 v[32:35], a[72:75], a[128:131], v[32:35]
    ds_read_b64_tr_b16 a[0:1], v8 offset:0
    s_add_u32 s75, s75, 8192
    v_mfma_f32_16x16x32_bf16 v[36:39], a[72:75], a[132:135], v[36:39]
    s_cmp_eq_u32 s75, 24576
    s_cselect_b32 s75, 0, s75
    v_mfma_f32_16x16x32_bf16 v[40:43], a[72:75], a[136:139], v[40:43]
    ds_read_b64_tr_b16 a[2:3], v8 offset:1024
    v_add_u32 v17, s75, v15
    v_mfma_f32_16x16x32_bf16 v[44:47], a[72:75], a[140:143], v[44:47]
    ds_read_b64_tr_b16 a[4:5], v9 offset:0
    s_mov_b32 m0, s76
    v_mfma_f32_16x16x32_bf16 v[60:63], a[76:79], a[140:143], v[60:63]
    ds_read_b64_tr_b16 a[6:7], v9 offset:1024
    buffer_load_dwordx4 v4, s[8:11], s77 offen lds
    v_mfma_f32_16x16x32_bf16 v[56:59], a[76:79], a[136:139], v[56:59]
    ds_read_b128 a[56:59], v17 offset:0
    v_mfma_f32_16x16x32_bf16 v[52:55], a[76:79], a[132:135], v[52:55]
    ds_read_b128 a[60:63], v17 offset:2048
    v_mfma_f32_16x16x32_bf16 v[48:51], a[76:79], a[128:131], v[48:51]
    ds_read_b128 a[64:67], v17 offset:4096
    v_mfma_f32_16x16x32_bf16 v[64:67], a[80:83], a[128:131], v[64:67]
    ds_read_b128 a[68:71], v17 offset:6144
    v_mfma_f32_16x16x32_bf16 v[68:71], a[80:83], a[132:135], v[68:71]
    ds_read_b64_tr_b16 a[8:9], v10 offset:0
    v_mfma_f32_16x16x32_bf16 v[72:75], a[80:83], a[136:139], v[72:75]
    ds_read_b64_tr_b16 a[10:11], v10 offset:1024
    buffer_load_dwordx4 v5, s[8:11], s77 offen offset:1024 lds
    v_mfma_f32_16x16x32_bf16 v[76:79], a[80:83], a[140:143], v[76:79]
    ds_read_b64_tr_b16 a[12:13], v11 offset:0
    v_mfma_f32_16x16x32_bf16 v[92:95], a[84:87], a[140:143], v[92:95]
    ds_read_b64_tr_b16 a[14:15], v11 offset:1024
    v_mfma_f32_16x16x32_bf16 v[88:91], a[84:87], a[136:139], v[88:91]
    ds_read_b64_tr_b16 a[16:17], v12 offset:0
    v_mfma_f32_16x16x32_bf16 v[84:87], a[84:87], a[132:135], v[84:87]
    ds_read_b64_tr_b16 a[18:19], v12 offset:1024
    v_mfma_f32_16x16x32_bf16 v[80:83], a[84:87], a[128:131], v[80:83]
    ds_read_b64_tr_b16 a[20:21], v13 offset:0
    v_mfma_f32_16x16x32_bf16 v[96:99], a[88:91], a[128:131], v[96:99]
    ds_read_b64_tr_b16 a[22:23], v13 offset:1024
    buffer_load_dwordx4 v6, s[8:11], s77 offen offset:2048 lds
    v_mfma_f32_16x16x32_bf16 v[100:103], a[88:91], a[132:135], v[100:103]
    ds_read_b64_tr_b16 a[24:25], v14 offset:0
    v_mfma_f32_16x16x32_bf16 v[104:107], a[88:91], a[136:139], v[104:107]
    ds_read_b64_tr_b16 a[26:27], v14 offset:1024
    v_mfma_f32_16x16x32_bf16 v[108:111], a[88:91], a[140:143], v[108:111]
    ds_read_b64_tr_b16 a[28:29], v8 offset:8192
    v_mfma_f32_16x16x32_bf16 v[124:127], a[92:95], a[140:143], v[124:127]
    ds_read_b64_tr_b16 a[30:31], v8 offset:9216
    v_mfma_f32_16x16x32_bf16 v[120:123], a[92:95], a[136:139], v[120:123]
    ds_read_b64_tr_b16 a[32:33], v9 offset:8192
    v_mfma_f32_16x16x32_bf16 v[116:119], a[92:95], a[132:135], v[116:119]
    ds_read_b64_tr_b16 a[34:35], v9 offset:9216
    v_mfma_f32_16x16x32_bf16 v[112:115], a[92:95], a[128:131], v[112:115]
    ds_read_b64_tr_b16 a[36:37], v10 offset:8192
    buffer_load_dwordx4 v7, s[8:11], s77 offen offset:3072 lds
    v_mfma_f32_16x16x32_bf16 a[180:183], a[96:99], a[128:131], a[180:183]
    ds_read_b64_tr_b16 a[38:39], v10 offset:9216
    v_mfma_f32_16x16x32_bf16 a[184:187], a[96:99], a[132:135], a[184:187]
    ds_read_b64_tr_b16 a[40:41], v11 offset:8192
    v_mfma_f32_16x16x32_bf16 a[188:191], a[96:99], a[136:139], a[188:191]
    ds_read_b64_tr_b16 a[42:43], v11 offset:9216
    v_mfma_f32_16x16x32_bf16 a[192:195], a[96:99], a[140:143], a[192:195]
    ds_read_b64_tr_b16 a[44:45], v12 offset:8192
    v_mfma_f32_16x16x32_bf16 v[140:143], a[100:103], a[140:143], v[140:143]
    ds_read_b64_tr_b16 a[46:47], v12 offset:9216
    s_add_u32 m0, s71, 49152
    v_mfma_f32_16x16x32_bf16 v[136:139], a[100:103], a[136:139], v[136:139]
    ds_read_b64_tr_b16 a[48:49], v13 offset:8192
    buffer_load_dwordx4 v3, s[12:15], s72 offen lds
    v_mfma_f32_16x16x32_bf16 v[132:135], a[100:103], a[132:135], v[132:135]
    ds_read_b64_tr_b16 a[50:51], v13 offset:9216
    v_mfma_f32_16x16x32_bf16 v[128:131], a[100:103], a[128:131], v[128:131]
    ds_read_b64_tr_b16 a[52:53], v14 offset:8192
    v_mfma_f32_16x16x32_bf16 v[144:147], a[104:107], a[128:131], v[144:147]
    ds_read_b64_tr_b16 a[54:55], v14 offset:9216
    v_mfma_f32_16x16x32_bf16 v[148:151], a[104:107], a[132:135], v[148:151]
    v_mfma_f32_16x16x32_bf16 v[152:155], a[104:107], a[136:139], v[152:155]
    v_mfma_f32_16x16x32_bf16 v[156:159], a[104:107], a[140:143], v[156:159]
    buffer_load_dwordx4 v3, s[12:15], s73 offen offset:1024 lds
    v_mfma_f32_16x16x32_bf16 v[172:175], a[108:111], a[140:143], v[172:175]
    v_mfma_f32_16x16x32_bf16 v[168:171], a[108:111], a[136:139], v[168:171]
    v_mfma_f32_16x16x32_bf16 v[164:167], a[108:111], a[132:135], v[164:167]
    v_mfma_f32_16x16x32_bf16 v[160:163], a[108:111], a[128:131], v[160:163]
    v_mfma_f32_16x16x32_bf16 v[176:179], a[112:115], a[128:131], v[176:179]
    v_mfma_f32_16x16x32_bf16 v[180:183], a[112:115], a[132:135], v[180:183]
    s_add_u32 m0, s71, 57344
    v_mfma_f32_16x16x32_bf16 v[184:187], a[112:115], a[136:139], v[184:187]
    buffer_load_dwordx4 v3, s[16:19], s72 offen lds
    v_mfma_f32_16x16x32_bf16 v[188:191], a[112:115], a[140:143], v[188:191]
    v_mfma_f32_16x16x32_bf16 v[204:207], a[116:119], a[140:143], v[204:207]
    v_mfma_f32_16x16x32_bf16 v[200:203], a[116:119], a[136:139], v[200:203]
    v_mfma_f32_16x16x32_bf16 v[196:199], a[116:119], a[132:135], v[196:199]
    v_mfma_f32_16x16x32_bf16 v[192:195], a[116:119], a[128:131], v[192:195]
    v_mfma_f32_16x16x32_bf16 v[208:211], a[120:123], a[128:131], v[208:211]
    buffer_load_dwordx4 v3, s[16:19], s73 offen offset:1024 lds
    v_mfma_f32_16x16x32_bf16 v[212:215], a[120:123], a[132:135], v[212:215]
    s_add_u32 s72, s72, 229376
    v_mfma_f32_16x16x32_bf16 v[216:219], a[120:123], a[136:139], v[216:219]
    s_cmp_eq_u32 s72, 7340032
    s_cselect_b32 s72, 0, s72
    v_mfma_f32_16x16x32_bf16 v[220:223], a[120:123], a[140:143], v[220:223]
    s_add_u32 s73, s72, 27648
    v_mfma_f32_16x16x32_bf16 a[208:211], a[124:127], a[140:143], a[208:211]
    v_mfma_f32_16x16x32_bf16 a[204:207], a[124:127], a[136:139], a[204:207]
    v_mfma_f32_16x16x32_bf16 a[200:203], a[124:127], a[132:135], a[200:203]
    v_mfma_f32_16x16x32_bf16 a[196:199], a[124:127], a[128:131], a[196:199]
    s_add_u32 s82, s82, 1
    s_cmp_lt_u32 s82, 2
    s_cbranch_scc1 L_g1_loop
    s_waitcnt vmcnt(16) lgkmcnt(0)
    s_barrier
    v_mfma_f32_16x16x32_bf16 v[32:35], a[0:3], a[56:59], v[32:35]
    ds_read_b64_tr_b16 a[72:73], v8 offset:16384
    v_add_u32 v17, s75, v16
    v_mfma_f32_16x16x32_bf16 v[36:39], a[0:3], a[60:63], v[36:39]
    ds_read_b64_tr_b16 a[74:75], v8 offset:17408
    v_mfma_f32_16x16x32_bf16 v[40:43], a[0:3], a[64:67], v[40:43]
    ds_read_b64_tr_b16 a[76:77], v9 offset:16384
    s_add_u32 m0, s76, 4096
    v_mfma_f32_16x16x32_bf16 v[44:47], a[0:3], a[68:71], v[44:47]
    ds_read_b64_tr_b16 a[78:79], v9 offset:17408
    s_add_u32 s79, s77, 0x10000
    v_mfma_f32_16x16x32_bf16 v[60:63], a[4:7], a[68:71], v[60:63]
    ds_read_b128 a[128:131], v17 offset:0
    buffer_load_dwordx4 v4, s[8:11], s79 offen lds
    v_mfma_f32_16x16x32_bf16 v[56:59], a[4:7], a[64:67], v[56:59]
    ds_read_b128 a[132:135], v17 offset:2048
    v_mfma_f32_16x16x32_bf16 v[52:55], a[4:7], a[60:63], v[52:55]
    ds_read_b128 a[136:139], v17 offset:4096
    v_mfma_f32_16x16x32_bf16 v[48:51], a[4:7], a[56:59], v[48:51]
    ds_read_b128 a[140:143], v17 offset:6144
    v_mfma_f32_16x16x32_bf16 v[64:67], a[8:11], a[56:59], v[64:67]
    ds_read_b64_tr_b16 a[80:81], v10 offset:16384
    v_mfma_f32_16x16x32_bf16 v[68:71], a[8:11], a[60:63], v[68:71]
    ds_read_b64_tr_b16 a[82:83], v10 offset:17408
    v_mfma_f32_16x16x32_bf16 v[72:75], a[8:11], a[64:67], v[72:75]
    ds_read_b64_tr_b16 a[84:85], v11 offset:16384
    buffer_load_dwordx4 v5, s[8:11], s79 offen offset:1024 lds
    v_mfma_f32_16x16x32_bf16 v[76:79], a[8:11], a[68:71], v[76:79]
    ds_read_b64_tr_b16 a[86:87], v11 offset:17408
    v_mfma_f32_16x16x32_bf16 v[92:95], a[12:15], a[68:71], v[92:95]
    ds_read_b64_tr_b16 a[88:89], v12 offset:16384
    v_and_b32 v27, 1, v0
    v_mfma_f32_16x16x32_bf16 v[88:91], a[12:15], a[64:67], v[88:91]
    ds_read_b64_tr_b16 a[90:91], v12 offset:17408
    v_mfma_f32_16x16x32_bf16 v[84:87], a[12:15], a[60:63], v[84:87]
    ds_read_b64_tr_b16 a[92:93], v13 offset:16384
    v_mfma_f32_16x16x32_bf16 v[80:83], a[12:15], a[56:59], v[80:83]
    ds_read_b64_tr_b16 a[94:95], v13 offset:17408
    v_mfma_f32_16x16x32_bf16 v[96:99], a[16:19], a[56:59], v[96:99]
    ds_read_b64_tr_b16 a[96:97], v14 offset:16384
    buffer_load_dwordx4 v6, s[8:11], s79 offen offset:2048 lds
    v_mfma_f32_16x16x32_bf16 v[100:103], a[16:19], a[60:63], v[100:103]
    ds_read_b64_tr_b16 a[98:99], v14 offset:17408
    v_mfma_f32_16x16x32_bf16 v[104:107], a[16:19], a[64:67], v[104:107]
    ds_read_b64_tr_b16 a[100:101], v8 offset:24576
    v_mfma_f32_16x16x32_bf16 v[108:111], a[16:19], a[68:71], v[108:111]
    ds_read_b64_tr_b16 a[102:103], v8 offset:25600
    v_mfma_f32_16x16x32_bf16 v[124:127], a[20:23], a[68:71], v[124:127]
    ds_read_b64_tr_b16 a[104:105], v9 offset:24576
    v_mfma_f32_16x16x32_bf16 v[120:123], a[20:23], a[64:67], v[120:123]
    ds_read_b64_tr_b16 a[106:107], v9 offset:25600
    v_mfma_f32_16x16x32_bf16 v[116:119], a[20:23], a[60:63], v[116:119]
    ds_read_b64_tr_b16 a[108:109], v10 offset:24576
    v_mfma_f32_16x16x32_bf16 v[112:115], a[20:23], a[56:59], v[112:115]
    ds_read_b64_tr_b16 a[110:111], v10 offset:25600
    buffer_load_dwordx4 v7, s[8:11], s79 offen offset:3072 lds
    v_mfma_f32_16x16x32_bf16 a[180:183], a[24:27], a[56:59], a[180:183]
    ds_read_b64_tr_b16 a[112:113], v11 offset:24576
    s_add_u32 s77, s77, 128
    v_mfma_f32_16x16x32_bf16 a[184:187], a[24:27], a[60:63], a[184:187]
    ds_read_b64_tr_b16 a[114:115], v11 offset:25600
    s_and_b32 s77, s77, 0x7ff
    v_mfma_f32_16x16x32_bf16 a[188:191], a[24:27], a[64:67], a[188:191]
    ds_read_b64_tr_b16 a[116:117], v12 offset:24576
    s_add_u32 s76, s76, 8192
    v_mfma_f32_16x16x32_bf16 a[192:195], a[24:27], a[68:71], a[192:195]
    s_cmp_eq_u32 s76, s91
    s_cselect_b32 s76, s70, s76
    v_mfma_f32_16x16x32_bf16 v[140:143], a[28:31], a[68:71], v[140:143]
    ds_read_b64_tr_b16 a[118:119], v12 offset:25600
    s_add_u32 m0, s71, 0
    v_mfma_f32_16x16x32_bf16 v[136:139], a[28:31], a[64:67], v[136:139]
    ds_read_b64_tr_b16 a[120:121], v13 offset:24576
    buffer_load_dwordx4 v3, s[12:15], s72 offen lds
    v_mfma_f32_16x16x32_bf16 v[132:135], a[28:31], a[60:63], v[132:135]
    ds_read_b64_tr_b16 a[122:123], v13 offset:25600
    v_mfma_f32_16x16x32_bf16 v[128:131], a[28:31], a[56:59], v[128:131]
    ds_read_b64_tr_b16 a[124:125], v14 offset:24576
    v_mfma_f32_16x16x32_bf16 v[144:147], a[32:35], a[56:59], v[144:147]
    ds_read_b64_tr_b16 a[126:127], v14 offset:25600
    v_lshlrev_b32 v27, 7, v27
    v_mfma_f32_16x16x32_bf16 v[148:151], a[32:35], a[60:63], v[148:151]
    v_mfma_f32_16x16x32_bf16 v[152:155], a[32:35], a[64:67], v[152:155]
    v_mfma_f32_16x16x32_bf16 v[156:159], a[32:35], a[68:71], v[156:159]
    buffer_load_dwordx4 v3, s[12:15], s73 offen offset:1024 lds
    v_mfma_f32_16x16x32_bf16 v[172:175], a[36:39], a[68:71], v[172:175]
    v_mfma_f32_16x16x32_bf16 v[168:171], a[36:39], a[64:67], v[168:171]
    v_mfma_f32_16x16x32_bf16 v[164:167], a[36:39], a[60:63], v[164:167]
    v_mfma_f32_16x16x32_bf16 v[160:163], a[36:39], a[56:59], v[160:163]
    v_mfma_f32_16x16x32_bf16 v[176:179], a[40:43], a[56:59], v[176:179]
    v_mfma_f32_16x16x32_bf16 v[180:183], a[40:43], a[60:63], v[180:183]
    s_add_u32 m0, s71, 8192
    v_mfma_f32_16x16x32_bf16 v[184:187], a[40:43], a[64:67], v[184:187]
    buffer_load_dwordx4 v3, s[16:19], s72 offen lds
    v_mfma_f32_16x16x32_bf16 v[188:191], a[40:43], a[68:71], v[188:191]
    v_mfma_f32_16x16x32_bf16 v[204:207], a[44:47], a[68:71], v[204:207]
    v_mfma_f32_16x16x32_bf16 v[200:203], a[44:47], a[64:67], v[200:203]
    v_mfma_f32_16x16x32_bf16 v[196:199], a[44:47], a[60:63], v[196:199]
    v_mfma_f32_16x16x32_bf16 v[192:195], a[44:47], a[56:59], v[192:195]
    v_mfma_f32_16x16x32_bf16 v[208:211], a[48:51], a[56:59], v[208:211]
    buffer_load_dwordx4 v3, s[16:19], s73 offen offset:1024 lds
    v_mfma_f32_16x16x32_bf16 v[212:215], a[48:51], a[60:63], v[212:215]
    s_add_u32 s72, s72, 229376
    v_mfma_f32_16x16x32_bf16 v[216:219], a[48:51], a[64:67], v[216:219]
    s_cmp_eq_u32 s72, 7340032
    s_cselect_b32 s72, 0, s72
    v_mfma_f32_16x16x32_bf16 v[220:223], a[48:51], a[68:71], v[220:223]
    s_add_u32 s73, s72, 27648
    v_mfma_f32_16x16x32_bf16 a[208:211], a[52:55], a[68:71], a[208:211]
    v_mfma_f32_16x16x32_bf16 a[204:207], a[52:55], a[64:67], a[204:207]
    v_mfma_f32_16x16x32_bf16 a[200:203], a[52:55], a[60:63], a[200:203]
    v_mfma_f32_16x16x32_bf16 a[196:199], a[52:55], a[56:59], a[196:199]
    s_waitcnt vmcnt(16) lgkmcnt(0)
    s_barrier
    v_mfma_f32_16x16x32_bf16 v[32:35], a[72:75], a[128:131], v[32:35]
    ds_read_b64_tr_b16 a[0:1], v8 offset:32768
    s_add_u32 s75, s75, 8192
    v_mfma_f32_16x16x32_bf16 v[36:39], a[72:75], a[132:135], v[36:39]
    s_cmp_eq_u32 s75, 24576
    s_cselect_b32 s75, 0, s75
    v_mfma_f32_16x16x32_bf16 v[40:43], a[72:75], a[136:139], v[40:43]
    ds_read_b64_tr_b16 a[2:3], v8 offset:33792
    v_add_u32 v17, s75, v15
    v_mfma_f32_16x16x32_bf16 v[44:47], a[72:75], a[140:143], v[44:47]
    ds_read_b64_tr_b16 a[4:5], v9 offset:32768
    s_mov_b32 m0, s76
    v_mfma_f32_16x16x32_bf16 v[60:63], a[76:79], a[140:143], v[60:63]
    ds_read_b64_tr_b16 a[6:7], v9 offset:33792
    buffer_load_dwordx4 v4, s[8:11], s77 offen lds
    v_mfma_f32_16x16x32_bf16 v[56:59], a[76:79], a[136:139], v[56:59]
    ds_read_b128 a[56:59], v17 offset:0
    v_mfma_f32_16x16x32_bf16 v[52:55], a[76:79], a[132:135], v[52:55]
    ds_read_b128 a[60:63], v17 offset:2048
    v_mfma_f32_16x16x32_bf16 v[48:51], a[76:79], a[128:131], v[48:51]
    ds_read_b128 a[64:67], v17 offset:4096
    v_mfma_f32_16x16x32_bf16 v[64:67], a[80:83], a[128:131], v[64:67]
    ds_read_b128 a[68:71], v17 offset:6144
    v_mfma_f32_16x16x32_bf16 v[68:71], a[80:83], a[132:135], v[68:71]
    ds_read_b64_tr_b16 a[8:9], v10 offset:32768
    v_mfma_f32_16x16x32_bf16 v[72:75], a[80:83], a[136:139], v[72:75]
    ds_read_b64_tr_b16 a[10:11], v10 offset:33792
    buffer_load_dwordx4 v5, s[8:11], s77 offen offset:1024 lds
    v_mfma_f32_16x16x32_bf16 v[76:79], a[80:83], a[140:143], v[76:79]
    ds_read_b64_tr_b16 a[12:13], v11 offset:32768
    v_mfma_f32_16x16x32_bf16 v[92:95], a[84:87], a[140:143], v[92:95]
    ds_read_b64_tr_b16 a[14:15], v11 offset:33792
    v_mfma_f32_16x16x32_bf16 v[88:91], a[84:87], a[136:139], v[88:91]
    ds_read_b64_tr_b16 a[16:17], v12 offset:32768
    v_mfma_f32_16x16x32_bf16 v[84:87], a[84:87], a[132:135], v[84:87]
    ds_read_b64_tr_b16 a[18:19], v12 offset:33792
    v_mfma_f32_16x16x32_bf16 v[80:83], a[84:87], a[128:131], v[80:83]
    ds_read_b64_tr_b16 a[20:21], v13 offset:32768
    v_mfma_f32_16x16x32_bf16 v[96:99], a[88:91], a[128:131], v[96:99]
    ds_read_b64_tr_b16 a[22:23], v13 offset:33792
    buffer_load_dwordx4 v6, s[8:11], s77 offen offset:2048 lds
    v_mfma_f32_16x16x32_bf16 v[100:103], a[88:91], a[132:135], v[100:103]
    ds_read_b64_tr_b16 a[24:25], v14 offset:32768
    v_mfma_f32_16x16x32_bf16 v[104:107], a[88:91], a[136:139], v[104:107]
    ds_read_b64_tr_b16 a[26:27], v14 offset:33792
    v_mfma_f32_16x16x32_bf16 v[108:111], a[88:91], a[140:143], v[108:111]
    ds_read_b64_tr_b16 a[28:29], v8 offset:40960
    v_mfma_f32_16x16x32_bf16 v[124:127], a[92:95], a[140:143], v[124:127]
    ds_read_b64_tr_b16 a[30:31], v8 offset:41984
    v_mfma_f32_16x16x32_bf16 v[120:123], a[92:95], a[136:139], v[120:123]
    ds_read_b64_tr_b16 a[32:33], v9 offset:40960
    v_mfma_f32_16x16x32_bf16 v[116:119], a[92:95], a[132:135], v[116:119]
    ds_read_b64_tr_b16 a[34:35], v9 offset:41984
    v_mfma_f32_16x16x32_bf16 v[112:115], a[92:95], a[128:131], v[112:115]
    ds_read_b64_tr_b16 a[36:37], v10 offset:40960
    buffer_load_dwordx4 v7, s[8:11], s77 offen offset:3072 lds
    v_mfma_f32_16x16x32_bf16 a[180:183], a[96:99], a[128:131], a[180:183]
    ds_read_b64_tr_b16 a[38:39], v10 offset:41984
    v_mfma_f32_16x16x32_bf16 a[184:187], a[96:99], a[132:135], a[184:187]
    ds_read_b64_tr_b16 a[40:41], v11 offset:40960
    v_mfma_f32_16x16x32_bf16 a[188:191], a[96:99], a[136:139], a[188:191]
    ds_read_b64_tr_b16 a[42:43], v11 offset:41984
    v_mfma_f32_16x16x32_bf16 a[192:195], a[96:99], a[140:143], a[192:195]
    ds_read_b64_tr_b16 a[44:45], v12 offset:40960
    v_mfma_f32_16x16x32_bf16 v[140:143], a[100:103], a[140:143], v[140:143]
    ds_read_b64_tr_b16 a[46:47], v12 offset:41984
    s_add_u32 m0, s71, 16384
    v_mfma_f32_16x16x32_bf16 v[136:139], a[100:103], a[136:139], v[136:139]
    ds_read_b64_tr_b16 a[48:49], v13 offset:40960
    buffer_load_dwordx4 v3, s[12:15], s72 offen lds
    v_mfma_f32_16x16x32_bf16 v[132:135], a[100:103], a[132:135], v[132:135]
    ds_read_b64_tr_b16 a[50:51], v13 offset:41984
    v_mfma_f32_16x16x32_bf16 v[128:131], a[100:103], a[128:131], v[128:131]
    ds_read_b64_tr_b16 a[52:53], v14 offset:40960
    v_mfma_f32_16x16x32_bf16 v[144:147], a[104:107], a[128:131], v[144:147]
    ds_read_b64_tr_b16 a[54:55], v14 offset:41984
    v_mfma_f32_16x16x32_bf16 v[148:151], a[104:107], a[132:135], v[148:151]
    v_mfma_f32_16x16x32_bf16 v[152:155], a[104:107], a[136:139], v[152:155]
    v_mfma_f32_16x16x32_bf16 v[156:159], a[104:107], a[140:143], v[156:159]
    buffer_load_dwordx4 v3, s[12:15], s73 offen offset:1024 lds
    v_mfma_f32_16x16x32_bf16 v[172:175], a[108:111], a[140:143], v[172:175]
    v_mfma_f32_16x16x32_bf16 v[168:171], a[108:111], a[136:139], v[168:171]
    v_mfma_f32_16x16x32_bf16 v[164:167], a[108:111], a[132:135], v[164:167]
    v_mfma_f32_16x16x32_bf16 v[160:163], a[108:111], a[128:131], v[160:163]
    v_mfma_f32_16x16x32_bf16 v[176:179], a[112:115], a[128:131], v[176:179]
    v_mfma_f32_16x16x32_bf16 v[180:183], a[112:115], a[132:135], v[180:183]
    s_add_u32 m0, s71, 24576
    v_mfma_f32_16x16x32_bf16 v[184:187], a[112:115], a[136:139], v[184:187]
    buffer_load_dwordx4 v3, s[16:19], s72 offen lds
    v_mfma_f32_16x16x32_bf16 v[188:191], a[112:115], a[140:143], v[188:191]
    v_mfma_f32_16x16x32_bf16 v[204:207], a[116:119], a[140:143], v[204:207]
    v_mfma_f32_16x16x32_bf16 v[200:203], a[116:119], a[136:139], v[200:203]
    v_mfma_f32_16x16x32_bf16 v[196:199], a[116:119], a[132:135], v[196:199]
    v_mfma_f32_16x16x32_bf16 v[192:195], a[116:119], a[128:131], v[192:195]
    v_mfma_f32_16x16x32_bf16 v[208:211], a[120:123], a[128:131], v[208:211]
    buffer_load_dwordx4 v3, s[16:19], s73 offen offset:1024 lds
    v_mfma_f32_16x16x32_bf16 v[212:215], a[120:123], a[132:135], v[212:215]
    s_add_u32 s72, s72, 229376
    v_mfma_f32_16x16x32_bf16 v[216:219], a[120:123], a[136:139], v[216:219]
    s_cmp_eq_u32 s72, 7340032
    s_cselect_b32 s72, 0, s72
    v_mfma_f32_16x16x32_bf16 v[220:223], a[120:123], a[140:143], v[220:223]
    s_add_u32 s73, s72, 27648
    v_mfma_f32_16x16x32_bf16 a[208:211], a[124:127], a[140:143], a[208:211]
    v_mfma_f32_16x16x32_bf16 a[204:207], a[124:127], a[136:139], a[204:207]
    v_mfma_f32_16x16x32_bf16 a[200:203], a[124:127], a[132:135], a[200:203]
    v_mfma_f32_16x16x32_bf16 a[196:199], a[124:127], a[128:131], a[196:199]
    s_waitcnt vmcnt(16) lgkmcnt(0)
    s_barrier
    v_mfma_f32_16x16x32_bf16 v[32:35], a[0:3], a[56:59], v[32:35]
    ds_read_b64_tr_b16 a[72:73], v8 offset:49152
    v_add_u32 v17, s75, v16
    v_mfma_f32_16x16x32_bf16 v[36:39], a[0:3], a[60:63], v[36:39]
    ds_read_b64_tr_b16 a[74:75], v8 offset:50176
    v_mfma_f32_16x16x32_bf16 v[40:43], a[0:3], a[64:67], v[40:43]
    ds_read_b64_tr_b16 a[76:77], v9 offset:49152
    s_add_u32 m0, s76, 4096
    v_mfma_f32_16x16x32_bf16 v[44:47], a[0:3], a[68:71], v[44:47]
    ds_read_b64_tr_b16 a[78:79], v9 offset:50176
    s_add_u32 s79, s77, 0x10000
    v_mfma_f32_16x16x32_bf16 v[60:63], a[4:7], a[68:71], v[60:63]
    ds_read_b128 a[128:131], v17 offset:0
    buffer_load_dwordx4 v4, s[8:11], s79 offen lds
    v_mfma_f32_16x16x32_bf16 v[56:59], a[4:7], a[64:67], v[56:59]
    ds_read_b128 a[132:135], v17 offset:2048
    v_mfma_f32_16x16x32_bf16 v[52:55], a[4:7], a[60:63], v[52:55]
    ds_read_b128 a[136:139], v17 offset:4096
    v_mfma_f32_16x16x32_bf16 v[48:51], a[4:7], a[56:59], v[48:51]
    ds_read_b128 a[140:143], v17 offset:6144
    v_mfma_f32_16x16x32_bf16 v[64:67], a[8:11], a[56:59], v[64:67]
    ds_read_b64_tr_b16 a[80:81], v10 offset:49152
    v_mfma_f32_16x16x32_bf16 v[68:71], a[8:11], a[60:63], v[68:71]
    ds_read_b64_tr_b16 a[82:83], v10 offset:50176
    buffer_load_dwordx4 v5, s[8:11], s79 offen offset:1024 lds
    v_mfma_f32_16x16x32_bf16 v[72:75], a[8:11], a[64:67], v[72:75]
    ds_read_b64_tr_b16 a[84:85], v11 offset:49152
    v_mfma_f32_16x16x32_bf16 v[76:79], a[8:11], a[68:71], v[76:79]
    ds_read_b64_tr_b16 a[86:87], v11 offset:50176
    v_mfma_f32_16x16x32_bf16 v[92:95], a[12:15], a[68:71], v[92:95]
    ds_read_b64_tr_b16 a[88:89], v12 offset:49152
    v_and_b32 v19, 15, v0
    v_mfma_f32_16x16x32_bf16 v[88:91], a[12:15], a[64:67], v[88:91]
    ds_read_b64_tr_b16 a[90:91], v12 offset:50176
    v_mfma_f32_16x16x32_bf16 v[84:87], a[12:15], a[60:63], v[84:87]
    ds_read_b64_tr_b16 a[92:93], v13 offset:49152
    v_mfma_f32_16x16x32_bf16 v[80:83], a[12:15], a[56:59], v[80:83]
    ds_read_b64_tr_b16 a[94:95], v13 offset:50176
    buffer_load_dwordx4 v6, s[8:11], s79 offen offset:2048 lds
    v_mfma_f32_16x16x32_bf16 v[96:99], a[16:19], a[56:59], v[96:99]
    ds_read_b64_tr_b16 a[96:97], v14 offset:49152
    v_lshlrev_b32 v19, 3, v19
    v_mfma_f32_16x16x32_bf16 v[100:103], a[16:19], a[60:63], v[100:103]
    ds_read_b64_tr_b16 a[98:99], v14 offset:50176
    v_mfma_f32_16x16x32_bf16 v[104:107], a[16:19], a[64:67], v[104:107]
    ds_read_b64_tr_b16 a[100:101], v8 offset:57344
    v_mfma_f32_16x16x32_bf16 v[108:111], a[16:19], a[68:71], v[108:111]
    ds_read_b64_tr_b16 a[102:103], v8 offset:58368
    v_mfma_f32_16x16x32_bf16 v[124:127], a[20:23], a[68:71], v[124:127]
    ds_read_b64_tr_b16 a[104:105], v9 offset:57344
    v_mfma_f32_16x16x32_bf16 v[120:123], a[20:23], a[64:67], v[120:123]
    ds_read_b64_tr_b16 a[106:107], v9 offset:58368
    buffer_load_dwordx4 v7, s[8:11], s79 offen offset:3072 lds
    v_mfma_f32_16x16x32_bf16 v[116:119], a[20:23], a[60:63], v[116:119]
    ds_read_b64_tr_b16 a[108:109], v10 offset:57344
    s_add_u32 s77, s77, 128
    v_mfma_f32_16x16x32_bf16 v[112:115], a[20:23], a[56:59], v[112:115]
    ds_read_b64_tr_b16 a[110:111], v10 offset:58368
    s_and_b32 s77, s77, 0x7ff
    v_mfma_f32_16x16x32_bf16 a[180:183], a[24:27], a[56:59], a[180:183]
    ds_read_b64_tr_b16 a[112:113], v11 offset:57344
    s_add_u32 s76, s76, 8192
    v_mfma_f32_16x16x32_bf16 a[184:187], a[24:27], a[60:63], a[184:187]
    s_cmp_eq_u32 s76, s91
    s_cselect_b32 s76, s70, s76
    s_lshl_b32 s85, s65, 11
    v_mfma_f32_16x16x32_bf16 a[188:191], a[24:27], a[64:67], a[188:191]
    ds_read_b64_tr_b16 a[114:115], v11 offset:58368
    s_add_u32 m0, s71, 32768
    v_mfma_f32_16x16x32_bf16 a[192:195], a[24:27], a[68:71], a[192:195]
    ds_read_b64_tr_b16 a[116:117], v12 offset:57344
    buffer_load_dwordx4 v3, s[12:15], s72 offen lds
    v_mfma_f32_16x16x32_bf16 v[140:143], a[28:31], a[68:71], v[140:143]
    ds_read_b64_tr_b16 a[118:119], v12 offset:58368
    s_lshl_b32 s3, s64, 9
    v_mfma_f32_16x16x32_bf16 v[136:139], a[28:31], a[64:67], v[136:139]
    ds_read_b64_tr_b16 a[120:121], v13 offset:57344
    v_mfma_f32_16x16x32_bf16 v[132:135], a[28:31], a[60:63], v[132:135]
    ds_read_b64_tr_b16 a[122:123], v13 offset:58368
    v_mfma_f32_16x16x32_bf16 v[128:131], a[28:31], a[56:59], v[128:131]
    ds_read_b64_tr_b16 a[124:125], v14 offset:57344
    v_mfma_f32_16x16x32_bf16 v[144:147], a[32:35], a[56:59], v[144:147]
    ds_read_b64_tr_b16 a[126:127], v14 offset:58368
    buffer_load_dwordx4 v3, s[12:15], s73 offen offset:1024 lds
    v_mfma_f32_16x16x32_bf16 v[148:151], a[32:35], a[60:63], v[148:151]
    v_mfma_f32_16x16x32_bf16 v[152:155], a[32:35], a[64:67], v[152:155]
    v_mfma_f32_16x16x32_bf16 v[156:159], a[32:35], a[68:71], v[156:159]
    s_add_u32 s85, s85, s3
    v_mfma_f32_16x16x32_bf16 v[172:175], a[36:39], a[68:71], v[172:175]
    v_mfma_f32_16x16x32_bf16 v[168:171], a[36:39], a[64:67], v[168:171]
    s_add_u32 m0, s71, 40960
    v_mfma_f32_16x16x32_bf16 v[164:167], a[36:39], a[60:63], v[164:167]
    buffer_load_dwordx4 v3, s[16:19], s72 offen lds
    v_mfma_f32_16x16x32_bf16 v[160:163], a[36:39], a[56:59], v[160:163]
    v_mfma_f32_16x16x32_bf16 v[176:179], a[40:43], a[56:59], v[176:179]
    v_mfma_f32_16x16x32_bf16 v[180:183], a[40:43], a[60:63], v[180:183]
    s_mul_i32 s83, s69, 4224
    v_mfma_f32_16x16x32_bf16 v[184:187], a[40:43], a[64:67], v[184:187]
    v_mfma_f32_16x16x32_bf16 v[188:191], a[40:43], a[68:71], v[188:191]
    buffer_load_dwordx4 v3, s[16:19], s73 offen offset:1024 lds
    v_mfma_f32_16x16x32_bf16 v[204:207], a[44:47], a[68:71], v[204:207]
    v_mfma_f32_16x16x32_bf16 v[200:203], a[44:47], a[64:67], v[200:203]
    v_mfma_f32_16x16x32_bf16 v[196:199], a[44:47], a[60:63], v[196:199]
    s_add_u32 s72, s72, 229376
    v_mfma_f32_16x16x32_bf16 v[192:195], a[44:47], a[56:59], v[192:195]
    s_cmp_eq_u32 s72, 7340032
    s_cselect_b32 s72, 0, s72
    s_lshl_b32 s84, s69, 12
    v_mfma_f32_16x16x32_bf16 v[208:211], a[48:51], a[56:59], v[208:211]
    s_add_u32 s73, s72, 27648
    v_mfma_f32_16x16x32_bf16 v[212:215], a[48:51], a[60:63], v[212:215]
    buffer_load_dword v18, v27, s[40:43], 0 offen sc1
    v_mfma_f32_16x16x32_bf16 v[216:219], a[48:51], a[64:67], v[216:219]
    v_mfma_f32_16x16x32_bf16 v[220:223], a[48:51], a[68:71], v[220:223]
    v_mfma_f32_16x16x32_bf16 a[208:211], a[52:55], a[68:71], a[208:211]
    v_mfma_f32_16x16x32_bf16 a[204:207], a[52:55], a[64:67], a[204:207]
    v_mfma_f32_16x16x32_bf16 a[200:203], a[52:55], a[60:63], a[200:203]
    v_mfma_f32_16x16x32_bf16 a[196:199], a[52:55], a[56:59], a[196:199]
    s_waitcnt vmcnt(17) lgkmcnt(0)
    s_barrier
    v_mfma_f32_16x16x32_bf16 v[32:35], a[72:75], a[128:131], v[32:35]
    ds_read_b64_tr_b16 a[0:1], v8 offset:0
    s_add_u32 s75, s75, 8192
    v_mfma_f32_16x16x32_bf16 v[36:39], a[72:75], a[132:135], v[36:39]
    s_cmp_eq_u32 s75, 24576
    s_cselect_b32 s75, 0, s75
    v_mfma_f32_16x16x32_bf16 v[40:43], a[72:75], a[136:139], v[40:43]
    ds_read_b64_tr_b16 a[2:3], v8 offset:1024
    v_add_u32 v17, s75, v15
    v_mfma_f32_16x16x32_bf16 v[44:47], a[72:75], a[140:143], v[44:47]
    ds_read_b64_tr_b16 a[4:5], v9 offset:0
    s_add_u32 m0, s71, 49152
    v_mfma_f32_16x16x32_bf16 v[60:63], a[76:79], a[140:143], v[60:63]
    ds_read_b64_tr_b16 a[6:7], v9 offset:1024
    buffer_load_dwordx4 v3, s[12:15], s72 offen lds
    v_mfma_f32_16x16x32_bf16 v[56:59], a[76:79], a[136:139], v[56:59]
    ds_read_b128 a[56:59], v17 offset:0
    v_mfma_f32_16x16x32_bf16 v[52:55], a[76:79], a[132:135], v[52:55]
    ds_read_b128 a[60:63], v17 offset:2048
    v_mfma_f32_16x16x32_bf16 v[48:51], a[76:79], a[128:131], v[48:51]
    ds_read_b128 a[64:67], v17 offset:4096
    v_mfma_f32_16x16x32_bf16 v[64:67], a[80:83], a[128:131], v[64:67]
    ds_read_b128 a[68:71], v17 offset:6144
    buffer_load_dwordx4 v3, s[12:15], s73 offen offset:1024 lds
    v_mfma_f32_16x16x32_bf16 v[68:71], a[80:83], a[132:135], v[68:71]
    ds_read_b64_tr_b16 a[8:9], v10 offset:0
    v_mfma_f32_16x16x32_bf16 v[72:75], a[80:83], a[136:139], v[72:75]
    ds_read_b64_tr_b16 a[10:11], v10 offset:1024
    v_mfma_f32_16x16x32_bf16 v[76:79], a[80:83], a[140:143], v[76:79]
    ds_read_b64_tr_b16 a[12:13], v11 offset:0
    v_mfma_f32_16x16x32_bf16 v[92:95], a[84:87], a[140:143], v[92:95]
    ds_read_b64_tr_b16 a[14:15], v11 offset:1024
    s_add_u32 m0, s71, 57344
    v_mfma_f32_16x16x32_bf16 v[88:91], a[84:87], a[136:139], v[88:91]
    ds_read_b64_tr_b16 a[16:17], v12 offset:0
    buffer_load_dwordx4 v3, s[16:19], s72 offen lds
    v_mfma_f32_16x16x32_bf16 v[84:87], a[84:87], a[132:135], v[84:87]
    ds_read_b64_tr_b16 a[18:19], v12 offset:1024
    v_mfma_f32_16x16x32_bf16 v[80:83], a[84:87], a[128:131], v[80:83]
    ds_read_b64_tr_b16 a[20:21], v13 offset:0
    v_mfma_f32_16x16x32_bf16 v[96:99], a[88:91], a[128:131], v[96:99]
    ds_read_b64_tr_b16 a[22:23], v13 offset:1024
    v_mfma_f32_16x16x32_bf16 v[100:103], a[88:91], a[132:135], v[100:103]
    ds_read_b64_tr_b16 a[24:25], v14 offset:0
    buffer_load_dwordx4 v3, s[16:19], s73 offen offset:1024 lds
    v_mfma_f32_16x16x32_bf16 v[104:107], a[88:91], a[136:139], v[104:107]
    ds_read_b64_tr_b16 a[26:27], v14 offset:1024
    s_add_u32 s72, s72, 229376
    v_mfma_f32_16x16x32_bf16 v[108:111], a[88:91], a[140:143], v[108:111]
    s_cmp_eq_u32 s72, 7340032
    s_cselect_b32 s72, 0, s72
    v_mfma_f32_16x16x32_bf16 v[124:127], a[92:95], a[140:143], v[124:127]
    ds_read_b64_tr_b16 a[28:29], v8 offset:8192
    s_add_u32 s73, s72, 27648
    v_mfma_f32_16x16x32_bf16 v[120:123], a[92:95], a[136:139], v[120:123]
    ds_read_b64_tr_b16 a[30:31], v8 offset:9216
    s_mul_i32 s74, s69, 7168
    v_mfma_f32_16x16x32_bf16 v[116:119], a[92:95], a[132:135], v[116:119]
    ds_read_b64_tr_b16 a[32:33], v9 offset:8192
    buffer_load_dwordx4 a[252:255], v2, s[44:47], s74 offen offset:0
    v_mfma_f32_16x16x32_bf16 v[112:115], a[92:95], a[128:131], v[112:115]
    ds_read_b64_tr_b16 a[34:35], v9 offset:9216
    v_mfma_f32_16x16x32_bf16 a[180:183], a[96:99], a[128:131], a[180:183]
    ds_read_b64_tr_b16 a[36:37], v10 offset:8192
    v_mfma_f32_16x16x32_bf16 a[184:187], a[96:99], a[132:135], a[184:187]
    ds_read_b64_tr_b16 a[38:39], v10 offset:9216
    v_mfma_f32_16x16x32_bf16 a[188:191], a[96:99], a[136:139], a[188:191]
    ds_read_b64_tr_b16 a[40:41], v11 offset:8192
    v_mfma_f32_16x16x32_bf16 a[192:195], a[96:99], a[140:143], a[192:195]
    ds_read_b64_tr_b16 a[42:43], v11 offset:9216
    buffer_load_dwordx4 a[252:255], v2, s[44:47], s74 offen offset:1024
    v_mfma_f32_16x16x32_bf16 v[140:143], a[100:103], a[140:143], v[140:143]
    ds_read_b64_tr_b16 a[44:45], v12 offset:8192
    v_mfma_f32_16x16x32_bf16 v[136:139], a[100:103], a[136:139], v[136:139]
    ds_read_b64_tr_b16 a[46:47], v12 offset:9216
    v_mfma_f32_16x16x32_bf16 v[132:135], a[100:103], a[132:135], v[132:135]
    ds_read_b64_tr_b16 a[48:49], v13 offset:8192
    v_mfma_f32_16x16x32_bf16 v[128:131], a[100:103], a[128:131], v[128:131]
    ds_read_b64_tr_b16 a[50:51], v13 offset:9216
    buffer_load_dwordx4 a[252:255], v2, s[44:47], s74 offen offset:2048
    v_mfma_f32_16x16x32_bf16 v[144:147], a[104:107], a[128:131], v[144:147]
    ds_read_b64_tr_b16 a[52:53], v14 offset:8192
    v_mfma_f32_16x16x32_bf16 v[148:151], a[104:107], a[132:135], v[148:151]
    ds_read_b64_tr_b16 a[54:55], v14 offset:9216
    v_mfma_f32_16x16x32_bf16 v[152:155], a[104:107], a[136:139], v[152:155]
    v_mfma_f32_16x16x32_bf16 v[156:159], a[104:107], a[140:143], v[156:159]
    v_mfma_f32_16x16x32_bf16 v[172:175], a[108:111], a[140:143], v[172:175]
    buffer_load_dwordx4 a[252:255], v2, s[44:47], s74 offen offset:3072
    v_mfma_f32_16x16x32_bf16 v[168:171], a[108:111], a[136:139], v[168:171]
    v_mfma_f32_16x16x32_bf16 v[164:167], a[108:111], a[132:135], v[164:167]
    v_mfma_f32_16x16x32_bf16 v[160:163], a[108:111], a[128:131], v[160:163]
    v_mfma_f32_16x16x32_bf16 v[176:179], a[112:115], a[128:131], v[176:179]
    s_add_u32 s74, s74, 4096
    v_mfma_f32_16x16x32_bf16 v[180:183], a[112:115], a[132:135], v[180:183]
    buffer_load_dwordx4 a[252:255], v2, s[44:47], s74 offen offset:0
    v_mfma_f32_16x16x32_bf16 v[184:187], a[112:115], a[136:139], v[184:187]
    v_mfma_f32_16x16x32_bf16 v[188:191], a[112:115], a[140:143], v[188:191]
    v_mfma_f32_16x16x32_bf16 v[204:207], a[116:119], a[140:143], v[204:207]
    v_mfma_f32_16x16x32_bf16 v[200:203], a[116:119], a[136:139], v[200:203]
    buffer_load_dwordx4 a[252:255], v2, s[44:47], s74 offen offset:1024
    v_mfma_f32_16x16x32_bf16 v[196:199], a[116:119], a[132:135], v[196:199]
    v_mfma_f32_16x16x32_bf16 v[192:195], a[116:119], a[128:131], v[192:195]
    v_mfma_f32_16x16x32_bf16 v[208:211], a[120:123], a[128:131], v[208:211]
    v_mfma_f32_16x16x32_bf16 v[212:215], a[120:123], a[132:135], v[212:215]
    v_mfma_f32_16x16x32_bf16 v[216:219], a[120:123], a[136:139], v[216:219]
    buffer_load_dwordx4 a[252:255], v2, s[44:47], s74 offen offset:2048
    v_mfma_f32_16x16x32_bf16 v[220:223], a[120:123], a[140:143], v[220:223]
    v_mfma_f32_16x16x32_bf16 a[208:211], a[124:127], a[140:143], a[208:211]
    v_mfma_f32_16x16x32_bf16 a[204:207], a[124:127], a[136:139], a[204:207]
    v_mfma_f32_16x16x32_bf16 a[200:203], a[124:127], a[132:135], a[200:203]
    v_mfma_f32_16x16x32_bf16 a[196:199], a[124:127], a[128:131], a[196:199]
    s_waitcnt vmcnt(11) lgkmcnt(0)
    s_barrier
    s_mov_b32 s82, 0
L_f0_chk:
    v_cmp_le_u32 vcc, 0x80, v18
    s_cmp_eq_u64 vcc, exec
    s_cbranch_scc1 L_f0_ok
    s_sleep 1
    buffer_load_dword v18, v27, s[40:43], 0 offen sc1
    s_waitcnt vmcnt(0)
    s_add_u32 s82, s82, 1
    s_cmp_lt_u32 s82, 200000
    s_cbranch_scc1 L_f0_chk
L_f0_ok:
    v_mfma_f32_16x16x32_bf16 v[32:35], a[0:3], a[56:59], v[32:35]
    ds_read_b64_tr_b16 a[72:73], v8 offset:16384
    v_add_u32 v17, s75, v16
    v_mfma_f32_16x16x32_bf16 v[36:39], a[0:3], a[60:63], v[36:39]
    ds_read_b64_tr_b16 a[74:75], v8 offset:17408
    v_mfma_f32_16x16x32_bf16 v[40:43], a[0:3], a[64:67], v[40:43]
    ds_read_b64_tr_b16 a[76:77], v9 offset:16384
    v_mfma_f32_16x16x32_bf16 v[44:47], a[0:3], a[68:71], v[44:47]
    ds_read_b64_tr_b16 a[78:79], v9 offset:17408
    s_add_u32 m0, s71, 0
    v_mfma_f32_16x16x32_bf16 v[60:63], a[4:7], a[68:71], v[60:63]
    ds_read_b128 a[128:131], v17 offset:0
    buffer_load_dwordx4 v28, s[36:39], 0 offen sc1 lds
    v_mfma_f32_16x16x32_bf16 v[56:59], a[4:7], a[64:67], v[56:59]
    ds_read_b128 a[132:135], v17 offset:2048
    v_mfma_f32_16x16x32_bf16 v[52:55], a[4:7], a[60:63], v[52:55]
    ds_read_b128 a[136:139], v17 offset:4096
    v_mfma_f32_16x16x32_bf16 v[48:51], a[4:7], a[56:59], v[48:51]
    ds_read_b128 a[140:143], v17 offset:6144
    v_mfma_f32_16x16x32_bf16 v[64:67], a[8:11], a[56:59], v[64:67]
    ds_read_b64_tr_b16 a[80:81], v10 offset:16384
    v_mfma_f32_16x16x32_bf16 v[68:71], a[8:11], a[60:63], v[68:71]
    ds_read_b64_tr_b16 a[82:83], v10 offset:17408
    v_mfma_f32_16x16x32_bf16 v[72:75], a[8:11], a[64:67], v[72:75]
    ds_read_b64_tr_b16 a[84:85], v11 offset:16384
    buffer_load_dwordx4 v28, s[36:39], 0 offen offset:1024 sc1 lds
    v_mfma_f32_16x16x32_bf16 v[76:79], a[8:11], a[68:71], v[76:79]
    ds_read_b64_tr_b16 a[86:87], v11 offset:17408
    v_mfma_f32_16x16x32_bf16 v[92:95], a[12:15], a[68:71], v[92:95]
    ds_read_b64_tr_b16 a[88:89], v12 offset:16384
    v_mfma_f32_16x16x32_bf16 v[88:91], a[12:15], a[64:67], v[88:91]
    ds_read_b64_tr_b16 a[90:91], v12 offset:17408
    v_mfma_f32_16x16x32_bf16 v[84:87], a[12:15], a[60:63], v[84:87]
    ds_read_b64_tr_b16 a[92:93], v13 offset:16384
    s_add_u32 m0, s71, 8192
    v_mfma_f32_16x16x32_bf16 v[80:83], a[12:15], a[56:59], v[80:83]
    ds_read_b64_tr_b16 a[94:95], v13 offset:17408
    s_movk_i32 s78, 6144
    v_mfma_f32_16x16x32_bf16 v[96:99], a[16:19], a[56:59], v[96:99]
    ds_read_b64_tr_b16 a[96:97], v14 offset:16384
    buffer_load_dwordx4 v28, s[36:39], s78 offen sc1 lds
    v_mfma_f32_16x16x32_bf16 v[100:103], a[16:19], a[60:63], v[100:103]
    ds_read_b64_tr_b16 a[98:99], v14 offset:17408
    v_mfma_f32_16x16x32_bf16 v[104:107], a[16:19], a[64:67], v[104:107]
    ds_read_b64_tr_b16 a[100:101], v8 offset:24576
    v_mfma_f32_16x16x32_bf16 v[108:111], a[16:19], a[68:71], v[108:111]
    ds_read_b64_tr_b16 a[102:103], v8 offset:25600
    v_mfma_f32_16x16x32_bf16 v[124:127], a[20:23], a[68:71], v[124:127]
    ds_read_b64_tr_b16 a[104:105], v9 offset:24576
    v_mfma_f32_16x16x32_bf16 v[120:123], a[20:23], a[64:67], v[120:123]
    ds_read_b64_tr_b16 a[106:107], v9 offset:25600
    v_mfma_f32_16x16x32_bf16 v[116:119], a[20:23], a[60:63], v[116:119]
    ds_read_b64_tr_b16 a[108:109], v10 offset:24576
    v_mfma_f32_16x16x32_bf16 v[112:115], a[20:23], a[56:59], v[112:115]
    ds_read_b64_tr_b16 a[110:111], v10 offset:25600
    buffer_load_dwordx4 v28, s[36:39], s78 offen offset:1024 sc1 lds
    v_mfma_f32_16x16x32_bf16 a[180:183], a[24:27], a[56:59], a[180:183]
    ds_read_b64_tr_b16 a[112:113], v11 offset:24576
    v_mfma_f32_16x16x32_bf16 a[184:187], a[24:27], a[60:63], a[184:187]
    ds_read_b64_tr_b16 a[114:115], v11 offset:25600
    v_mfma_f32_16x16x32_bf16 a[188:191], a[24:27], a[64:67], a[188:191]
    ds_read_b64_tr_b16 a[116:117], v12 offset:24576
    v_mfma_f32_16x16x32_bf16 a[192:195], a[24:27], a[68:71], a[192:195]
    ds_read_b64_tr_b16 a[118:119], v12 offset:25600
    v_mfma_f32_16x16x32_bf16 v[140:143], a[28:31], a[68:71], v[140:143]
    ds_read_b64_tr_b16 a[120:121], v13 offset:24576
    v_mfma_f32_16x16x32_bf16 v[136:139], a[28:31], a[64:67], v[136:139]
    ds_read_b64_tr_b16 a[122:123], v13 offset:25600
    buffer_load_dwordx2 v[20:21], v19, s[36:39], s85 offen offset:0 sc1
    v_mfma_f32_16x16x32_bf16 v[132:135], a[28:31], a[60:63], v[132:135]
    ds_read_b64_tr_b16 a[124:125], v14 offset:24576
    v_mfma_f32_16x16x32_bf16 v[128:131], a[28:31], a[56:59], v[128:131]
    ds_read_b64_tr_b16 a[126:127], v14 offset:25600
    v_mfma_f32_16x16x32_bf16 v[144:147], a[32:35], a[56:59], v[144:147]
    v_mfma_f32_16x16x32_bf16 v[148:151], a[32:35], a[60:63], v[148:151]
    v_mfma_f32_16x16x32_bf16 v[152:155], a[32:35], a[64:67], v[152:155]
    v_mfma_f32_16x16x32_bf16 v[156:159], a[32:35], a[68:71], v[156:159]
    buffer_load_dwordx2 v[22:23], v19, s[36:39], s85 offen offset:128 sc1
    v_mfma_f32_16x16x32_bf16 v[172:175], a[36:39], a[68:71], v[172:175]
    v_mfma_f32_16x16x32_bf16 v[168:171], a[36:39], a[64:67], v[168:171]
    v_mfma_f32_16x16x32_bf16 v[164:167], a[36:39], a[60:63], v[164:167]
    v_mfma_f32_16x16x32_bf16 v[160:163], a[36:39], a[56:59], v[160:163]
    v_mfma_f32_16x16x32_bf16 v[176:179], a[40:43], a[56:59], v[176:179]
    v_mfma_f32_16x16x32_bf16 v[180:183], a[40:43], a[60:63], v[180:183]
    v_mfma_f32_16x16x32_bf16 v[184:187], a[40:43], a[64:67], v[184:187]
    buffer_load_dwordx2 v[24:25], v19, s[36:39], s85 offen offset:256 sc1
    v_mfma_f32_16x16x32_bf16 v[188:191], a[40:43], a[68:71], v[188:191]
    v_mfma_f32_16x16x32_bf16 v[204:207], a[44:47], a[68:71], v[204:207]
    v_mfma_f32_16x16x32_bf16 v[200:203], a[44:47], a[64:67], v[200:203]
    v_mfma_f32_16x16x32_bf16 v[196:199], a[44:47], a[60:63], v[196:199]
    v_mfma_f32_16x16x32_bf16 v[192:195], a[44:47], a[56:59], v[192:195]
    v_mfma_f32_16x16x32_bf16 v[208:211], a[48:51], a[56:59], v[208:211]
    buffer_load_dwordx2 v[26:27], v19, s[36:39], s85 offen offset:384 sc1
    v_mfma_f32_16x16x32_bf16 v[212:215], a[48:51], a[60:63], v[212:215]
    v_mfma_f32_16x16x32_bf16 v[216:219], a[48:51], a[64:67], v[216:219]
    v_mfma_f32_16x16x32_bf16 v[220:223], a[48:51], a[68:71], v[220:223]
    v_mfma_f32_16x16x32_bf16 a[208:211], a[52:55], a[68:71], a[208:211]
    v_mfma_f32_16x16x32_bf16 a[204:207], a[52:55], a[64:67], a[204:207]
    v_mfma_f32_16x16x32_bf16 a[200:203], a[52:55], a[60:63], a[200:203]
    v_mfma_f32_16x16x32_bf16 a[196:199], a[52:55], a[56:59], a[196:199]
    s_waitcnt vmcnt(20) lgkmcnt(0)
    s_barrier
    v_mfma_f32_16x16x32_bf16 v[32:35], a[72:75], a[128:131], v[32:35]
    ds_read_b64_tr_b16 a[0:1], v8 offset:32768
    s_add_u32 s75, s75, 8192
    v_mfma_f32_16x16x32_bf16 v[36:39], a[72:75], a[132:135], v[36:39]
    s_cmp_eq_u32 s75, 24576
    s_cselect_b32 s75, 0, s75
    v_mfma_f32_16x16x32_bf16 v[40:43], a[72:75], a[136:139], v[40:43]
    ds_read_b64_tr_b16 a[2:3], v8 offset:33792
    v_add_u32 v17, s75, v15
    v_mfma_f32_16x16x32_bf16 v[44:47], a[72:75], a[140:143], v[44:47]
    ds_read_b64_tr_b16 a[4:5], v9 offset:32768
    s_add_u32 m0, s70, 0
    v_mfma_f32_16x16x32_bf16 v[60:63], a[76:79], a[140:143], v[60:63]
    ds_read_b64_tr_b16 a[6:7], v9 offset:33792
    s_add_u32 s79, s83, 0
    v_mfma_f32_16x16x32_bf16 v[56:59], a[76:79], a[136:139], v[56:59]
    ds_read_b128 a[56:59], v17 offset:0
    buffer_load_dwordx4 v2, s[24:27], s79 offen sc1 lds
    v_mfma_f32_16x16x32_bf16 v[52:55], a[76:79], a[132:135], v[52:55]
    ds_read_b128 a[60:63], v17 offset:2048
    v_mfma_f32_16x16x32_bf16 v[48:51], a[76:79], a[128:131], v[48:51]
    ds_read_b128 a[64:67], v17 offset:4096
    v_mfma_f32_16x16x32_bf16 v[64:67], a[80:83], a[128:131], v[64:67]
    ds_read_b128 a[68:71], v17 offset:6144
    v_mfma_f32_16x16x32_bf16 v[68:71], a[80:83], a[132:135], v[68:71]
    ds_read_b64_tr_b16 a[8:9], v10 offset:32768
    v_mfma_f32_16x16x32_bf16 v[72:75], a[80:83], a[136:139], v[72:75]
    ds_read_b64_tr_b16 a[10:11], v10 offset:33792
    buffer_load_dwordx4 v2, s[24:27], s79 offen offset:1024 sc1 lds
    v_mfma_f32_16x16x32_bf16 v[76:79], a[80:83], a[140:143], v[76:79]
    ds_read_b64_tr_b16 a[12:13], v11 offset:32768
    v_mfma_f32_16x16x32_bf16 v[92:95], a[84:87], a[140:143], v[92:95]
    ds_read_b64_tr_b16 a[14:15], v11 offset:33792
    v_mfma_f32_16x16x32_bf16 v[88:91], a[84:87], a[136:139], v[88:91]
    ds_read_b64_tr_b16 a[16:17], v12 offset:32768
    v_mfma_f32_16x16x32_bf16 v[84:87], a[84:87], a[132:135], v[84:87]
    ds_read_b64_tr_b16 a[18:19], v12 offset:33792
    v_mfma_f32_16x16x32_bf16 v[80:83], a[84:87], a[128:131], v[80:83]
    ds_read_b64_tr_b16 a[20:21], v13 offset:32768
    v_mfma_f32_16x16x32_bf16 v[96:99], a[88:91], a[128:131], v[96:99]
    ds_read_b64_tr_b16 a[22:23], v13 offset:33792
    buffer_load_dwordx4 v2, s[24:27], s79 offen offset:2048 sc1 lds
    v_mfma_f32_16x16x32_bf16 v[100:103], a[88:91], a[132:135], v[100:103]
    ds_read_b64_tr_b16 a[24:25], v14 offset:32768
    v_mfma_f32_16x16x32_bf16 v[104:107], a[88:91], a[136:139], v[104:107]
    ds_read_b64_tr_b16 a[26:27], v14 offset:33792
    v_mfma_f32_16x16x32_bf16 v[108:111], a[88:91], a[140:143], v[108:111]
    ds_read_b64_tr_b16 a[28:29], v8 offset:40960
    v_mfma_f32_16x16x32_bf16 v[124:127], a[92:95], a[140:143], v[124:127]
    ds_read_b64_tr_b16 a[30:31], v8 offset:41984
    v_mfma_f32_16x16x32_bf16 v[120:123], a[92:95], a[136:139], v[120:123]
    ds_read_b64_tr_b16 a[32:33], v9 offset:40960
    v_mfma_f32_16x16x32_bf16 v[116:119], a[92:95], a[132:135], v[116:119]
    ds_read_b64_tr_b16 a[34:35], v9 offset:41984
    v_mfma_f32_16x16x32_bf16 v[112:115], a[92:95], a[128:131], v[112:115]
    ds_read_b64_tr_b16 a[36:37], v10 offset:40960
    buffer_load_dwordx4 v2, s[24:27], s79 offen offset:3072 sc1 lds
    v_mfma_f32_16x16x32_bf16 a[180:183], a[96:99], a[128:131], a[180:183]
    ds_read_b64_tr_b16 a[38:39], v10 offset:41984
    v_mfma_f32_16x16x32_bf16 a[184:187], a[96:99], a[132:135], a[184:187]
    ds_read_b64_tr_b16 a[40:41], v11 offset:40960
    v_mfma_f32_16x16x32_bf16 a[188:191], a[96:99], a[136:139], a[188:191]
    ds_read_b64_tr_b16 a[42:43], v11 offset:41984
    v_mfma_f32_16x16x32_bf16 a[192:195], a[96:99], a[140:143], a[192:195]
    ds_read_b64_tr_b16 a[44:45], v12 offset:40960
    s_add_u32 m0, s70, 8320
    v_mfma_f32_16x16x32_bf16 v[140:143], a[100:103], a[140:143], v[140:143]
    ds_read_b64_tr_b16 a[46:47], v12 offset:41984
    s_add_u32 s79, s83, 4
    v_mfma_f32_16x16x32_bf16 v[136:139], a[100:103], a[136:139], v[136:139]
    ds_read_b64_tr_b16 a[48:49], v13 offset:40960
    buffer_load_dwordx4 v2, s[24:27], s79 offen sc1 lds
    v_mfma_f32_16x16x32_bf16 v[132:135], a[100:103], a[132:135], v[132:135]
    ds_read_b64_tr_b16 a[50:51], v13 offset:41984
    v_mfma_f32_16x16x32_bf16 v[128:131], a[100:103], a[128:131], v[128:131]
    ds_read_b64_tr_b16 a[52:53], v14 offset:40960
    v_mfma_f32_16x16x32_bf16 v[144:147], a[104:107], a[128:131], v[144:147]
    ds_read_b64_tr_b16 a[54:55], v14 offset:41984
    v_mfma_f32_16x16x32_bf16 v[148:151], a[104:107], a[132:135], v[148:151]
    v_mfma_f32_16x16x32_bf16 v[152:155], a[104:107], a[136:139], v[152:155]
    v_mfma_f32_16x16x32_bf16 v[156:159], a[104:107], a[140:143], v[156:159]
    buffer_load_dwordx4 v2, s[24:27], s79 offen offset:1024 sc1 lds
    v_mfma_f32_16x16x32_bf16 v[172:175], a[108:111], a[140:143], v[172:175]
    v_mfma_f32_16x16x32_bf16 v[168:171], a[108:111], a[136:139], v[168:171]
    v_mfma_f32_16x16x32_bf16 v[164:167], a[108:111], a[132:135], v[164:167]
    v_mfma_f32_16x16x32_bf16 v[160:163], a[108:111], a[128:131], v[160:163]
    v_mfma_f32_16x16x32_bf16 v[176:179], a[112:115], a[128:131], v[176:179]
    v_mfma_f32_16x16x32_bf16 v[180:183], a[112:115], a[132:135], v[180:183]
    v_mfma_f32_16x16x32_bf16 v[184:187], a[112:115], a[136:139], v[184:187]
    buffer_load_dwordx4 v2, s[24:27], s79 offen offset:2048 sc1 lds
    v_mfma_f32_16x16x32_bf16 v[188:191], a[112:115], a[140:143], v[188:191]
    v_mfma_f32_16x16x32_bf16 v[204:207], a[116:119], a[140:143], v[204:207]
    v_mfma_f32_16x16x32_bf16 v[200:203], a[116:119], a[136:139], v[200:203]
    v_mfma_f32_16x16x32_bf16 v[196:199], a[116:119], a[132:135], v[196:199]
    v_mfma_f32_16x16x32_bf16 v[192:195], a[116:119], a[128:131], v[192:195]
    v_mfma_f32_16x16x32_bf16 v[208:211], a[120:123], a[128:131], v[208:211]
    buffer_load_dwordx4 v2, s[24:27], s79 offen offset:3072 sc1 lds
    v_mfma_f32_16x16x32_bf16 v[212:215], a[120:123], a[132:135], v[212:215]
    v_mfma_f32_16x16x32_bf16 v[216:219], a[120:123], a[136:139], v[216:219]
    v_mfma_f32_16x16x32_bf16 v[220:223], a[120:123], a[140:143], v[220:223]
    v_mfma_f32_16x16x32_bf16 a[208:211], a[124:127], a[140:143], a[208:211]
    v_mfma_f32_16x16x32_bf16 a[204:207], a[124:127], a[136:139], a[204:207]
    v_mfma_f32_16x16x32_bf16 a[200:203], a[124:127], a[132:135], a[200:203]
    v_mfma_f32_16x16x32_bf16 a[196:199], a[124:127], a[128:131], a[196:199]
    s_waitcnt vmcnt(23) lgkmcnt(0)
    s_barrier
    v_mfma_f32_16x16x32_bf16 v[32:35], a[0:3], a[56:59], v[32:35]
    ds_read_b64_tr_b16 a[72:73], v8 offset:49152
    v_add_u32 v17, s75, v16
    v_mfma_f32_16x16x32_bf16 v[36:39], a[0:3], a[60:63], v[36:39]
    ds_read_b64_tr_b16 a[74:75], v8 offset:50176
    v_mfma_f32_16x16x32_bf16 v[40:43], a[0:3], a[64:67], v[40:43]
    ds_read_b64_tr_b16 a[76:77], v9 offset:49152
    v_mfma_f32_16x16x32_bf16 v[44:47], a[0:3], a[68:71], v[44:47]
    ds_read_b64_tr_b16 a[78:79], v9 offset:50176
    v_mfma_f32_16x16x32_bf16 v[60:63], a[4:7], a[68:71], v[60:63]
    ds_read_b128 a[128:131], v17 offset:0
    v_mfma_f32_16x16x32_bf16 v[56:59], a[4:7], a[64:67], v[56:59]
    ds_read_b128 a[132:135], v17 offset:2048
    v_mfma_f32_16x16x32_bf16 v[52:55], a[4:7], a[60:63], v[52:55]
    ds_read_b128 a[136:139], v17 offset:4096
    v_mfma_f32_16x16x32_bf16 v[48:51], a[4:7], a[56:59], v[48:51]
    ds_read_b128 a[140:143], v17 offset:6144
    v_mfma_f32_16x16x32_bf16 v[64:67], a[8:11], a[56:59], v[64:67]
    ds_read_b64_tr_b16 a[80:81], v10 offset:49152
    v_mfma_f32_16x16x32_bf16 v[68:71], a[8:11], a[60:63], v[68:71]
    ds_read_b64_tr_b16 a[82:83], v10 offset:50176
    v_mfma_f32_16x16x32_bf16 v[72:75], a[8:11], a[64:67], v[72:75]
    ds_read_b64_tr_b16 a[84:85], v11 offset:49152
    v_mfma_f32_16x16x32_bf16 v[76:79], a[8:11], a[68:71], v[76:79]
    ds_read_b64_tr_b16 a[86:87], v11 offset:50176
    v_mfma_f32_16x16x32_bf16 v[92:95], a[12:15], a[68:71], v[92:95]
    ds_read_b64_tr_b16 a[88:89], v12 offset:49152
    v_and_b32 v3, 15, v0
    v_mfma_f32_16x16x32_bf16 v[88:91], a[12:15], a[64:67], v[88:91]
    ds_read_b64_tr_b16 a[90:91], v12 offset:50176
    v_lshrrev_b32 v28, 4, v0
    v_mfma_f32_16x16x32_bf16 v[84:87], a[12:15], a[60:63], v[84:87]
    ds_read_b64_tr_b16 a[92:93], v13 offset:49152
    v_mfma_f32_16x16x32_bf16 v[80:83], a[12:15], a[56:59], v[80:83]
    ds_read_b64_tr_b16 a[94:95], v13 offset:50176
    v_lshrrev_b32 v4, 2, v3
    v_mfma_f32_16x16x32_bf16 v[96:99], a[16:19], a[56:59], v[96:99]
    ds_read_b64_tr_b16 a[96:97], v14 offset:49152
    v_mfma_f32_16x16x32_bf16 v[100:103], a[16:19], a[60:63], v[100:103]
    ds_read_b64_tr_b16 a[98:99], v14 offset:50176
    v_mfma_f32_16x16x32_bf16 v[104:107], a[16:19], a[64:67], v[104:107]
    ds_read_b64_tr_b16 a[100:101], v8 offset:57344
    v_mul_u32_u24 v4, 4160, v4
    v_mfma_f32_16x16x32_bf16 v[108:111], a[16:19], a[68:71], v[108:111]
    ds_read_b64_tr_b16 a[102:103], v8 offset:58368
    v_mfma_f32_16x16x32_bf16 v[124:127], a[20:23], a[68:71], v[124:127]
    ds_read_b64_tr_b16 a[104:105], v9 offset:57344
    v_mfma_f32_16x16x32_bf16 v[120:123], a[20:23], a[64:67], v[120:123]
    ds_read_b64_tr_b16 a[106:107], v9 offset:58368
    v_and_b32 v6, 3, v0
    v_mfma_f32_16x16x32_bf16 v[116:119], a[20:23], a[60:63], v[116:119]
    ds_read_b64_tr_b16 a[108:109], v10 offset:57344
    v_mfma_f32_16x16x32_bf16 v[112:115], a[20:23], a[56:59], v[112:115]
    ds_read_b64_tr_b16 a[110:111], v10 offset:58368
    v_lshl_add_u32 v4, v6, 4, v4
    v_mfma_f32_16x16x32_bf16 a[180:183], a[24:27], a[56:59], a[180:183]
    ds_read_b64_tr_b16 a[112:113], v11 offset:57344
    v_mfma_f32_16x16x32_bf16 a[184:187], a[24:27], a[60:63], a[184:187]
    ds_read_b64_tr_b16 a[114:115], v11 offset:58368
    v_mfma_f32_16x16x32_bf16 a[188:191], a[24:27], a[64:67], a[188:191]
    ds_read_b64_tr_b16 a[116:117], v12 offset:57344
    v_add_u32 v4, 4096, v4
    v_mfma_f32_16x16x32_bf16 a[192:195], a[24:27], a[68:71], a[192:195]
    ds_read_b64_tr_b16 a[118:119], v12 offset:58368
    v_mfma_f32_16x16x32_bf16 v[140:143], a[28:31], a[68:71], v[140:143]
    ds_read_b64_tr_b16 a[120:121], v13 offset:57344
    v_mfma_f32_16x16x32_bf16 v[136:139], a[28:31], a[64:67], v[136:139]
    ds_read_b64_tr_b16 a[122:123], v13 offset:58368
    v_add_u32 v5, 16640, v2
    v_mfma_f32_16x16x32_bf16 v[132:135], a[28:31], a[60:63], v[132:135]
    ds_read_b64_tr_b16 a[124:125], v14 offset:57344
    v_mfma_f32_16x16x32_bf16 v[128:131], a[28:31], a[56:59], v[128:131]
    ds_read_b64_tr_b16 a[126:127], v14 offset:58368
    v_mfma_f32_16x16x32_bf16 v[144:147], a[32:35], a[56:59], v[144:147]
    v_cmp_gt_u32 vcc, 32, v0
    v_mfma_f32_16x16x32_bf16 v[148:151], a[32:35], a[60:63], v[148:151]
    v_mfma_f32_16x16x32_bf16 v[152:155], a[32:35], a[64:67], v[152:155]
    v_add_u32 v29, s70, v2
    v_mfma_f32_16x16x32_bf16 v[156:159], a[32:35], a[68:71], v[156:159]
    v_mfma_f32_16x16x32_bf16 v[172:175], a[36:39], a[68:71], v[172:175]
    v_mfma_f32_16x16x32_bf16 v[168:171], a[36:39], a[64:67], v[168:171]
    v_mov_b32 v248, 0
    v_mfma_f32_16x16x32_bf16 v[164:167], a[36:39], a[60:63], v[164:167]
    v_mfma_f32_16x16x32_bf16 v[160:163], a[36:39], a[56:59], v[160:163]
    v_mfma_f32_16x16x32_bf16 v[176:179], a[40:43], a[56:59], v[176:179]
    v_mov_b32 v249, 0
    v_mfma_f32_16x16x32_bf16 v[180:183], a[40:43], a[60:63], v[180:183]
    v_mfma_f32_16x16x32_bf16 v[184:187], a[40:43], a[64:67], v[184:187]
    v_mfma_f32_16x16x32_bf16 v[188:191], a[40:43], a[68:71], v[188:191]
    v_cndmask_b32 v5, v4, v5, vcc
    v_mfma_f32_16x16x32_bf16 v[204:207], a[44:47], a[68:71], v[204:207]
    v_mfma_f32_16x16x32_bf16 v[200:203], a[44:47], a[64:67], v[200:203]
    v_add_u32 v5, s70, v5
    v_mfma_f32_16x16x32_bf16 v[196:199], a[44:47], a[60:63], v[196:199]
    v_mfma_f32_16x16x32_bf16 v[192:195], a[44:47], a[56:59], v[192:195]
    v_mfma_f32_16x16x32_bf16 v[208:211], a[48:51], a[56:59], v[208:211]
    v_mov_b32 v250, 0
    v_mfma_f32_16x16x32_bf16 v[212:215], a[48:51], a[60:63], v[212:215]
    v_mfma_f32_16x16x32_bf16 v[216:219], a[48:51], a[64:67], v[216:219]
    v_mfma_f32_16x16x32_bf16 v[220:223], a[48:51], a[68:71], v[220:223]
    v_mov_b32 v251, 0
    v_mfma_f32_16x16x32_bf16 a[208:211], a[52:55], a[68:71], a[208:211]
    v_mfma_f32_16x16x32_bf16 a[204:207], a[52:55], a[64:67], a[204:207]
    v_mfma_f32_16x16x32_bf16 a[200:203], a[52:55], a[60:63], a[200:203]
    v_mfma_f32_16x16x32_bf16 a[196:199], a[52:55], a[56:59], a[196:199]
    s_waitcnt vmcnt(8) lgkmcnt(0)
    s_barrier
    v_mfma_f32_16x16x32_bf16 v[32:35], a[72:75], a[128:131], v[32:35]
    ds_read_b64_tr_b16 a[0:1], v8 offset:0
    v_mfma_f32_16x16x32_bf16 v[36:39], a[72:75], a[132:135], v[36:39]
    ds_read_b64_tr_b16 a[2:3], v8 offset:1024
    v_mfma_f32_16x16x32_bf16 v[40:43], a[72:75], a[136:139], v[40:43]
    ds_read_b64_tr_b16 a[4:5], v9 offset:0
    v_mfma_f32_16x16x32_bf16 v[44:47], a[72:75], a[140:143], v[44:47]
    ds_read_b64_tr_b16 a[6:7], v9 offset:1024
    s_add_u32 m0, s70, 17152
    v_mfma_f32_16x16x32_bf16 v[60:63], a[76:79], a[140:143], v[60:63]
    ds_read_b64_tr_b16 a[8:9], v10 offset:0
    buffer_load_dwordx4 v2, s[28:31], s84 offen nt lds
    v_mfma_f32_16x16x32_bf16 v[56:59], a[76:79], a[136:139], v[56:59]
    ds_read_b64_tr_b16 a[10:11], v10 offset:1024
    v_cmp_gt_u32 vcc, 48, v0
    v_mfma_f32_16x16x32_bf16 v[52:55], a[76:79], a[132:135], v[52:55]
    ds_read_b64_tr_b16 a[12:13], v11 offset:0
    ds_write_b128 v5, v[248:251]
    v_mfma_f32_16x16x32_bf16 v[48:51], a[76:79], a[128:131], v[48:51]
    ds_read_b64_tr_b16 a[14:15], v11 offset:1024
    v_lshrrev_b32 v1, 16, v20
    v_mfma_f32_16x16x32_bf16 v[64:67], a[80:83], a[128:131], v[64:67]
    ds_read_b64_tr_b16 a[16:17], v12 offset:0
    v_or_b32 v1, v1, v20
    v_mfma_f32_16x16x32_bf16 v[68:71], a[80:83], a[132:135], v[68:71]
    ds_read_b64_tr_b16 a[18:19], v12 offset:1024
    v_cndmask_b32 v1, 0, v1, vcc
    v_mfma_f32_16x16x32_bf16 v[72:75], a[80:83], a[136:139], v[72:75]
    ds_read_b64_tr_b16 a[20:21], v13 offset:0
    v_accvgpr_write_b32 a56, v1
    v_mfma_f32_16x16x32_bf16 v[76:79], a[80:83], a[140:143], v[76:79]
    ds_read_b64_tr_b16 a[22:23], v13 offset:1024
    buffer_load_dwordx4 v2, s[28:31], s84 offen offset:1024 nt lds
    v_mfma_f32_16x16x32_bf16 v[92:95], a[84:87], a[140:143], v[92:95]
    ds_read_b64_tr_b16 a[24:25], v14 offset:0
    v_accvgpr_write_b32 a57, v1
    v_mfma_f32_16x16x32_bf16 v[88:91], a[84:87], a[136:139], v[88:91]
    ds_read_b64_tr_b16 a[26:27], v14 offset:1024
    v_accvgpr_write_b32 a58, v1
    v_mfma_f32_16x16x32_bf16 v[84:87], a[84:87], a[132:135], v[84:87]
    ds_read_b64_tr_b16 a[28:29], v8 offset:8192
    v_accvgpr_write_b32 a59, v1
    v_mfma_f32_16x16x32_bf16 v[80:83], a[84:87], a[128:131], v[80:83]
    ds_read_b64_tr_b16 a[30:31], v8 offset:9216
    v_lshrrev_b32 v1, 16, v22
    v_mfma_f32_16x16x32_bf16 v[96:99], a[88:91], a[128:131], v[96:99]
    ds_read_b64_tr_b16 a[32:33], v9 offset:8192
    v_or_b32 v1, v1, v22
    v_mfma_f32_16x16x32_bf16 v[100:103], a[88:91], a[132:135], v[100:103]
    ds_read_b64_tr_b16 a[34:35], v9 offset:9216
    v_cndmask_b32 v1, 0, v1, vcc
    v_mfma_f32_16x16x32_bf16 v[104:107], a[88:91], a[136:139], v[104:107]
    ds_read_b64_tr_b16 a[36:37], v10 offset:8192
    buffer_load_dwordx4 v2, s[28:31], s84 offen offset:2048 nt lds
    v_mfma_f32_16x16x32_bf16 v[108:111], a[88:91], a[140:143], v[108:111]
    ds_read_b64_tr_b16 a[38:39], v10 offset:9216
    v_accvgpr_write_b32 a60, v1
    v_mfma_f32_16x16x32_bf16 v[124:127], a[92:95], a[140:143], v[124:127]
    ds_read_b64_tr_b16 a[40:41], v11 offset:8192
    v_accvgpr_write_b32 a61, v1
    v_mfma_f32_16x16x32_bf16 v[120:123], a[92:95], a[136:139], v[120:123]
    ds_read_b64_tr_b16 a[42:43], v11 offset:9216
    v_accvgpr_write_b32 a62, v1
    v_mfma_f32_16x16x32_bf16 v[116:119], a[92:95], a[132:135], v[116:119]
    ds_read_b64_tr_b16 a[44:45], v12 offset:8192
    v_accvgpr_write_b32 a63, v1
    v_mfma_f32_16x16x32_bf16 v[112:115], a[92:95], a[128:131], v[112:115]
    ds_read_b64_tr_b16 a[46:47], v12 offset:9216
    v_lshrrev_b32 v1, 16, v24
    v_mfma_f32_16x16x32_bf16 a[180:183], a[96:99], a[128:131], a[180:183]
    ds_read_b64_tr_b16 a[48:49], v13 offset:8192
    v_or_b32 v1, v1, v24
    v_mfma_f32_16x16x32_bf16 a[184:187], a[96:99], a[132:135], a[184:187]
    ds_read_b64_tr_b16 a[50:51], v13 offset:9216
    buffer_load_dwordx4 v2, s[28:31], s84 offen offset:3072 nt lds
    v_mfma_f32_16x16x32_bf16 a[188:191], a[96:99], a[136:139], a[188:191]
    ds_read_b64_tr_b16 a[52:53], v14 offset:8192
    v_cndmask_b32 v1, 0, v1, vcc
    v_mfma_f32_16x16x32_bf16 a[192:195], a[96:99], a[140:143], a[192:195]
    ds_read_b64_tr_b16 a[54:55], v14 offset:9216
    v_accvgpr_write_b32 a64, v1
    v_mfma_f32_16x16x32_bf16 v[140:143], a[100:103], a[140:143], v[140:143]
    v_accvgpr_write_b32 a65, v1
    v_accvgpr_write_b32 a66, v1
    v_mfma_f32_16x16x32_bf16 v[136:139], a[100:103], a[136:139], v[136:139]
    v_accvgpr_write_b32 a67, v1
    v_mfma_f32_16x16x32_bf16 v[132:135], a[100:103], a[132:135], v[132:135]
    v_lshrrev_b32 v1, 16, v26
    v_mfma_f32_16x16x32_bf16 v[128:131], a[100:103], a[128:131], v[128:131]
    v_or_b32 v1, v1, v26
    v_mfma_f32_16x16x32_bf16 v[144:147], a[104:107], a[128:131], v[144:147]
    v_cndmask_b32 v1, 0, v1, vcc
    v_mfma_f32_16x16x32_bf16 v[148:151], a[104:107], a[132:135], v[148:151]
    v_mfma_f32_16x16x32_bf16 v[152:155], a[104:107], a[136:139], v[152:155]
    v_accvgpr_write_b32 a68, v1
    v_mfma_f32_16x16x32_bf16 v[156:159], a[104:107], a[140:143], v[156:159]
    v_accvgpr_write_b32 a69, v1
    v_mfma_f32_16x16x32_bf16 v[172:175], a[108:111], a[140:143], v[172:175]
    v_accvgpr_write_b32 a70, v1
    v_mfma_f32_16x16x32_bf16 v[168:171], a[108:111], a[136:139], v[168:171]
    v_accvgpr_write_b32 a71, v1
    v_mfma_f32_16x16x32_bf16 v[164:167], a[108:111], a[132:135], v[164:167]
    v_mfma_f32_16x16x32_bf16 v[160:163], a[108:111], a[128:131], v[160:163]
    v_mul_f32 v20, 0xbfb8aa3b, v21
    v_mfma_f32_16x16x32_bf16 v[176:179], a[112:115], a[128:131], v[176:179]
    v_mul_f32 v21, v21, v21
    v_mfma_f32_16x16x32_bf16 v[180:183], a[112:115], a[132:135], v[180:183]
    v_rcp_f32 v21, v21
    v_mfma_f32_16x16x32_bf16 v[184:187], a[112:115], a[136:139], v[184:187]
    v_mul_f32 v22, 0xbfb8aa3b, v23
    v_mfma_f32_16x16x32_bf16 v[188:191], a[112:115], a[140:143], v[188:191]
    v_mfma_f32_16x16x32_bf16 v[204:207], a[116:119], a[140:143], v[204:207]
    v_mul_f32 v23, v23, v23
    v_mfma_f32_16x16x32_bf16 v[200:203], a[116:119], a[136:139], v[200:203]
    v_rcp_f32 v23, v23
    v_mfma_f32_16x16x32_bf16 v[196:199], a[116:119], a[132:135], v[196:199]
    v_mul_f32 v24, 0xbfb8aa3b, v25
    v_mfma_f32_16x16x32_bf16 v[192:195], a[116:119], a[128:131], v[192:195]
    v_mul_f32 v25, v25, v25
    v_mfma_f32_16x16x32_bf16 v[208:211], a[120:123], a[128:131], v[208:211]
    v_mfma_f32_16x16x32_bf16 v[212:215], a[120:123], a[132:135], v[212:215]
    v_rcp_f32 v25, v25
    v_mfma_f32_16x16x32_bf16 v[216:219], a[120:123], a[136:139], v[216:219]
    v_mul_f32 v26, 0xbfb8aa3b, v27
    v_mfma_f32_16x16x32_bf16 v[220:223], a[120:123], a[140:143], v[220:223]
    v_mul_f32 v27, v27, v27
    v_mfma_f32_16x16x32_bf16 a[208:211], a[124:127], a[140:143], a[208:211]
    v_rcp_f32 v27, v27
    v_mfma_f32_16x16x32_bf16 a[204:207], a[124:127], a[136:139], a[204:207]
    v_mfma_f32_16x16x32_bf16 a[200:203], a[124:127], a[132:135], a[200:203]
    v_mfma_f32_16x16x32_bf16 a[196:199], a[124:127], a[128:131], a[196:199]
    s_waitcnt vmcnt(4) lgkmcnt(0)
    s_barrier
    v_mfma_f32_16x16x32_bf16 v[32:35], a[0:3], a[56:59], v[32:35]
    ds_read_b128 v[224:227], v29 offset:0
    v_mfma_f32_16x16x32_bf16 v[36:39], a[0:3], a[60:63], v[36:39]
    ds_read_b128 v[228:231], v29 offset:8320
    v_mfma_f32_16x16x32_bf16 v[40:43], a[0:3], a[64:67], v[40:43]
    ds_read_b32 v232, v29 offset:8336
    v_mfma_f32_16x16x32_bf16 v[44:47], a[0:3], a[68:71], v[44:47]
    ds_read_b128 v[236:239], v29 offset:1024
    v_mfma_f32_16x16x32_bf16 v[60:63], a[4:7], a[68:71], v[60:63]
    ds_read_b128 v[240:243], v29 offset:9344
    v_mfma_f32_16x16x32_bf16 v[56:59], a[4:7], a[64:67], v[56:59]
    ds_read_b32 v244, v29 offset:9360
    s_lshl_b32 s3, s65, 4
    v_mfma_f32_16x16x32_bf16 v[52:55], a[4:7], a[60:63], v[52:55]
    s_lshl_b32 s6, s64, 2
    s_add_u32 s3, s3, s6
    s_mul_i32 s3, s3, 114688
    v_mfma_f32_16x16x32_bf16 v[48:51], a[4:7], a[56:59], v[48:51]
    s_mul_i32 s6, s66, 3584
    s_add_u32 s3, s3, s6
    v_lshrrev_b32 v18, 1, v28
    v_mfma_f32_16x16x32_bf16 v[64:67], a[8:11], a[56:59], v[64:67]
    v_lshlrev_b32 v18, 8, v18
    v_lshl_add_u32 v18, v3, 4, v18
    v_mfma_f32_16x16x32_bf16 v[68:71], a[8:11], a[60:63], v[68:71]
    v_add_u32 v18, s3, v18
    v_and_b32 v1, 1, v28
    v_mfma_f32_16x16x32_bf16 v[72:75], a[8:11], a[64:67], v[72:75]
    v_mul_u32_u24 v19, 114688, v1
    v_add_u32 v19, v19, v18
    v_mfma_f32_16x16x32_bf16 v[76:79], a[8:11], a[68:71], v[76:79]
    v_lshl_add_u32 v18, v1, 9, v18
    s_waitcnt lgkmcnt(3)
    v_mfma_f32_16x16x32_bf16 v[92:95], a[12:15], a[68:71], v[92:95]
    v_alignbit_b32 v224, v228, v224, 16
    v_alignbit_b32 v225, v229, v225, 16
    v_mfma_f32_16x16x32_bf16 v[88:91], a[12:15], a[64:67], v[88:91]
    v_alignbit_b32 v226, v230, v226, 16
    v_mfma_f32_16x16x32_bf16 v[84:87], a[12:15], a[60:63], v[84:87]
    v_alignbit_b32 v227, v231, v227, 16
    v_mfma_f32_16x16x32_bf16 v[80:83], a[12:15], a[56:59], v[80:83]
    ds_write_b128 v29, v[224:227] offset:4160
    v_alignbit_b32 v228, v229, v228, 16
    v_mfma_f32_16x16x32_bf16 v[96:99], a[16:19], a[56:59], v[96:99]
    v_alignbit_b32 v229, v230, v229, 16
    v_mfma_f32_16x16x32_bf16 v[100:103], a[16:19], a[60:63], v[100:103]
    v_alignbit_b32 v230, v231, v230, 16
    v_alignbit_b32 v231, v232, v231, 16
    v_mfma_f32_16x16x32_bf16 v[104:107], a[16:19], a[64:67], v[104:107]
    ds_write_b128 v29, v[228:231] offset:12480
    v_mfma_f32_16x16x32_bf16 v[108:111], a[16:19], a[68:71], v[108:111]
    ds_read_b128 v[224:227], v29 offset:2048
    v_mfma_f32_16x16x32_bf16 v[124:127], a[20:23], a[68:71], v[124:127]
    ds_read_b128 v[228:231], v29 offset:10368
    v_mfma_f32_16x16x32_bf16 v[120:123], a[20:23], a[64:67], v[120:123]
    ds_read_b32 v232, v29 offset:10384
    s_waitcnt lgkmcnt(5)
    v_alignbit_b32 v236, v240, v236, 16
    v_mfma_f32_16x16x32_bf16 v[116:119], a[20:23], a[60:63], v[116:119]
    v_alignbit_b32 v237, v241, v237, 16
    v_alignbit_b32 v238, v242, v238, 16
    v_mfma_f32_16x16x32_bf16 v[112:115], a[20:23], a[56:59], v[112:115]
    v_alignbit_b32 v239, v243, v239, 16
    v_mfma_f32_16x16x32_bf16 a[180:183], a[24:27], a[56:59], a[180:183]
    ds_write_b128 v29, v[236:239] offset:5184
    v_alignbit_b32 v240, v241, v240, 16
    v_mfma_f32_16x16x32_bf16 a[184:187], a[24:27], a[60:63], a[184:187]
    v_alignbit_b32 v241, v242, v241, 16
    v_mfma_f32_16x16x32_bf16 a[188:191], a[24:27], a[64:67], a[188:191]
    v_alignbit_b32 v242, v243, v242, 16
    v_mfma_f32_16x16x32_bf16 a[192:195], a[24:27], a[68:71], a[192:195]
    v_alignbit_b32 v243, v244, v243, 16
    ds_write_b128 v29, v[240:243] offset:13504
    v_mfma_f32_16x16x32_bf16 v[140:143], a[28:31], a[68:71], v[140:143]
    ds_read_b128 v[236:239], v29 offset:3072
    v_mfma_f32_16x16x32_bf16 v[136:139], a[28:31], a[64:67], v[136:139]
    ds_read_b128 v[240:243], v29 offset:11392
    v_mfma_f32_16x16x32_bf16 v[132:135], a[28:31], a[60:63], v[132:135]
    ds_read_b32 v244, v29 offset:11408
    v_and_b32 v4, 3, v3
    v_mfma_f32_16x16x32_bf16 v[128:131], a[28:31], a[56:59], v[128:131]
    v_sub_u32 v4, 3, v4
    v_mfma_f32_16x16x32_bf16 v[144:147], a[32:35], a[56:59], v[144:147]
    v_mul_u32_u24 v16, 4160, v4
    v_and_b32 v4, 12, v3
    v_mfma_f32_16x16x32_bf16 v[148:151], a[32:35], a[60:63], v[148:151]
    v_lshlrev_b32 v4, 1, v4
    v_mfma_f32_16x16x32_bf16 v[152:155], a[32:35], a[64:67], v[152:155]
    v_sub_u32 v16, v16, v4
    s_waitcnt lgkmcnt(5)
    v_alignbit_b32 v224, v228, v224, 16
    v_mfma_f32_16x16x32_bf16 v[156:159], a[32:35], a[68:71], v[156:159]
    v_alignbit_b32 v225, v229, v225, 16
    v_mfma_f32_16x16x32_bf16 v[172:175], a[36:39], a[68:71], v[172:175]
    v_alignbit_b32 v226, v230, v226, 16
    v_alignbit_b32 v227, v231, v227, 16
    v_mfma_f32_16x16x32_bf16 v[168:171], a[36:39], a[64:67], v[168:171]
    ds_write_b128 v29, v[224:227] offset:6208
    v_mfma_f32_16x16x32_bf16 v[164:167], a[36:39], a[60:63], v[164:167]
    v_alignbit_b32 v228, v229, v228, 16
    v_mfma_f32_16x16x32_bf16 v[160:163], a[36:39], a[56:59], v[160:163]
    v_alignbit_b32 v229, v230, v229, 16
    v_alignbit_b32 v230, v231, v230, 16
    v_mfma_f32_16x16x32_bf16 v[176:179], a[40:43], a[56:59], v[176:179]
    v_alignbit_b32 v231, v232, v231, 16
    v_mfma_f32_16x16x32_bf16 v[180:183], a[40:43], a[60:63], v[180:183]
    ds_write_b128 v29, v[228:231] offset:14528
    v_lshl_add_u32 v16, v28, 4, v16
    v_mfma_f32_16x16x32_bf16 v[184:187], a[40:43], a[64:67], v[184:187]
    s_add_u32 s3, s70, 472
    v_mfma_f32_16x16x32_bf16 v[188:191], a[40:43], a[68:71], v[188:191]
    v_add_u32 v16, s3, v16
    v_mfma_f32_16x16x32_bf16 v[204:207], a[44:47], a[68:71], v[204:207]
    v_lshlrev_b32 v17, 5, v3
    v_lshl_add_u32 v17, v28, 4, v17
    v_mfma_f32_16x16x32_bf16 v[200:203], a[44:47], a[64:67], v[200:203]
    s_add_u32 s3, s70, 17120
    v_mfma_f32_16x16x32_bf16 v[196:199], a[44:47], a[60:63], v[196:199]
    v_add_u32 v17, s3, v17
    s_waitcnt lgkmcnt(2)
    v_alignbit_b32 v236, v240, v236, 16
    v_mfma_f32_16x16x32_bf16 v[192:195], a[44:47], a[56:59], v[192:195]
    v_alignbit_b32 v237, v241, v237, 16
    v_mfma_f32_16x16x32_bf16 v[208:211], a[48:51], a[56:59], v[208:211]
    v_alignbit_b32 v238, v242, v238, 16
    v_mfma_f32_16x16x32_bf16 v[212:215], a[48:51], a[60:63], v[212:215]
    v_alignbit_b32 v239, v243, v239, 16
    ds_write_b128 v29, v[236:239] offset:7232
    v_mfma_f32_16x16x32_bf16 v[216:219], a[48:51], a[64:67], v[216:219]
    v_alignbit_b32 v240, v241, v240, 16
    v_mfma_f32_16x16x32_bf16 v[220:223], a[48:51], a[68:71], v[220:223]
    v_alignbit_b32 v241, v242, v241, 16
    v_alignbit_b32 v242, v243, v242, 16
    v_mfma_f32_16x16x32_bf16 a[208:211], a[52:55], a[68:71], a[208:211]
    v_alignbit_b32 v243, v244, v243, 16
    v_mfma_f32_16x16x32_bf16 a[204:207], a[52:55], a[64:67], a[204:207]
    ds_write_b128 v29, v[240:243] offset:15552
    v_mfma_f32_16x16x32_bf16 a[200:203], a[52:55], a[60:63], a[200:203]
    v_mfma_f32_16x16x32_bf16 a[196:199], a[52:55], a[56:59], a[196:199]
    s_nop 4
    s_mov_b32 s78, 0
    v_pk_mul_f32 v[4:5], v[32:33], v[20:21] op_sel_hi:[1,0]
    v_pk_mul_f32 v[6:7], v[34:35], v[20:21] op_sel_hi:[1,0]
    v_exp_f32 v4, v4
    v_exp_f32 v5, v5
    v_exp_f32 v6, v6
    v_exp_f32 v7, v7
    v_pk_mul_f32 v[32:33], v[32:33], v[128:129]
    v_pk_mul_f32 v[34:35], v[34:35], v[130:131]
    v_pk_fma_f32 v[4:5], v[4:5], v[20:21], v[20:21] op_sel:[0,1,1] op_sel_hi:[1,1,1]
    v_pk_fma_f32 v[6:7], v[6:7], v[20:21], v[20:21] op_sel:[0,1,1] op_sel_hi:[1,1,1]
    v_rcp_f32 v6, v6
    v_rcp_f32 v7, v7
    v_rcp_f32 v4, v4
    v_rcp_f32 v5, v5
    v_pk_mul_f32 v[34:35], v[34:35], v[6:7]
    v_pk_mul_f32 v[32:33], v[32:33], v[4:5]
    v_cvt_pk_bf16_f32 v9, v34, v35
    v_cvt_pk_bf16_f32 v8, v32, v33
    v_pk_mul_f32 v[4:5], v[48:49], v[20:21] op_sel_hi:[1,0]
    v_pk_mul_f32 v[6:7], v[50:51], v[20:21] op_sel_hi:[1,0]
    v_exp_f32 v4, v4
    v_exp_f32 v5, v5
    v_exp_f32 v6, v6
    v_exp_f32 v7, v7
    v_pk_mul_f32 v[48:49], v[48:49], v[144:145]
    v_pk_mul_f32 v[50:51], v[50:51], v[146:147]
    v_pk_fma_f32 v[4:5], v[4:5], v[20:21], v[20:21] op_sel:[0,1,1] op_sel_hi:[1,1,1]
    v_pk_fma_f32 v[6:7], v[6:7], v[20:21], v[20:21] op_sel:[0,1,1] op_sel_hi:[1,1,1]
    v_rcp_f32 v6, v6
    v_rcp_f32 v7, v7
    v_rcp_f32 v4, v4
    v_rcp_f32 v5, v5
    v_pk_mul_f32 v[50:51], v[50:51], v[6:7]
    v_pk_mul_f32 v[48:49], v[48:49], v[4:5]
    v_cvt_pk_bf16_f32 v11, v50, v51
    v_cvt_pk_bf16_f32 v10, v48, v49
    v_pk_mul_f32 v[4:5], v[64:65], v[20:21] op_sel_hi:[1,0]
    v_pk_mul_f32 v[6:7], v[66:67], v[20:21] op_sel_hi:[1,0]
    v_permlane16_swap_b32 v8, v10
    v_permlane16_swap_b32 v9, v11
    buffer_store_dwordx4 v[8:11], v18, s[20:23], s78 offen offset:0 sc1
    v_exp_f32 v4, v4
    v_exp_f32 v5, v5
    v_exp_f32 v6, v6
    v_exp_f32 v7, v7
    v_pk_mul_f32 v[64:65], v[64:65], v[160:161]
    v_pk_mul_f32 v[66:67], v[66:67], v[162:163]
    v_pk_fma_f32 v[4:5], v[4:5], v[20:21], v[20:21] op_sel:[0,1,1] op_sel_hi:[1,1,1]
    v_pk_fma_f32 v[6:7], v[6:7], v[20:21], v[20:21] op_sel:[0,1,1] op_sel_hi:[1,1,1]
    v_rcp_f32 v6, v6
    v_rcp_f32 v7, v7
    v_rcp_f32 v4, v4
    v_rcp_f32 v5, v5
    v_pk_mul_f32 v[66:67], v[66:67], v[6:7]
    v_pk_mul_f32 v[64:65], v[64:65], v[4:5]
    v_cvt_pk_bf16_f32 v13, v66, v67
    v_cvt_pk_bf16_f32 v12, v64, v65
    v_pk_mul_f32 v[4:5], v[80:81], v[20:21] op_sel_hi:[1,0]
    v_pk_mul_f32 v[6:7], v[82:83], v[20:21] op_sel_hi:[1,0]
    v_exp_f32 v4, v4
    v_exp_f32 v5, v5
    v_exp_f32 v6, v6
    v_exp_f32 v7, v7
    v_pk_mul_f32 v[80:81], v[80:81], v[176:177]
    v_pk_mul_f32 v[82:83], v[82:83], v[178:179]
    v_pk_fma_f32 v[4:5], v[4:5], v[20:21], v[20:21] op_sel:[0,1,1] op_sel_hi:[1,1,1]
    v_pk_fma_f32 v[6:7], v[6:7], v[20:21], v[20:21] op_sel:[0,1,1] op_sel_hi:[1,1,1]
    v_rcp_f32 v6, v6
    v_rcp_f32 v7, v7
    v_rcp_f32 v4, v4
    v_rcp_f32 v5, v5
    v_pk_mul_f32 v[82:83], v[82:83], v[6:7]
    v_pk_mul_f32 v[80:81], v[80:81], v[4:5]
    v_cvt_pk_bf16_f32 v15, v82, v83
    v_cvt_pk_bf16_f32 v14, v80, v81
    v_pk_mul_f32 v[4:5], v[96:97], v[20:21] op_sel_hi:[1,0]
    v_pk_mul_f32 v[6:7], v[98:99], v[20:21] op_sel_hi:[1,0]
    v_permlane16_swap_b32 v12, v14
    v_permlane16_swap_b32 v13, v15
    buffer_store_dwordx4 v[12:15], v18, s[20:23], s78 offen offset:1024 sc1
    v_exp_f32 v4, v4
    v_exp_f32 v5, v5
    v_exp_f32 v6, v6
    v_exp_f32 v7, v7
    v_pk_mul_f32 v[96:97], v[96:97], v[192:193]
    v_pk_mul_f32 v[98:99], v[98:99], v[194:195]
    v_pk_fma_f32 v[4:5], v[4:5], v[20:21], v[20:21] op_sel:[0,1,1] op_sel_hi:[1,1,1]
    v_pk_fma_f32 v[6:7], v[6:7], v[20:21], v[20:21] op_sel:[0,1,1] op_sel_hi:[1,1,1]
    v_rcp_f32 v6, v6
    v_rcp_f32 v7, v7
    v_rcp_f32 v4, v4
    v_rcp_f32 v5, v5
    v_pk_mul_f32 v[98:99], v[98:99], v[6:7]
    v_pk_mul_f32 v[96:97], v[96:97], v[4:5]
    v_cvt_pk_bf16_f32 v9, v98, v99
    v_cvt_pk_bf16_f32 v8, v96, v97
    v_pk_mul_f32 v[4:5], v[112:113], v[20:21] op_sel_hi:[1,0]
    v_pk_mul_f32 v[6:7], v[114:115], v[20:21] op_sel_hi:[1,0]
    v_exp_f32 v4, v4
    v_exp_f32 v5, v5
    v_exp_f32 v6, v6
    v_exp_f32 v7, v7
    v_pk_mul_f32 v[112:113], v[112:113], v[208:209]
    v_pk_mul_f32 v[114:115], v[114:115], v[210:211]
    v_pk_fma_f32 v[4:5], v[4:5], v[20:21], v[20:21] op_sel:[0,1,1] op_sel_hi:[1,1,1]
    v_pk_fma_f32 v[6:7], v[6:7], v[20:21], v[20:21] op_sel:[0,1,1] op_sel_hi:[1,1,1]
    v_rcp_f32 v6, v6
    v_rcp_f32 v7, v7
    v_rcp_f32 v4, v4
    v_rcp_f32 v5, v5
    v_pk_mul_f32 v[114:115], v[114:115], v[6:7]
    v_pk_mul_f32 v[112:113], v[112:113], v[4:5]
    v_cvt_pk_bf16_f32 v11, v114, v115
    v_cvt_pk_bf16_f32 v10, v112, v113
    v_accvgpr_read_b32 v248, a180
    v_accvgpr_read_b32 v252, a196
    v_accvgpr_read_b32 v249, a181
    v_accvgpr_read_b32 v253, a197
    v_accvgpr_read_b32 v250, a182
    v_accvgpr_read_b32 v254, a198
    v_accvgpr_read_b32 v251, a183
    v_accvgpr_read_b32 v255, a199
    v_permlane16_swap_b32 v8, v10
    v_permlane16_swap_b32 v9, v11
    buffer_store_dwordx4 v[8:11], v18, s[20:23], s78 offen offset:2048 sc1
    v_pk_mul_f32 v[4:5], v[248:249], v[20:21] op_sel_hi:[1,0]
    v_pk_mul_f32 v[6:7], v[250:251], v[20:21] op_sel_hi:[1,0]
    v_exp_f32 v4, v4
    v_exp_f32 v5, v5
    v_exp_f32 v6, v6
    v_exp_f32 v7, v7
    v_pk_mul_f32 v[248:249], v[248:249], v[252:253]
    v_pk_mul_f32 v[250:251], v[250:251], v[254:255]
    v_pk_fma_f32 v[4:5], v[4:5], v[20:21], v[20:21] op_sel:[0,1,1] op_sel_hi:[1,1,1]
    v_pk_fma_f32 v[6:7], v[6:7], v[20:21], v[20:21] op_sel:[0,1,1] op_sel_hi:[1,1,1]
    v_rcp_f32 v6, v6
    v_rcp_f32 v7, v7
    v_rcp_f32 v4, v4
    v_rcp_f32 v5, v5
    v_pk_mul_f32 v[250:251], v[250:251], v[6:7]
    v_pk_mul_f32 v[248:249], v[248:249], v[4:5]
    v_cvt_pk_bf16_f32 v245, v250, v251
    v_cvt_pk_bf16_f32 v244, v248, v249
    s_mov_b32 s79, 114688
    v_pk_mul_f32 v[4:5], v[36:37], v[22:23] op_sel_hi:[1,0]
    v_pk_mul_f32 v[6:7], v[38:39], v[22:23] op_sel_hi:[1,0]
    v_exp_f32 v4, v4
    v_exp_f32 v5, v5
    v_exp_f32 v6, v6
    v_exp_f32 v7, v7
    v_pk_mul_f32 v[36:37], v[36:37], v[132:133]
    v_pk_mul_f32 v[38:39], v[38:39], v[134:135]
    v_pk_fma_f32 v[4:5], v[4:5], v[22:23], v[22:23] op_sel:[0,1,1] op_sel_hi:[1,1,1]
    v_pk_fma_f32 v[6:7], v[6:7], v[22:23], v[22:23] op_sel:[0,1,1] op_sel_hi:[1,1,1]
    v_rcp_f32 v6, v6
    v_rcp_f32 v7, v7
    v_rcp_f32 v4, v4
    v_rcp_f32 v5, v5
    v_pk_mul_f32 v[38:39], v[38:39], v[6:7]
    v_pk_mul_f32 v[36:37], v[36:37], v[4:5]
    v_cvt_pk_bf16_f32 v13, v38, v39
    v_cvt_pk_bf16_f32 v12, v36, v37
    v_pk_mul_f32 v[4:5], v[52:53], v[22:23] op_sel_hi:[1,0]
    v_pk_mul_f32 v[6:7], v[54:55], v[22:23] op_sel_hi:[1,0]
    v_exp_f32 v4, v4
    v_exp_f32 v5, v5
    v_exp_f32 v6, v6
    v_exp_f32 v7, v7
    v_pk_mul_f32 v[52:53], v[52:53], v[148:149]
    v_pk_mul_f32 v[54:55], v[54:55], v[150:151]
    v_pk_fma_f32 v[4:5], v[4:5], v[22:23], v[22:23] op_sel:[0,1,1] op_sel_hi:[1,1,1]
    v_pk_fma_f32 v[6:7], v[6:7], v[22:23], v[22:23] op_sel:[0,1,1] op_sel_hi:[1,1,1]
    v_rcp_f32 v6, v6
    v_rcp_f32 v7, v7
    v_rcp_f32 v4, v4
    v_rcp_f32 v5, v5
    v_pk_mul_f32 v[54:55], v[54:55], v[6:7]
    v_pk_mul_f32 v[52:53], v[52:53], v[4:5]
    v_cvt_pk_bf16_f32 v15, v54, v55
    v_cvt_pk_bf16_f32 v14, v52, v53
    v_pk_mul_f32 v[4:5], v[68:69], v[22:23] op_sel_hi:[1,0]
    v_pk_mul_f32 v[6:7], v[70:71], v[22:23] op_sel_hi:[1,0]
    v_permlane16_swap_b32 v12, v14
    v_permlane16_swap_b32 v13, v15
    buffer_store_dwordx4 v[12:15], v18, s[20:23], s79 offen offset:0 sc1
    v_exp_f32 v4, v4
    v_exp_f32 v5, v5
    v_exp_f32 v6, v6
    v_exp_f32 v7, v7
    v_pk_mul_f32 v[68:69], v[68:69], v[164:165]
    v_pk_mul_f32 v[70:71], v[70:71], v[166:167]
    v_pk_fma_f32 v[4:5], v[4:5], v[22:23], v[22:23] op_sel:[0,1,1] op_sel_hi:[1,1,1]
    v_pk_fma_f32 v[6:7], v[6:7], v[22:23], v[22:23] op_sel:[0,1,1] op_sel_hi:[1,1,1]
    v_rcp_f32 v6, v6
    v_rcp_f32 v7, v7
    v_rcp_f32 v4, v4
    v_rcp_f32 v5, v5
    v_pk_mul_f32 v[70:71], v[70:71], v[6:7]
    v_pk_mul_f32 v[68:69], v[68:69], v[4:5]
    v_cvt_pk_bf16_f32 v9, v70, v71
    v_cvt_pk_bf16_f32 v8, v68, v69
    v_pk_mul_f32 v[4:5], v[84:85], v[22:23] op_sel_hi:[1,0]
    v_pk_mul_f32 v[6:7], v[86:87], v[22:23] op_sel_hi:[1,0]
    v_exp_f32 v4, v4
    v_exp_f32 v5, v5
    v_exp_f32 v6, v6
    v_exp_f32 v7, v7
    v_pk_mul_f32 v[84:85], v[84:85], v[180:181]
    v_pk_mul_f32 v[86:87], v[86:87], v[182:183]
    v_pk_fma_f32 v[4:5], v[4:5], v[22:23], v[22:23] op_sel:[0,1,1] op_sel_hi:[1,1,1]
    v_pk_fma_f32 v[6:7], v[6:7], v[22:23], v[22:23] op_sel:[0,1,1] op_sel_hi:[1,1,1]
    v_rcp_f32 v6, v6
    v_rcp_f32 v7, v7
    v_rcp_f32 v4, v4
    v_rcp_f32 v5, v5
    v_pk_mul_f32 v[86:87], v[86:87], v[6:7]
    v_pk_mul_f32 v[84:85], v[84:85], v[4:5]
    v_cvt_pk_bf16_f32 v11, v86, v87
    v_cvt_pk_bf16_f32 v10, v84, v85
    v_pk_mul_f32 v[4:5], v[100:101], v[22:23] op_sel_hi:[1,0]
    v_pk_mul_f32 v[6:7], v[102:103], v[22:23] op_sel_hi:[1,0]
    v_permlane16_swap_b32 v8, v10
    v_permlane16_swap_b32 v9, v11
    buffer_store_dwordx4 v[8:11], v18, s[20:23], s79 offen offset:1024 sc1
    v_exp_f32 v4, v4
    v_exp_f32 v5, v5
    v_exp_f32 v6, v6
    v_exp_f32 v7, v7
    v_pk_mul_f32 v[100:101], v[100:101], v[196:197]
    v_pk_mul_f32 v[102:103], v[102:103], v[198:199]
    v_pk_fma_f32 v[4:5], v[4:5], v[22:23], v[22:23] op_sel:[0,1,1] op_sel_hi:[1,1,1]
    v_pk_fma_f32 v[6:7], v[6:7], v[22:23], v[22:23] op_sel:[0,1,1] op_sel_hi:[1,1,1]
    v_rcp_f32 v6, v6
    v_rcp_f32 v7, v7
    v_rcp_f32 v4, v4
    v_rcp_f32 v5, v5
    v_pk_mul_f32 v[102:103], v[102:103], v[6:7]
    v_pk_mul_f32 v[100:101], v[100:101], v[4:5]
    v_cvt_pk_bf16_f32 v13, v102, v103
    v_cvt_pk_bf16_f32 v12, v100, v101
    v_pk_mul_f32 v[4:5], v[116:117], v[22:23] op_sel_hi:[1,0]
    v_pk_mul_f32 v[6:7], v[118:119], v[22:23] op_sel_hi:[1,0]
    v_exp_f32 v4, v4
    v_exp_f32 v5, v5
    v_exp_f32 v6, v6
    v_exp_f32 v7, v7
    v_pk_mul_f32 v[116:117], v[116:117], v[212:213]
    v_pk_mul_f32 v[118:119], v[118:119], v[214:215]
    v_pk_fma_f32 v[4:5], v[4:5], v[22:23], v[22:23] op_sel:[0,1,1] op_sel_hi:[1,1,1]
    v_pk_fma_f32 v[6:7], v[6:7], v[22:23], v[22:23] op_sel:[0,1,1] op_sel_hi:[1,1,1]
    v_rcp_f32 v6, v6
    v_rcp_f32 v7, v7
    v_rcp_f32 v4, v4
    v_rcp_f32 v5, v5
    v_pk_mul_f32 v[118:119], v[118:119], v[6:7]
    v_pk_mul_f32 v[116:117], v[116:117], v[4:5]
    v_cvt_pk_bf16_f32 v15, v118, v119
    v_cvt_pk_bf16_f32 v14, v116, v117
    v_accvgpr_read_b32 v248, a184
    v_accvgpr_read_b32 v252, a200
    v_accvgpr_read_b32 v249, a185
    v_accvgpr_read_b32 v253, a201
    v_accvgpr_read_b32 v250, a186
    v_accvgpr_read_b32 v254, a202
    v_accvgpr_read_b32 v251, a187
    v_accvgpr_read_b32 v255, a203
    v_permlane16_swap_b32 v12, v14
    v_permlane16_swap_b32 v13, v15
    buffer_store_dwordx4 v[12:15], v18, s[20:23], s79 offen offset:2048 sc1
    v_pk_mul_f32 v[4:5], v[248:249], v[22:23] op_sel_hi:[1,0]
    v_pk_mul_f32 v[6:7], v[250:251], v[22:23] op_sel_hi:[1,0]
    v_exp_f32 v4, v4
    v_exp_f32 v5, v5
    v_exp_f32 v6, v6
    v_exp_f32 v7, v7
    v_pk_mul_f32 v[248:249], v[248:249], v[252:253]
    v_pk_mul_f32 v[250:251], v[250:251], v[254:255]
    v_pk_fma_f32 v[4:5], v[4:5], v[22:23], v[22:23] op_sel:[0,1,1] op_sel_hi:[1,1,1]
    v_pk_fma_f32 v[6:7], v[6:7], v[22:23], v[22:23] op_sel:[0,1,1] op_sel_hi:[1,1,1]
    v_rcp_f32 v6, v6
    v_rcp_f32 v7, v7
    v_rcp_f32 v4, v4
    v_rcp_f32 v5, v5
    v_pk_mul_f32 v[250:251], v[250:251], v[6:7]
    v_pk_mul_f32 v[248:249], v[248:249], v[4:5]
    v_cvt_pk_bf16_f32 v247, v250, v251
    v_cvt_pk_bf16_f32 v246, v248, v249
    v_pk_mul_f32 v[4:5], v[40:41], v[24:25] op_sel_hi:[1,0]
    v_pk_mul_f32 v[6:7], v[42:43], v[24:25] op_sel_hi:[1,0]
    v_permlane16_swap_b32 v244, v246
    v_permlane16_swap_b32 v245, v247
    buffer_store_dwordx4 v[244:247], v19, s[20:23], s78 offen offset:3072 sc1
    s_mov_b32 s78, 229376
    v_exp_f32 v4, v4
    v_exp_f32 v5, v5
    v_exp_f32 v6, v6
    v_exp_f32 v7, v7
    v_pk_mul_f32 v[40:41], v[40:41], v[136:137]
    v_pk_mul_f32 v[42:43], v[42:43], v[138:139]
    v_pk_fma_f32 v[4:5], v[4:5], v[24:25], v[24:25] op_sel:[0,1,1] op_sel_hi:[1,1,1]
    v_pk_fma_f32 v[6:7], v[6:7], v[24:25], v[24:25] op_sel:[0,1,1] op_sel_hi:[1,1,1]
    v_rcp_f32 v6, v6
    v_rcp_f32 v7, v7
    v_rcp_f32 v4, v4
    v_rcp_f32 v5, v5
    v_pk_mul_f32 v[42:43], v[42:43], v[6:7]
    v_pk_mul_f32 v[40:41], v[40:41], v[4:5]
    v_cvt_pk_bf16_f32 v9, v42, v43
    v_cvt_pk_bf16_f32 v8, v40, v41
    v_pk_mul_f32 v[4:5], v[56:57], v[24:25] op_sel_hi:[1,0]
    v_pk_mul_f32 v[6:7], v[58:59], v[24:25] op_sel_hi:[1,0]
    v_exp_f32 v4, v4
    v_exp_f32 v5, v5
    v_exp_f32 v6, v6
    v_exp_f32 v7, v7
    v_pk_mul_f32 v[56:57], v[56:57], v[152:153]
    v_pk_mul_f32 v[58:59], v[58:59], v[154:155]
    v_pk_fma_f32 v[4:5], v[4:5], v[24:25], v[24:25] op_sel:[0,1,1] op_sel_hi:[1,1,1]
    v_pk_fma_f32 v[6:7], v[6:7], v[24:25], v[24:25] op_sel:[0,1,1] op_sel_hi:[1,1,1]
    v_rcp_f32 v6, v6
    v_rcp_f32 v7, v7
    v_rcp_f32 v4, v4
    v_rcp_f32 v5, v5
    v_pk_mul_f32 v[58:59], v[58:59], v[6:7]
    v_pk_mul_f32 v[56:57], v[56:57], v[4:5]
    v_cvt_pk_bf16_f32 v11, v58, v59
    v_cvt_pk_bf16_f32 v10, v56, v57
    v_pk_mul_f32 v[4:5], v[72:73], v[24:25] op_sel_hi:[1,0]
    v_pk_mul_f32 v[6:7], v[74:75], v[24:25] op_sel_hi:[1,0]
    v_permlane16_swap_b32 v8, v10
    v_permlane16_swap_b32 v9, v11
    buffer_store_dwordx4 v[8:11], v18, s[20:23], s78 offen offset:0 sc1
    v_exp_f32 v4, v4
    v_exp_f32 v5, v5
    v_exp_f32 v6, v6
    v_exp_f32 v7, v7
    v_pk_mul_f32 v[72:73], v[72:73], v[168:169]
    v_pk_mul_f32 v[74:75], v[74:75], v[170:171]
    v_pk_fma_f32 v[4:5], v[4:5], v[24:25], v[24:25] op_sel:[0,1,1] op_sel_hi:[1,1,1]
    v_pk_fma_f32 v[6:7], v[6:7], v[24:25], v[24:25] op_sel:[0,1,1] op_sel_hi:[1,1,1]
    v_rcp_f32 v6, v6
    v_rcp_f32 v7, v7
    v_rcp_f32 v4, v4
    v_rcp_f32 v5, v5
    v_pk_mul_f32 v[74:75], v[74:75], v[6:7]
    v_pk_mul_f32 v[72:73], v[72:73], v[4:5]
    v_cvt_pk_bf16_f32 v13, v74, v75
    v_cvt_pk_bf16_f32 v12, v72, v73
    v_pk_mul_f32 v[4:5], v[88:89], v[24:25] op_sel_hi:[1,0]
    v_pk_mul_f32 v[6:7], v[90:91], v[24:25] op_sel_hi:[1,0]
    v_exp_f32 v4, v4
    v_exp_f32 v5, v5
    v_exp_f32 v6, v6
    v_exp_f32 v7, v7
    v_pk_mul_f32 v[88:89], v[88:89], v[184:185]
    v_pk_mul_f32 v[90:91], v[90:91], v[186:187]
    v_pk_fma_f32 v[4:5], v[4:5], v[24:25], v[24:25] op_sel:[0,1,1] op_sel_hi:[1,1,1]
    v_pk_fma_f32 v[6:7], v[6:7], v[24:25], v[24:25] op_sel:[0,1,1] op_sel_hi:[1,1,1]
    v_rcp_f32 v6, v6
    v_rcp_f32 v7, v7
    v_rcp_f32 v4, v4
    v_rcp_f32 v5, v5
    v_pk_mul_f32 v[90:91], v[90:91], v[6:7]
    v_pk_mul_f32 v[88:89], v[88:89], v[4:5]
    v_cvt_pk_bf16_f32 v15, v90, v91
    v_cvt_pk_bf16_f32 v14, v88, v89
    v_pk_mul_f32 v[4:5], v[104:105], v[24:25] op_sel_hi:[1,0]
    v_pk_mul_f32 v[6:7], v[106:107], v[24:25] op_sel_hi:[1,0]
    v_permlane16_swap_b32 v12, v14
    v_permlane16_swap_b32 v13, v15
    buffer_store_dwordx4 v[12:15], v18, s[20:23], s78 offen offset:1024 sc1
    v_exp_f32 v4, v4
    v_exp_f32 v5, v5
    v_exp_f32 v6, v6
    v_exp_f32 v7, v7
    v_pk_mul_f32 v[104:105], v[104:105], v[200:201]
    v_pk_mul_f32 v[106:107], v[106:107], v[202:203]
    v_pk_fma_f32 v[4:5], v[4:5], v[24:25], v[24:25] op_sel:[0,1,1] op_sel_hi:[1,1,1]
    v_pk_fma_f32 v[6:7], v[6:7], v[24:25], v[24:25] op_sel:[0,1,1] op_sel_hi:[1,1,1]
    v_rcp_f32 v6, v6
    v_rcp_f32 v7, v7
    v_rcp_f32 v4, v4
    v_rcp_f32 v5, v5
    v_pk_mul_f32 v[106:107], v[106:107], v[6:7]
    v_pk_mul_f32 v[104:105], v[104:105], v[4:5]
    v_cvt_pk_bf16_f32 v9, v106, v107
    v_cvt_pk_bf16_f32 v8, v104, v105
    v_pk_mul_f32 v[4:5], v[120:121], v[24:25] op_sel_hi:[1,0]
    v_pk_mul_f32 v[6:7], v[122:123], v[24:25] op_sel_hi:[1,0]
    v_exp_f32 v4, v4
    v_exp_f32 v5, v5
    v_exp_f32 v6, v6
    v_exp_f32 v7, v7
    v_pk_mul_f32 v[120:121], v[120:121], v[216:217]
    v_pk_mul_f32 v[122:123], v[122:123], v[218:219]
    v_pk_fma_f32 v[4:5], v[4:5], v[24:25], v[24:25] op_sel:[0,1,1] op_sel_hi:[1,1,1]
    v_pk_fma_f32 v[6:7], v[6:7], v[24:25], v[24:25] op_sel:[0,1,1] op_sel_hi:[1,1,1]
    v_rcp_f32 v6, v6
    v_rcp_f32 v7, v7
    v_rcp_f32 v4, v4
    v_rcp_f32 v5, v5
    v_pk_mul_f32 v[122:123], v[122:123], v[6:7]
    v_pk_mul_f32 v[120:121], v[120:121], v[4:5]
    v_cvt_pk_bf16_f32 v11, v122, v123
    v_cvt_pk_bf16_f32 v10, v120, v121
    v_accvgpr_read_b32 v248, a188
    v_accvgpr_read_b32 v252, a204
    v_accvgpr_read_b32 v249, a189
    v_accvgpr_read_b32 v253, a205
    v_accvgpr_read_b32 v250, a190
    v_accvgpr_read_b32 v254, a206
    v_accvgpr_read_b32 v251, a191
    v_accvgpr_read_b32 v255, a207
    v_permlane16_swap_b32 v8, v10
    v_permlane16_swap_b32 v9, v11
    buffer_store_dwordx4 v[8:11], v18, s[20:23], s78 offen offset:2048 sc1
    v_pk_mul_f32 v[4:5], v[248:249], v[24:25] op_sel_hi:[1,0]
    v_pk_mul_f32 v[6:7], v[250:251], v[24:25] op_sel_hi:[1,0]
    v_exp_f32 v4, v4
    v_exp_f32 v5, v5
    v_exp_f32 v6, v6
    v_exp_f32 v7, v7
    v_pk_mul_f32 v[248:249], v[248:249], v[252:253]
    v_pk_mul_f32 v[250:251], v[250:251], v[254:255]
    v_pk_fma_f32 v[4:5], v[4:5], v[24:25], v[24:25] op_sel:[0,1,1] op_sel_hi:[1,1,1]
    v_pk_fma_f32 v[6:7], v[6:7], v[24:25], v[24:25] op_sel:[0,1,1] op_sel_hi:[1,1,1]
    v_rcp_f32 v6, v6
    v_rcp_f32 v7, v7
    v_rcp_f32 v4, v4
    v_rcp_f32 v5, v5
    v_pk_mul_f32 v[250:251], v[250:251], v[6:7]
    v_pk_mul_f32 v[248:249], v[248:249], v[4:5]
    v_cvt_pk_bf16_f32 v245, v250, v251
    v_cvt_pk_bf16_f32 v244, v248, v249
    s_mov_b32 s79, 344064
    v_pk_mul_f32 v[4:5], v[44:45], v[26:27] op_sel_hi:[1,0]
    v_pk_mul_f32 v[6:7], v[46:47], v[26:27] op_sel_hi:[1,0]
    v_exp_f32 v4, v4
    v_exp_f32 v5, v5
    v_exp_f32 v6, v6
    v_exp_f32 v7, v7
    v_pk_mul_f32 v[44:45], v[44:45], v[140:141]
    v_pk_mul_f32 v[46:47], v[46:47], v[142:143]
    v_pk_fma_f32 v[4:5], v[4:5], v[26:27], v[26:27] op_sel:[0,1,1] op_sel_hi:[1,1,1]
    v_pk_fma_f32 v[6:7], v[6:7], v[26:27], v[26:27] op_sel:[0,1,1] op_sel_hi:[1,1,1]
    v_rcp_f32 v6, v6
    v_rcp_f32 v7, v7
    v_rcp_f32 v4, v4
    v_rcp_f32 v5, v5
    v_pk_mul_f32 v[46:47], v[46:47], v[6:7]
    v_pk_mul_f32 v[44:45], v[44:45], v[4:5]
    v_cvt_pk_bf16_f32 v13, v46, v47
    v_cvt_pk_bf16_f32 v12, v44, v45
    v_pk_mul_f32 v[4:5], v[60:61], v[26:27] op_sel_hi:[1,0]
    v_pk_mul_f32 v[6:7], v[62:63], v[26:27] op_sel_hi:[1,0]
    v_exp_f32 v4, v4
    v_exp_f32 v5, v5
    v_exp_f32 v6, v6
    v_exp_f32 v7, v7
    v_pk_mul_f32 v[60:61], v[60:61], v[156:157]
    v_pk_mul_f32 v[62:63], v[62:63], v[158:159]
    v_pk_fma_f32 v[4:5], v[4:5], v[26:27], v[26:27] op_sel:[0,1,1] op_sel_hi:[1,1,1]
    v_pk_fma_f32 v[6:7], v[6:7], v[26:27], v[26:27] op_sel:[0,1,1] op_sel_hi:[1,1,1]
    v_rcp_f32 v6, v6
    v_rcp_f32 v7, v7
    v_rcp_f32 v4, v4
    v_rcp_f32 v5, v5
    v_pk_mul_f32 v[62:63], v[62:63], v[6:7]
    v_pk_mul_f32 v[60:61], v[60:61], v[4:5]
    v_cvt_pk_bf16_f32 v15, v62, v63
    v_cvt_pk_bf16_f32 v14, v60, v61
    v_pk_mul_f32 v[4:5], v[76:77], v[26:27] op_sel_hi:[1,0]
    v_pk_mul_f32 v[6:7], v[78:79], v[26:27] op_sel_hi:[1,0]
    v_permlane16_swap_b32 v12, v14
    v_permlane16_swap_b32 v13, v15
    buffer_store_dwordx4 v[12:15], v18, s[20:23], s79 offen offset:0 sc1
    v_exp_f32 v4, v4
    v_exp_f32 v5, v5
    v_exp_f32 v6, v6
    v_exp_f32 v7, v7
    v_pk_mul_f32 v[76:77], v[76:77], v[172:173]
    v_pk_mul_f32 v[78:79], v[78:79], v[174:175]
    v_pk_fma_f32 v[4:5], v[4:5], v[26:27], v[26:27] op_sel:[0,1,1] op_sel_hi:[1,1,1]
    v_pk_fma_f32 v[6:7], v[6:7], v[26:27], v[26:27] op_sel:[0,1,1] op_sel_hi:[1,1,1]
    v_rcp_f32 v6, v6
    v_rcp_f32 v7, v7
    v_rcp_f32 v4, v4
    v_rcp_f32 v5, v5
    v_pk_mul_f32 v[78:79], v[78:79], v[6:7]
    v_pk_mul_f32 v[76:77], v[76:77], v[4:5]
    v_cvt_pk_bf16_f32 v9, v78, v79
    v_cvt_pk_bf16_f32 v8, v76, v77
    v_pk_mul_f32 v[4:5], v[92:93], v[26:27] op_sel_hi:[1,0]
    v_pk_mul_f32 v[6:7], v[94:95], v[26:27] op_sel_hi:[1,0]
    v_exp_f32 v4, v4
    v_exp_f32 v5, v5
    v_exp_f32 v6, v6
    v_exp_f32 v7, v7
    v_pk_mul_f32 v[92:93], v[92:93], v[188:189]
    v_pk_mul_f32 v[94:95], v[94:95], v[190:191]
    v_pk_fma_f32 v[4:5], v[4:5], v[26:27], v[26:27] op_sel:[0,1,1] op_sel_hi:[1,1,1]
    v_pk_fma_f32 v[6:7], v[6:7], v[26:27], v[26:27] op_sel:[0,1,1] op_sel_hi:[1,1,1]
    v_rcp_f32 v6, v6
    v_rcp_f32 v7, v7
    v_rcp_f32 v4, v4
    v_rcp_f32 v5, v5
    v_pk_mul_f32 v[94:95], v[94:95], v[6:7]
    v_pk_mul_f32 v[92:93], v[92:93], v[4:5]
    v_cvt_pk_bf16_f32 v11, v94, v95
    v_cvt_pk_bf16_f32 v10, v92, v93
    v_pk_mul_f32 v[4:5], v[108:109], v[26:27] op_sel_hi:[1,0]
    v_pk_mul_f32 v[6:7], v[110:111], v[26:27] op_sel_hi:[1,0]
    v_permlane16_swap_b32 v8, v10
    v_permlane16_swap_b32 v9, v11
    buffer_store_dwordx4 v[8:11], v18, s[20:23], s79 offen offset:1024 sc1
    v_exp_f32 v4, v4
    v_exp_f32 v5, v5
    v_exp_f32 v6, v6
    v_exp_f32 v7, v7
    v_pk_mul_f32 v[108:109], v[108:109], v[204:205]
    v_pk_mul_f32 v[110:111], v[110:111], v[206:207]
    v_pk_fma_f32 v[4:5], v[4:5], v[26:27], v[26:27] op_sel:[0,1,1] op_sel_hi:[1,1,1]
    v_pk_fma_f32 v[6:7], v[6:7], v[26:27], v[26:27] op_sel:[0,1,1] op_sel_hi:[1,1,1]
    v_rcp_f32 v6, v6
    v_rcp_f32 v7, v7
    v_rcp_f32 v4, v4
    v_rcp_f32 v5, v5
    v_pk_mul_f32 v[110:111], v[110:111], v[6:7]
    v_pk_mul_f32 v[108:109], v[108:109], v[4:5]
    v_cvt_pk_bf16_f32 v13, v110, v111
    v_cvt_pk_bf16_f32 v12, v108, v109
    v_pk_mul_f32 v[4:5], v[124:125], v[26:27] op_sel_hi:[1,0]
    v_pk_mul_f32 v[6:7], v[126:127], v[26:27] op_sel_hi:[1,0]
    v_exp_f32 v4, v4
    v_exp_f32 v5, v5
    v_exp_f32 v6, v6
    v_exp_f32 v7, v7
    v_pk_mul_f32 v[124:125], v[124:125], v[220:221]
    v_pk_mul_f32 v[126:127], v[126:127], v[222:223]
    v_pk_fma_f32 v[4:5], v[4:5], v[26:27], v[26:27] op_sel:[0,1,1] op_sel_hi:[1,1,1]
    v_pk_fma_f32 v[6:7], v[6:7], v[26:27], v[26:27] op_sel:[0,1,1] op_sel_hi:[1,1,1]
    v_rcp_f32 v6, v6
    v_rcp_f32 v7, v7
    v_rcp_f32 v4, v4
    v_rcp_f32 v5, v5
    v_pk_mul_f32 v[126:127], v[126:127], v[6:7]
    v_pk_mul_f32 v[124:125], v[124:125], v[4:5]
    v_cvt_pk_bf16_f32 v15, v126, v127
    v_cvt_pk_bf16_f32 v14, v124, v125
    v_accvgpr_read_b32 v248, a192
    v_accvgpr_read_b32 v252, a208
    v_accvgpr_read_b32 v249, a193
    v_accvgpr_read_b32 v253, a209
    v_accvgpr_read_b32 v250, a194
    v_accvgpr_read_b32 v254, a210
    v_accvgpr_read_b32 v251, a195
    v_accvgpr_read_b32 v255, a211
    v_permlane16_swap_b32 v12, v14
    v_permlane16_swap_b32 v13, v15
    buffer_store_dwordx4 v[12:15], v18, s[20:23], s79 offen offset:2048 sc1
    v_pk_mul_f32 v[4:5], v[248:249], v[26:27] op_sel_hi:[1,0]
    v_pk_mul_f32 v[6:7], v[250:251], v[26:27] op_sel_hi:[1,0]
    v_exp_f32 v4, v4
    v_exp_f32 v5, v5
    v_exp_f32 v6, v6
    v_exp_f32 v7, v7
    v_pk_mul_f32 v[248:249], v[248:249], v[252:253]
    v_pk_mul_f32 v[250:251], v[250:251], v[254:255]
    v_pk_fma_f32 v[4:5], v[4:5], v[26:27], v[26:27] op_sel:[0,1,1] op_sel_hi:[1,1,1]
    v_pk_fma_f32 v[6:7], v[6:7], v[26:27], v[26:27] op_sel:[0,1,1] op_sel_hi:[1,1,1]
    v_rcp_f32 v6, v6
    v_rcp_f32 v7, v7
    v_rcp_f32 v4, v4
    v_rcp_f32 v5, v5
    v_pk_mul_f32 v[250:251], v[250:251], v[6:7]
    v_pk_mul_f32 v[248:249], v[248:249], v[4:5]
    v_cvt_pk_bf16_f32 v247, v250, v251
    v_cvt_pk_bf16_f32 v246, v248, v249
    s_nop 1
    v_permlane16_swap_b32 v244, v246
    v_permlane16_swap_b32 v245, v247
    buffer_store_dwordx4 v[244:247], v19, s[20:23], s78 offen offset:3072 sc1
    s_mov_b32 s78, 229376
    s_waitcnt vmcnt(14)
    ds_read_b128 a[32:35], v17 offset:0
    ds_read_b64 a[0:1], v16 offset:3584
    ds_read_b64 a[2:3], v16 offset:3592
    ds_read_b128 a[36:39], v17 offset:512
    ds_read_b64 a[4:5], v16 offset:3072
    ds_read_b64 a[6:7], v16 offset:3080
    ds_read_b128 a[40:43], v17 offset:1024
    ds_read_b64 a[8:9], v16 offset:2560
    ds_read_b64 a[10:11], v16 offset:2568
    ds_read_b128 a[44:47], v17 offset:1536
    ds_read_b64 a[12:13], v16 offset:2048
    ds_read_b64 a[14:15], v16 offset:2056
    ds_read_b128 a[48:51], v17 offset:2048
    ds_read_b64 a[16:17], v16 offset:1536
    ds_read_b64 a[18:19], v16 offset:1544
    ds_read_b128 a[52:55], v17 offset:2560
    ds_read_b64 a[20:21], v16 offset:1024
    ds_read_b64 a[22:23], v16 offset:1032
    ds_read_b128 a[56:59], v17 offset:3072
    ds_read_b64 a[24:25], v16 offset:512
    ds_read_b64 a[26:27], v16 offset:520
    ds_read_b128 a[60:63], v17 offset:3584
    ds_read_b64 a[28:29], v16 offset:0
    ds_read_b64 a[30:31], v16 offset:8
    v_subrev_u32 v16, 64, v16
    v_subrev_u32 v17, 64, v17
    s_waitcnt lgkmcnt(0)
    v_mfma_f32_16x16x32_bf16 v[32:35], a[0:3], a[32:35], 0
    ds_read_b128 a[96:99], v17 offset:0
    s_lshr_b32 s72, s64, 1
    v_mfma_f32_16x16x32_bf16 v[36:39], a[0:3], a[36:39], 0
    ds_read_b64 a[64:65], v16 offset:3584
    s_and_b32 s73, s64, 1
    v_mfma_f32_16x16x32_bf16 v[40:43], a[0:3], a[40:43], 0
    ds_read_b64 a[66:67], v16 offset:3592
    s_and_b32 s4, s2, 1
    v_mfma_f32_16x16x32_bf16 v[44:47], a[0:3], a[44:47], 0
    ds_read_b128 a[100:103], v17 offset:512
    v_bfe_u32 v6, v0, 1, 3
    v_mfma_f32_16x16x32_bf16 v[48:51], a[0:3], a[48:51], 0
    ds_read_b64 a[68:69], v16 offset:3072
    v_xor_b32 v6, v6, v28
    v_mfma_f32_16x16x32_bf16 v[52:55], a[0:3], a[52:55], 0
    ds_read_b64 a[70:71], v16 offset:3080
    s_lshl_b32 s78, s64, 3
    v_mfma_f32_16x16x32_bf16 v[56:59], a[0:3], a[56:59], 0
    ds_read_b128 a[104:107], v17 offset:1024
    v_add_u32 v7, s78, v28
    v_mfma_f32_16x16x32_bf16 v[60:63], a[0:3], a[60:63], 0
    ds_read_b64 a[72:73], v16 offset:2560
    v_and_b32 v4, 1, v0
    v_mfma_f32_16x16x32_bf16 v[60:63], a[4:7], a[56:59], v[60:63]
    ds_read_b64 a[74:75], v16 offset:2568
    v_mfma_f32_16x16x32_bf16 v[56:59], a[4:7], a[52:55], v[56:59]
    ds_read_b128 a[108:111], v17 offset:1536
    v_lshlrev_b32 v194, 11, v7
    v_mfma_f32_16x16x32_bf16 v[52:55], a[4:7], a[48:51], v[52:55]
    ds_read_b64 a[76:77], v16 offset:2048
    v_lshl_add_u32 v194, v4, 4, v194
    v_mfma_f32_16x16x32_bf16 v[48:51], a[4:7], a[44:47], v[48:51]
    ds_read_b64 a[78:79], v16 offset:2056
    s_lshl_b32 s78, s68, 8
    v_mfma_f32_16x16x32_bf16 v[44:47], a[4:7], a[40:43], v[44:47]
    ds_read_b128 a[112:115], v17 offset:2048
    v_mfma_f32_16x16x32_bf16 v[40:43], a[4:7], a[36:39], v[40:43]
    ds_read_b64 a[80:81], v16 offset:1536
    v_add_u32 v194, s78, v194
    v_mfma_f32_16x16x32_bf16 v[36:39], a[4:7], a[32:35], v[36:39]
    ds_read_b64 a[82:83], v16 offset:1544
    v_xor_b32 v7, 4, v6
    v_mfma_f32_16x16x32_bf16 v[40:43], a[8:11], a[32:35], v[40:43]
    ds_read_b128 a[116:119], v17 offset:2560
    v_mfma_f32_16x16x32_bf16 v[44:47], a[8:11], a[36:39], v[44:47]
    ds_read_b64 a[84:85], v16 offset:1024
    v_lshl_add_u32 v195, v7, 5, v194
    v_mfma_f32_16x16x32_bf16 v[48:51], a[8:11], a[40:43], v[48:51]
    ds_read_b64 a[86:87], v16 offset:1032
    v_lshl_add_u32 v194, v6, 5, v194
    v_mfma_f32_16x16x32_bf16 v[52:55], a[8:11], a[44:47], v[52:55]
    ds_read_b128 a[120:123], v17 offset:3072
    v_add_u32 v195, 7168, v195
    v_mfma_f32_16x16x32_bf16 v[56:59], a[8:11], a[48:51], v[56:59]
    ds_read_b64 a[88:89], v16 offset:512
    v_mfma_f32_16x16x32_bf16 v[60:63], a[8:11], a[52:55], v[60:63]
    ds_read_b64 a[90:91], v16 offset:520
    s_lshl_b32 s74, s64, 11
    v_mfma_f32_16x16x32_bf16 v[60:63], a[12:15], a[48:51], v[60:63]
    ds_read_b128 a[124:127], v17 offset:3584
    s_add_u32 s71, s74, 81920
    v_mfma_f32_16x16x32_bf16 v[56:59], a[12:15], a[44:47], v[56:59]
    ds_read_b64 a[92:93], v16 offset:0
    s_mul_i32 s75, s4, 57344
    v_mfma_f32_16x16x32_bf16 v[52:55], a[12:15], a[40:43], v[52:55]
    ds_read_b64 a[94:95], v16 offset:8
    v_mfma_f32_16x16x32_bf16 v[48:51], a[12:15], a[36:39], v[48:51]
    s_lshl_b32 s76, s75, 6
    v_mfma_f32_16x16x32_bf16 v[44:47], a[12:15], a[32:35], v[44:47]
    s_lshl_b32 s78, s67, 3
    v_mfma_f32_16x16x32_bf16 v[48:51], a[16:19], a[32:35], v[48:51]
    v_mfma_f32_16x16x32_bf16 v[52:55], a[16:19], a[36:39], v[52:55]
    s_lshl_b32 s79, s64, 1
    v_mfma_f32_16x16x32_bf16 v[56:59], a[16:19], a[40:43], v[56:59]
    s_add_u32 s78, s78, s79
    v_mfma_f32_16x16x32_bf16 v[60:63], a[16:19], a[44:47], v[60:63]
    s_mul_i32 s78, s78, 114688
    v_mfma_f32_16x16x32_bf16 v[60:63], a[20:23], a[40:43], v[60:63]
    v_mfma_f32_16x16x32_bf16 v[56:59], a[20:23], a[36:39], v[56:59]
    v_add_u32 v192, s78, v2
    v_mfma_f32_16x16x32_bf16 v[52:55], a[20:23], a[32:35], v[52:55]
    v_add_u32 v193, 113664, v192
    v_subrev_u32 v16, 64, v16
    v_mfma_f32_16x16x32_bf16 v[56:59], a[24:27], a[32:35], v[56:59]
    v_subrev_u32 v17, 64, v17
    v_mfma_f32_16x16x32_bf16 v[60:63], a[24:27], a[36:39], v[60:63]
    v_mfma_f32_16x16x32_bf16 v[60:63], a[28:31], a[32:35], v[60:63]
    s_waitcnt lgkmcnt(0)
    v_mfma_f32_16x16x32_bf16 v[32:35], a[64:67], a[96:99], v[32:35]
    ds_read_b128 a[32:35], v17 offset:0
    v_bfe_u32 v6, v0, 2, 2
    v_mfma_f32_16x16x32_bf16 v[36:39], a[64:67], a[100:103], v[36:39]
    ds_read_b64 a[0:1], v16 offset:3584
    v_and_b32 v7, 3, v0
    v_mfma_f32_16x16x32_bf16 v[40:43], a[64:67], a[104:107], v[40:43]
    ds_read_b64 a[2:3], v16 offset:3592
    v_lshl_add_u32 v4, v28, 2, v6
    v_mfma_f32_16x16x32_bf16 v[44:47], a[64:67], a[108:111], v[44:47]
    ds_read_b128 a[36:39], v17 offset:512
    v_and_b32 v5, 7, v4
    v_mfma_f32_16x16x32_bf16 v[48:51], a[64:67], a[112:115], v[48:51]
    ds_read_b64 a[4:5], v16 offset:3072
    v_lshlrev_b32 v4, 8, v4
    v_mfma_f32_16x16x32_bf16 v[52:55], a[64:67], a[116:119], v[52:55]
    ds_read_b64 a[6:7], v16 offset:3080
    v_mfma_f32_16x16x32_bf16 v[56:59], a[64:67], a[120:123], v[56:59]
    ds_read_b128 a[40:43], v17 offset:1024
    v_lshl_add_u32 v4, v7, 3, v4
    v_mfma_f32_16x16x32_bf16 v[60:63], a[64:67], a[124:127], v[60:63]
    ds_read_b64 a[8:9], v16 offset:2560
    v_add_u32 v4, 81920, v4
    v_mfma_f32_16x16x32_bf16 v[60:63], a[68:71], a[120:123], v[60:63]
    ds_read_b64 a[10:11], v16 offset:2568
    v_mfma_f32_16x16x32_bf16 v[56:59], a[68:71], a[116:119], v[56:59]
    ds_read_b128 a[44:47], v17 offset:1536
    s_lshl_b32 s78, s73, 2
    v_mfma_f32_16x16x32_bf16 v[52:55], a[68:71], a[112:115], v[52:55]
    ds_read_b64 a[12:13], v16 offset:2048
    v_mfma_f32_16x16x32_bf16 v[48:51], a[68:71], a[108:111], v[48:51]
    ds_read_b64 a[14:15], v16 offset:2056
    v_xor_b32 v5, s78, v5
    v_mfma_f32_16x16x32_bf16 v[44:47], a[68:71], a[104:107], v[44:47]
    ds_read_b128 a[48:51], v17 offset:2048
    v_xor_b32 v7, 0, v5
    v_mfma_f32_16x16x32_bf16 v[40:43], a[68:71], a[100:103], v[40:43]
    ds_read_b64 a[16:17], v16 offset:1536
    v_mfma_f32_16x16x32_bf16 v[36:39], a[68:71], a[96:99], v[36:39]
    ds_read_b64 a[18:19], v16 offset:1544
    v_lshl_add_u32 v196, v7, 5, v4
    v_mfma_f32_16x16x32_bf16 v[40:43], a[72:75], a[96:99], v[40:43]
    ds_read_b128 a[52:55], v17 offset:2560
    v_mfma_f32_16x16x32_bf16 v[44:47], a[72:75], a[100:103], v[44:47]
    ds_read_b64 a[20:21], v16 offset:1024
    v_xor_b32 v7, 1, v5
    v_mfma_f32_16x16x32_bf16 v[48:51], a[72:75], a[104:107], v[48:51]
    ds_read_b64 a[22:23], v16 offset:1032
    v_lshl_add_u32 v197, v7, 5, v4
    v_mfma_f32_16x16x32_bf16 v[52:55], a[72:75], a[108:111], v[52:55]
    ds_read_b128 a[56:59], v17 offset:3072
    v_mfma_f32_16x16x32_bf16 v[56:59], a[72:75], a[112:115], v[56:59]
    ds_read_b64 a[24:25], v16 offset:512
    v_xor_b32 v7, 2, v5
    v_mfma_f32_16x16x32_bf16 v[60:63], a[72:75], a[116:119], v[60:63]
    ds_read_b64 a[26:27], v16 offset:520
    v_lshl_add_u32 v198, v7, 5, v4
    v_mfma_f32_16x16x32_bf16 v[60:63], a[76:79], a[112:115], v[60:63]
    ds_read_b128 a[60:63], v17 offset:3584
    v_mfma_f32_16x16x32_bf16 v[56:59], a[76:79], a[108:111], v[56:59]
    ds_read_b64 a[28:29], v16 offset:0
    v_xor_b32 v7, 3, v5
    v_mfma_f32_16x16x32_bf16 v[52:55], a[76:79], a[104:107], v[52:55]
    ds_read_b64 a[30:31], v16 offset:8
    v_mfma_f32_16x16x32_bf16 v[48:51], a[76:79], a[100:103], v[48:51]
    v_lshl_add_u32 v199, v7, 5, v4
    v_mfma_f32_16x16x32_bf16 v[44:47], a[76:79], a[96:99], v[44:47]
    s_lshl_b32 s78, s72, 12
    v_mfma_f32_16x16x32_bf16 v[48:51], a[80:83], a[96:99], v[48:51]
    v_mfma_f32_16x16x32_bf16 v[52:55], a[80:83], a[100:103], v[52:55]
    s_lshl_b32 s79, s4, 11
    v_mfma_f32_16x16x32_bf16 v[56:59], a[80:83], a[104:107], v[56:59]
    v_mfma_f32_16x16x32_bf16 v[60:63], a[80:83], a[108:111], v[60:63]
    s_add_u32 s78, s78, s79
    v_mfma_f32_16x16x32_bf16 v[60:63], a[84:87], a[104:107], v[60:63]
    v_lshrrev_b32 v4, 1, v28
    v_mfma_f32_16x16x32_bf16 v[56:59], a[84:87], a[100:103], v[56:59]
    v_mfma_f32_16x16x32_bf16 v[52:55], a[84:87], a[96:99], v[52:55]
    v_lshlrev_b32 v4, 8, v4
    v_subrev_u32 v16, 64, v16
    v_mfma_f32_16x16x32_bf16 v[56:59], a[88:91], a[96:99], v[56:59]
    v_subrev_u32 v17, 64, v17
    v_mfma_f32_16x16x32_bf16 v[60:63], a[88:91], a[100:103], v[60:63]
    v_mfma_f32_16x16x32_bf16 v[60:63], a[92:95], a[96:99], v[60:63]
    s_waitcnt lgkmcnt(0)
    v_mfma_f32_16x16x32_bf16 v[32:35], a[0:3], a[32:35], v[32:35]
    ds_read_b128 a[96:99], v17 offset:0
    v_lshl_add_u32 v4, v3, 4, v4
    v_mfma_f32_16x16x32_bf16 v[36:39], a[0:3], a[36:39], v[36:39]
    ds_read_b64 a[64:65], v16 offset:3584
    v_and_b32 v5, 1, v28
    v_mfma_f32_16x16x32_bf16 v[40:43], a[0:3], a[40:43], v[40:43]
    ds_read_b64 a[66:67], v16 offset:3592
    v_mfma_f32_16x16x32_bf16 v[44:47], a[0:3], a[44:47], v[44:47]
    ds_read_b128 a[100:103], v17 offset:512
    v_mfma_f32_16x16x32_bf16 v[48:51], a[0:3], a[48:51], v[48:51]
    ds_read_b64 a[68:69], v16 offset:3072
    v_lshl_add_u32 v4, v5, 3, v4
    v_mfma_f32_16x16x32_bf16 v[52:55], a[0:3], a[52:55], v[52:55]
    ds_read_b64 a[70:71], v16 offset:3080
    v_mfma_f32_16x16x32_bf16 v[56:59], a[0:3], a[56:59], v[56:59]
    ds_read_b128 a[104:107], v17 offset:1024
    v_mfma_f32_16x16x32_bf16 v[60:63], a[0:3], a[60:63], v[60:63]
    ds_read_b64 a[72:73], v16 offset:2560
    v_add_u32 v200, s78, v4
    v_mfma_f32_16x16x32_bf16 v[60:63], a[4:7], a[56:59], v[60:63]
    ds_read_b64 a[74:75], v16 offset:2568
    v_mfma_f32_16x16x32_bf16 v[56:59], a[4:7], a[52:55], v[56:59]
    ds_read_b128 a[108:111], v17 offset:1536
    v_mfma_f32_16x16x32_bf16 v[52:55], a[4:7], a[48:51], v[52:55]
    ds_read_b64 a[76:77], v16 offset:2048
    v_mfma_f32_16x16x32_bf16 v[48:51], a[4:7], a[44:47], v[48:51]
    ds_read_b64 a[78:79], v16 offset:2056
    v_xor_b32 v201, 0x800, v200
    v_mfma_f32_16x16x32_bf16 v[44:47], a[4:7], a[40:43], v[44:47]
    ds_read_b128 a[112:115], v17 offset:2048
    v_mfma_f32_16x16x32_bf16 v[40:43], a[4:7], a[36:39], v[40:43]
    ds_read_b64 a[80:81], v16 offset:1536
    v_mfma_f32_16x16x32_bf16 v[36:39], a[4:7], a[32:35], v[36:39]
    ds_read_b64 a[82:83], v16 offset:1544
    v_lshlrev_b32 v23, 2, v3
    v_mfma_f32_16x16x32_bf16 v[40:43], a[8:11], a[32:35], v[40:43]
    ds_read_b128 a[116:119], v17 offset:2560
    v_mfma_f32_16x16x32_bf16 v[44:47], a[8:11], a[36:39], v[44:47]
    ds_read_b64 a[84:85], v16 offset:1024
    v_mfma_f32_16x16x32_bf16 v[48:51], a[8:11], a[40:43], v[48:51]
    ds_read_b64 a[86:87], v16 offset:1032
    s_lshr_b32 s77, s67, 1
    v_mfma_f32_16x16x32_bf16 v[52:55], a[8:11], a[44:47], v[52:55]
    ds_read_b128 a[120:123], v17 offset:3072
    v_mfma_f32_16x16x32_bf16 v[56:59], a[8:11], a[48:51], v[56:59]
    ds_read_b64 a[88:89], v16 offset:512
    v_mfma_f32_16x16x32_bf16 v[60:63], a[8:11], a[52:55], v[60:63]
    ds_read_b64 a[90:91], v16 offset:520
    s_lshl_b32 s77, s77, 7
    v_mfma_f32_16x16x32_bf16 v[60:63], a[12:15], a[48:51], v[60:63]
    ds_read_b128 a[124:127], v17 offset:3584
    v_mfma_f32_16x16x32_bf16 v[56:59], a[12:15], a[44:47], v[56:59]
    ds_read_b64 a[92:93], v16 offset:0
    v_mfma_f32_16x16x32_bf16 v[52:55], a[12:15], a[40:43], v[52:55]
    ds_read_b64 a[94:95], v16 offset:8
    v_mfma_f32_16x16x32_bf16 v[48:51], a[12:15], a[36:39], v[48:51]
    s_lshl_b32 s78, s4, 6
    v_mfma_f32_16x16x32_bf16 v[44:47], a[12:15], a[32:35], v[44:47]
    v_mfma_f32_16x16x32_bf16 v[48:51], a[16:19], a[32:35], v[48:51]
    v_mfma_f32_16x16x32_bf16 v[52:55], a[16:19], a[36:39], v[52:55]
    s_add_u32 s77, s77, s78
    v_mfma_f32_16x16x32_bf16 v[56:59], a[16:19], a[40:43], v[56:59]
    v_mfma_f32_16x16x32_bf16 v[60:63], a[16:19], a[44:47], v[60:63]
    v_mfma_f32_16x16x32_bf16 v[60:63], a[20:23], a[40:43], v[60:63]
    s_add_u32 s77, s77, 16384
    v_mfma_f32_16x16x32_bf16 v[56:59], a[20:23], a[36:39], v[56:59]
    v_mfma_f32_16x16x32_bf16 v[52:55], a[20:23], a[32:35], v[52:55]
    v_subrev_u32 v16, 64, v16
    v_subrev_u32 v17, 64, v17
    v_mfma_f32_16x16x32_bf16 v[56:59], a[24:27], a[32:35], v[56:59]
    v_mfma_f32_16x16x32_bf16 v[60:63], a[24:27], a[36:39], v[60:63]
    v_mfma_f32_16x16x32_bf16 v[60:63], a[28:31], a[32:35], v[60:63]
    s_waitcnt vmcnt(0)
    s_barrier
    s_cmp_lg_u32 s64, 0
    s_cbranch_scc1 L_f1_nosig
    v_mov_b32 v1, 1
    s_mov_b64 exec, 1
    buffer_store_dword v1, off, s[36:39], s80 sc1
    s_mov_b64 exec, -1
L_f1_nosig:
    s_waitcnt lgkmcnt(0)
    v_mfma_f32_16x16x32_bf16 v[32:35], a[64:67], a[96:99], v[32:35]
    ds_read_b128 a[32:35], v17 offset:0
    s_getpc_b64 s[6:7]
L_pcc:
    v_mfma_f32_16x16x32_bf16 v[36:39], a[64:67], a[100:103], v[36:39]
    ds_read_b64 a[0:1], v16 offset:3584
    s_lshr_b32 s3, s2, 3
    v_mfma_f32_16x16x32_bf16 v[40:43], a[64:67], a[104:107], v[40:43]
    ds_read_b64 a[2:3], v16 offset:3592
    v_mfma_f32_16x16x32_bf16 v[44:47], a[64:67], a[108:111], v[44:47]
    ds_read_b128 a[36:39], v17 offset:512
    s_and_b32 s3, s3, 1
    v_mfma_f32_16x16x32_bf16 v[48:51], a[64:67], a[112:115], v[48:51]
    ds_read_b64 a[4:5], v16 offset:3072
    v_mfma_f32_16x16x32_bf16 v[52:55], a[64:67], a[116:119], v[52:55]
    ds_read_b64 a[6:7], v16 offset:3080
    s_lshl_b32 s3, s3, 2
    v_mfma_f32_16x16x32_bf16 v[56:59], a[64:67], a[120:123], v[56:59]
    ds_read_b128 a[40:43], v17 offset:1024
    v_mfma_f32_16x16x32_bf16 v[60:63], a[64:67], a[124:127], v[60:63]
    ds_read_b64 a[8:9], v16 offset:2560
    v_mfma_f32_16x16x32_bf16 v[60:63], a[68:71], a[120:123], v[60:63]
    ds_read_b64 a[10:11], v16 offset:2568
    s_add_u32 s3, s3, s64
    v_mfma_f32_16x16x32_bf16 v[56:59], a[68:71], a[116:119], v[56:59]
    ds_read_b128 a[44:47], v17 offset:1536
    v_mfma_f32_16x16x32_bf16 v[52:55], a[68:71], a[112:115], v[52:55]
    ds_read_b64 a[12:13], v16 offset:2048
    s_lshl_b32 s3, s3, 12
    v_mfma_f32_16x16x32_bf16 v[48:51], a[68:71], a[108:111], v[48:51]
    ds_read_b64 a[14:15], v16 offset:2056
    v_mfma_f32_16x16x32_bf16 v[44:47], a[68:71], a[104:107], v[44:47]
    ds_read_b128 a[48:51], v17 offset:2048
    v_mfma_f32_16x16x32_bf16 v[40:43], a[68:71], a[100:103], v[40:43]
    ds_read_b64 a[16:17], v16 offset:1536
    v_lshlrev_b32 v204, 6, v0
    v_mfma_f32_16x16x32_bf16 v[36:39], a[68:71], a[96:99], v[36:39]
    ds_read_b64 a[18:19], v16 offset:1544
    v_mfma_f32_16x16x32_bf16 v[40:43], a[72:75], a[96:99], v[40:43]
    ds_read_b128 a[52:55], v17 offset:2560
    v_mfma_f32_16x16x32_bf16 v[44:47], a[72:75], a[100:103], v[44:47]
    ds_read_b64 a[20:21], v16 offset:1024
    v_add_u32 v204, s3, v204
    v_mfma_f32_16x16x32_bf16 v[48:51], a[72:75], a[104:107], v[48:51]
    ds_read_b64 a[22:23], v16 offset:1032
    v_mfma_f32_16x16x32_bf16 v[52:55], a[72:75], a[108:111], v[52:55]
    ds_read_b128 a[56:59], v17 offset:3072
    v_min_u32 v204, L_end-L_pcc, v204
    v_mfma_f32_16x16x32_bf16 v[56:59], a[72:75], a[112:115], v[56:59]
    ds_read_b64 a[24:25], v16 offset:512
    v_mfma_f32_16x16x32_bf16 v[60:63], a[72:75], a[116:119], v[60:63]
    ds_read_b64 a[26:27], v16 offset:520
    v_mfma_f32_16x16x32_bf16 v[60:63], a[76:79], a[112:115], v[60:63]
    ds_read_b128 a[60:63], v17 offset:3584
    v_mov_b32 v205, s7
    v_mfma_f32_16x16x32_bf16 v[56:59], a[76:79], a[108:111], v[56:59]
    ds_read_b64 a[28:29], v16 offset:0
    v_mfma_f32_16x16x32_bf16 v[52:55], a[76:79], a[104:107], v[52:55]
    ds_read_b64 a[30:31], v16 offset:8
    v_add_co_u32 v204, vcc, s6, v204
    v_mfma_f32_16x16x32_bf16 v[48:51], a[76:79], a[100:103], v[48:51]
    v_mfma_f32_16x16x32_bf16 v[44:47], a[76:79], a[96:99], v[44:47]
    v_mfma_f32_16x16x32_bf16 v[48:51], a[80:83], a[96:99], v[48:51]
    s_nop 1
    v_mfma_f32_16x16x32_bf16 v[52:55], a[80:83], a[100:103], v[52:55]
    v_mfma_f32_16x16x32_bf16 v[56:59], a[80:83], a[104:107], v[56:59]
    v_addc_co_u32 v205, vcc, 0, v205, vcc
    v_mfma_f32_16x16x32_bf16 v[60:63], a[80:83], a[108:111], v[60:63]
    v_mfma_f32_16x16x32_bf16 v[60:63], a[84:87], a[104:107], v[60:63]
    v_mfma_f32_16x16x32_bf16 v[56:59], a[84:87], a[100:103], v[56:59]
    global_load_dword a255, v[204:205], off
    v_mfma_f32_16x16x32_bf16 v[52:55], a[84:87], a[96:99], v[52:55]
    v_subrev_u32 v16, 64, v16
    v_subrev_u32 v17, 64, v17
    v_mfma_f32_16x16x32_bf16 v[56:59], a[88:91], a[96:99], v[56:59]
    v_mfma_f32_16x16x32_bf16 v[60:63], a[88:91], a[100:103], v[60:63]
    v_mfma_f32_16x16x32_bf16 v[60:63], a[92:95], a[96:99], v[60:63]
    s_waitcnt lgkmcnt(0)
    v_mfma_f32_16x16x32_bf16 v[32:35], a[0:3], a[32:35], v[32:35]
    ds_read_b128 a[96:99], v17 offset:0
    v_mfma_f32_16x16x32_bf16 v[36:39], a[0:3], a[36:39], v[36:39]
    ds_read_b64 a[64:65], v16 offset:3584
    s_add_u32 m0, s71, 16384
    v_mfma_f32_16x16x32_bf16 v[40:43], a[0:3], a[40:43], v[40:43]
    ds_read_b64 a[66:67], v16 offset:3592
    buffer_load_dwordx4 v194, s[44:47], s76 offen lds
    v_mfma_f32_16x16x32_bf16 v[44:47], a[0:3], a[44:47], v[44:47]
    ds_read_b128 a[100:103], v17 offset:512
    v_mfma_f32_16x16x32_bf16 v[48:51], a[0:3], a[48:51], v[48:51]
    ds_read_b64 a[68:69], v16 offset:3072
    v_mfma_f32_16x16x32_bf16 v[52:55], a[0:3], a[52:55], v[52:55]
    ds_read_b64 a[70:71], v16 offset:3080
    v_mfma_f32_16x16x32_bf16 v[56:59], a[0:3], a[56:59], v[56:59]
    ds_read_b128 a[104:107], v17 offset:1024
    buffer_load_dwordx4 v195, s[44:47], s76 offen offset:1024 lds
    v_mfma_f32_16x16x32_bf16 v[60:63], a[0:3], a[60:63], v[60:63]
    ds_read_b64 a[72:73], v16 offset:2560
    v_mfma_f32_16x16x32_bf16 v[60:63], a[4:7], a[56:59], v[60:63]
    ds_read_b64 a[74:75], v16 offset:2568
    s_add_u32 s76, s76, 0x10000
    v_mfma_f32_16x16x32_bf16 v[56:59], a[4:7], a[52:55], v[56:59]
    ds_read_b128 a[108:111], v17 offset:1536
    s_add_u32 m0, s71, 24576
    v_mfma_f32_16x16x32_bf16 v[52:55], a[4:7], a[48:51], v[52:55]
    ds_read_b64 a[76:77], v16 offset:2048
    buffer_load_dwordx4 v194, s[44:47], s76 offen lds
    v_mfma_f32_16x16x32_bf16 v[48:51], a[4:7], a[44:47], v[48:51]
    ds_read_b64 a[78:79], v16 offset:2056
    v_mfma_f32_16x16x32_bf16 v[44:47], a[4:7], a[40:43], v[44:47]
    ds_read_b128 a[112:115], v17 offset:2048
    v_mfma_f32_16x16x32_bf16 v[40:43], a[4:7], a[36:39], v[40:43]
    ds_read_b64 a[80:81], v16 offset:1536
    v_mfma_f32_16x16x32_bf16 v[36:39], a[4:7], a[32:35], v[36:39]
    ds_read_b64 a[82:83], v16 offset:1544
    buffer_load_dwordx4 v195, s[44:47], s76 offen offset:1024 lds
    v_mfma_f32_16x16x32_bf16 v[40:43], a[8:11], a[32:35], v[40:43]
    ds_read_b128 a[116:119], v17 offset:2560
    v_mfma_f32_16x16x32_bf16 v[44:47], a[8:11], a[36:39], v[44:47]
    ds_read_b64 a[84:85], v16 offset:1024
    s_add_u32 s76, s76, 0x10000
    v_mfma_f32_16x16x32_bf16 v[48:51], a[8:11], a[40:43], v[48:51]
    ds_read_b64 a[86:87], v16 offset:1032
    s_add_u32 m0, s71, 32768
    v_mfma_f32_16x16x32_bf16 v[52:55], a[8:11], a[44:47], v[52:55]
    ds_read_b128 a[120:123], v17 offset:3072
    buffer_load_dwordx4 v194, s[44:47], s76 offen lds
    v_mfma_f32_16x16x32_bf16 v[56:59], a[8:11], a[48:51], v[56:59]
    ds_read_b64 a[88:89], v16 offset:512
    v_mfma_f32_16x16x32_bf16 v[60:63], a[8:11], a[52:55], v[60:63]
    ds_read_b64 a[90:91], v16 offset:520
    v_mfma_f32_16x16x32_bf16 v[60:63], a[12:15], a[48:51], v[60:63]
    ds_read_b128 a[124:127], v17 offset:3584
    v_mfma_f32_16x16x32_bf16 v[56:59], a[12:15], a[44:47], v[56:59]
    ds_read_b64 a[92:93], v16 offset:0
    buffer_load_dwordx4 v195, s[44:47], s76 offen offset:1024 lds
    v_mfma_f32_16x16x32_bf16 v[52:55], a[12:15], a[40:43], v[52:55]
    ds_read_b64 a[94:95], v16 offset:8
    v_mfma_f32_16x16x32_bf16 v[48:51], a[12:15], a[36:39], v[48:51]
    s_add_u32 s76, s76, 0x10000
    v_mfma_f32_16x16x32_bf16 v[44:47], a[12:15], a[32:35], v[44:47]
    s_add_u32 m0, s71, 40960
    v_mfma_f32_16x16x32_bf16 v[48:51], a[16:19], a[32:35], v[48:51]
    buffer_load_dwordx4 v194, s[44:47], s76 offen lds
    v_mfma_f32_16x16x32_bf16 v[52:55], a[16:19], a[36:39], v[52:55]
    v_mfma_f32_16x16x32_bf16 v[56:59], a[16:19], a[40:43], v[56:59]
    v_mfma_f32_16x16x32_bf16 v[60:63], a[16:19], a[44:47], v[60:63]
    v_mfma_f32_16x16x32_bf16 v[60:63], a[20:23], a[40:43], v[60:63]
    buffer_load_dwordx4 v195, s[44:47], s76 offen offset:1024 lds
    v_mfma_f32_16x16x32_bf16 v[56:59], a[20:23], a[36:39], v[56:59]
    s_add_u32 s76, s76, 0x10000
    v_mfma_f32_16x16x32_bf16 v[52:55], a[20:23], a[32:35], v[52:55]
    v_subrev_u32 v16, 64, v16
    v_subrev_u32 v17, 64, v17
    v_mfma_f32_16x16x32_bf16 v[56:59], a[24:27], a[32:35], v[56:59]
    v_mfma_f32_16x16x32_bf16 v[60:63], a[24:27], a[36:39], v[60:63]
    v_mfma_f32_16x16x32_bf16 v[60:63], a[28:31], a[32:35], v[60:63]
    s_waitcnt lgkmcnt(0)
    v_mfma_f32_16x16x32_bf16 v[32:35], a[64:67], a[96:99], v[32:35]
    ds_read_b128 a[32:35], v17 offset:0
    v_mfma_f32_16x16x32_bf16 v[36:39], a[64:67], a[100:103], v[36:39]
    ds_read_b64 a[0:1], v16 offset:3584
    s_add_u32 m0, s71, 49152
    v_mfma_f32_16x16x32_bf16 v[40:43], a[64:67], a[104:107], v[40:43]
    ds_read_b64 a[2:3], v16 offset:3592
    buffer_load_dwordx4 v194, s[44:47], s76 offen lds
    v_mfma_f32_16x16x32_bf16 v[44:47], a[64:67], a[108:111], v[44:47]
    ds_read_b128 a[36:39], v17 offset:512
    v_mfma_f32_16x16x32_bf16 v[48:51], a[64:67], a[112:115], v[48:51]
    ds_read_b64 a[4:5], v16 offset:3072
    v_mfma_f32_16x16x32_bf16 v[52:55], a[64:67], a[116:119], v[52:55]
    ds_read_b64 a[6:7], v16 offset:3080
    v_mfma_f32_16x16x32_bf16 v[56:59], a[64:67], a[120:123], v[56:59]
    ds_read_b128 a[40:43], v17 offset:1024
    buffer_load_dwordx4 v195, s[44:47], s76 offen offset:1024 lds
    v_mfma_f32_16x16x32_bf16 v[60:63], a[64:67], a[124:127], v[60:63]
    ds_read_b64 a[8:9], v16 offset:2560
    v_mfma_f32_16x16x32_bf16 v[60:63], a[68:71], a[120:123], v[60:63]
    ds_read_b64 a[10:11], v16 offset:2568
    s_add_u32 s76, s76, 0x10000
    v_mfma_f32_16x16x32_bf16 v[56:59], a[68:71], a[116:119], v[56:59]
    ds_read_b128 a[44:47], v17 offset:1536
    s_add_u32 m0, s71, 57344
    v_mfma_f32_16x16x32_bf16 v[52:55], a[68:71], a[112:115], v[52:55]
    ds_read_b64 a[12:13], v16 offset:2048
    buffer_load_dwordx4 v194, s[44:47], s76 offen lds
    v_mfma_f32_16x16x32_bf16 v[48:51], a[68:71], a[108:111], v[48:51]
    ds_read_b64 a[14:15], v16 offset:2056
    v_mfma_f32_16x16x32_bf16 v[44:47], a[68:71], a[104:107], v[44:47]
    ds_read_b128 a[48:51], v17 offset:2048
    v_mfma_f32_16x16x32_bf16 v[40:43], a[68:71], a[100:103], v[40:43]
    ds_read_b64 a[16:17], v16 offset:1536
    v_mfma_f32_16x16x32_bf16 v[36:39], a[68:71], a[96:99], v[36:39]
    ds_read_b64 a[18:19], v16 offset:1544
    buffer_load_dwordx4 v195, s[44:47], s76 offen offset:1024 lds
    v_mfma_f32_16x16x32_bf16 v[40:43], a[72:75], a[96:99], v[40:43]
    ds_read_b128 a[52:55], v17 offset:2560
    v_mfma_f32_16x16x32_bf16 v[44:47], a[72:75], a[100:103], v[44:47]
    ds_read_b64 a[20:21], v16 offset:1024
    s_add_u32 s76, s76, 0x10000
    v_mfma_f32_16x16x32_bf16 v[48:51], a[72:75], a[104:107], v[48:51]
    ds_read_b64 a[22:23], v16 offset:1032
    s_add_u32 m0, s71, 65536
    v_mfma_f32_16x16x32_bf16 v[52:55], a[72:75], a[108:111], v[52:55]
    ds_read_b128 a[56:59], v17 offset:3072
    buffer_load_dwordx4 v194, s[44:47], s76 offen lds
    v_mfma_f32_16x16x32_bf16 v[56:59], a[72:75], a[112:115], v[56:59]
    ds_read_b64 a[24:25], v16 offset:512
    v_mfma_f32_16x16x32_bf16 v[60:63], a[72:75], a[116:119], v[60:63]
    ds_read_b64 a[26:27], v16 offset:520
    v_mfma_f32_16x16x32_bf16 v[60:63], a[76:79], a[112:115], v[60:63]
    ds_read_b128 a[60:63], v17 offset:3584
    v_mfma_f32_16x16x32_bf16 v[56:59], a[76:79], a[108:111], v[56:59]
    ds_read_b64 a[28:29], v16 offset:0
    buffer_load_dwordx4 v195, s[44:47], s76 offen offset:1024 lds
    v_mfma_f32_16x16x32_bf16 v[52:55], a[76:79], a[104:107], v[52:55]
    ds_read_b64 a[30:31], v16 offset:8
    v_mfma_f32_16x16x32_bf16 v[48:51], a[76:79], a[100:103], v[48:51]
    s_add_u32 s76, s76, 0x10000
    v_mfma_f32_16x16x32_bf16 v[44:47], a[76:79], a[96:99], v[44:47]
    s_add_u32 m0, s71, 73728
    v_mfma_f32_16x16x32_bf16 v[48:51], a[80:83], a[96:99], v[48:51]
    buffer_load_dwordx4 v194, s[44:47], s76 offen lds
    v_mfma_f32_16x16x32_bf16 v[52:55], a[80:83], a[100:103], v[52:55]
    v_mfma_f32_16x16x32_bf16 v[56:59], a[80:83], a[104:107], v[56:59]
    v_mfma_f32_16x16x32_bf16 v[60:63], a[80:83], a[108:111], v[60:63]
    v_mfma_f32_16x16x32_bf16 v[60:63], a[84:87], a[104:107], v[60:63]
    buffer_load_dwordx4 v195, s[44:47], s76 offen offset:1024 lds
    v_mfma_f32_16x16x32_bf16 v[56:59], a[84:87], a[100:103], v[56:59]
    s_add_u32 s76, s76, 0x10000
    v_mfma_f32_16x16x32_bf16 v[52:55], a[84:87], a[96:99], v[52:55]
    v_subrev_u32 v16, 64, v16
    v_subrev_u32 v17, 64, v17
    v_mfma_f32_16x16x32_bf16 v[56:59], a[88:91], a[96:99], v[56:59]
    v_mfma_f32_16x16x32_bf16 v[60:63], a[88:91], a[100:103], v[60:63]
    v_mfma_f32_16x16x32_bf16 v[60:63], a[92:95], a[96:99], v[60:63]
    s_waitcnt lgkmcnt(0)
    v_mfma_f32_16x16x32_bf16 v[32:35], a[0:3], a[32:35], v[32:35]
    ds_read_b128 a[96:99], v17 offset:0
    buffer_load_dword v22, v23, s[36:39], s77 offen sc1
    v_mfma_f32_16x16x32_bf16 v[36:39], a[0:3], a[36:39], v[36:39]
    ds_read_b64 a[64:65], v16 offset:3584
    v_mfma_f32_16x16x32_bf16 v[40:43], a[0:3], a[40:43], v[40:43]
    ds_read_b64 a[66:67], v16 offset:3592
    v_mfma_f32_16x16x32_bf16 v[44:47], a[0:3], a[44:47], v[44:47]
    ds_read_b128 a[100:103], v17 offset:512
    v_mfma_f32_16x16x32_bf16 v[48:51], a[0:3], a[48:51], v[48:51]
    ds_read_b64 a[68:69], v16 offset:3072
    v_mfma_f32_16x16x32_bf16 v[52:55], a[0:3], a[52:55], v[52:55]
    ds_read_b64 a[70:71], v16 offset:3080
    v_mfma_f32_16x16x32_bf16 v[56:59], a[0:3], a[56:59], v[56:59]
    ds_read_b128 a[104:107], v17 offset:1024
    v_mfma_f32_16x16x32_bf16 v[60:63], a[0:3], a[60:63], v[60:63]
    ds_read_b64 a[72:73], v16 offset:2560
    v_mfma_f32_16x16x32_bf16 v[60:63], a[4:7], a[56:59], v[60:63]
    ds_read_b64 a[74:75], v16 offset:2568
    v_mfma_f32_16x16x32_bf16 v[56:59], a[4:7], a[52:55], v[56:59]
    ds_read_b128 a[108:111], v17 offset:1536
    v_mfma_f32_16x16x32_bf16 v[52:55], a[4:7], a[48:51], v[52:55]
    ds_read_b64 a[76:77], v16 offset:2048
    v_mfma_f32_16x16x32_bf16 v[48:51], a[4:7], a[44:47], v[48:51]
    ds_read_b64 a[78:79], v16 offset:2056
    v_mfma_f32_16x16x32_bf16 v[44:47], a[4:7], a[40:43], v[44:47]
    ds_read_b128 a[112:115], v17 offset:2048
    v_mfma_f32_16x16x32_bf16 v[40:43], a[4:7], a[36:39], v[40:43]
    ds_read_b64 a[80:81], v16 offset:1536
    v_mfma_f32_16x16x32_bf16 v[36:39], a[4:7], a[32:35], v[36:39]
    ds_read_b64 a[82:83], v16 offset:1544
    v_mfma_f32_16x16x32_bf16 v[40:43], a[8:11], a[32:35], v[40:43]
    ds_read_b128 a[116:119], v17 offset:2560
    v_mfma_f32_16x16x32_bf16 v[44:47], a[8:11], a[36:39], v[44:47]
    ds_read_b64 a[84:85], v16 offset:1024
    v_mfma_f32_16x16x32_bf16 v[48:51], a[8:11], a[40:43], v[48:51]
    ds_read_b64 a[86:87], v16 offset:1032
    v_mfma_f32_16x16x32_bf16 v[52:55], a[8:11], a[44:47], v[52:55]
    ds_read_b128 a[120:123], v17 offset:3072
    v_mfma_f32_16x16x32_bf16 v[56:59], a[8:11], a[48:51], v[56:59]
    ds_read_b64 a[88:89], v16 offset:512
    v_mfma_f32_16x16x32_bf16 v[60:63], a[8:11], a[52:55], v[60:63]
    ds_read_b64 a[90:91], v16 offset:520
    v_mfma_f32_16x16x32_bf16 v[60:63], a[12:15], a[48:51], v[60:63]
    ds_read_b128 a[124:127], v17 offset:3584
    v_mfma_f32_16x16x32_bf16 v[56:59], a[12:15], a[44:47], v[56:59]
    ds_read_b64 a[92:93], v16 offset:0
    v_mfma_f32_16x16x32_bf16 v[52:55], a[12:15], a[40:43], v[52:55]
    ds_read_b64 a[94:95], v16 offset:8
    v_mfma_f32_16x16x32_bf16 v[48:51], a[12:15], a[36:39], v[48:51]
    v_mfma_f32_16x16x32_bf16 v[44:47], a[12:15], a[32:35], v[44:47]
    v_mfma_f32_16x16x32_bf16 v[48:51], a[16:19], a[32:35], v[48:51]
    v_mfma_f32_16x16x32_bf16 v[52:55], a[16:19], a[36:39], v[52:55]
    v_mfma_f32_16x16x32_bf16 v[56:59], a[16:19], a[40:43], v[56:59]
    v_mfma_f32_16x16x32_bf16 v[60:63], a[16:19], a[44:47], v[60:63]
    v_mfma_f32_16x16x32_bf16 v[60:63], a[20:23], a[40:43], v[60:63]
    v_mfma_f32_16x16x32_bf16 v[56:59], a[20:23], a[36:39], v[56:59]
    v_mfma_f32_16x16x32_bf16 v[52:55], a[20:23], a[32:35], v[52:55]
    v_subrev_u32 v16, 64, v16
    v_subrev_u32 v17, 64, v17
    v_mfma_f32_16x16x32_bf16 v[56:59], a[24:27], a[32:35], v[56:59]
    v_mfma_f32_16x16x32_bf16 v[60:63], a[24:27], a[36:39], v[60:63]
    v_mfma_f32_16x16x32_bf16 v[60:63], a[28:31], a[32:35], v[60:63]
    s_waitcnt lgkmcnt(0)
    v_mfma_f32_16x16x32_bf16 v[32:35], a[64:67], a[96:99], v[32:35]
    v_lshlrev_b32 v12, 5, v3
    v_mfma_f32_16x16x32_bf16 v[36:39], a[64:67], a[100:103], v[36:39]
    v_lshl_add_u32 v12, v28, 3, v12
    v_mfma_f32_16x16x32_bf16 v[40:43], a[64:67], a[104:107], v[40:43]
    v_mfma_f32_16x16x32_bf16 v[44:47], a[64:67], a[108:111], v[44:47]
    v_mfma_f32_16x16x32_bf16 v[48:51], a[64:67], a[112:115], v[48:51]
    s_add_u32 s78, s70, 504
    v_mfma_f32_16x16x32_bf16 v[52:55], a[64:67], a[116:119], v[52:55]
    v_mfma_f32_16x16x32_bf16 v[56:59], a[64:67], a[120:123], v[56:59]
    v_mfma_f32_16x16x32_bf16 v[60:63], a[64:67], a[124:127], v[60:63]
    v_sub_u32 v13, s78, v12
    v_mfma_f32_16x16x32_bf16 v[60:63], a[68:71], a[120:123], v[60:63]
    v_mfma_f32_16x16x32_bf16 v[56:59], a[68:71], a[116:119], v[56:59]
    v_mfma_f32_16x16x32_bf16 v[52:55], a[68:71], a[112:115], v[52:55]
    ds_read_b64 v[224:225], v13 offset:3584
    v_mfma_f32_16x16x32_bf16 v[48:51], a[68:71], a[108:111], v[48:51]
    v_mfma_f32_16x16x32_bf16 v[44:47], a[68:71], a[104:107], v[44:47]
    v_mfma_f32_16x16x32_bf16 v[40:43], a[68:71], a[100:103], v[40:43]
    ds_read_b64 v[226:227], v13 offset:3072
    v_mfma_f32_16x16x32_bf16 v[36:39], a[68:71], a[96:99], v[36:39]
    v_mfma_f32_16x16x32_bf16 v[40:43], a[72:75], a[96:99], v[40:43]
    v_mfma_f32_16x16x32_bf16 v[44:47], a[72:75], a[100:103], v[44:47]
    ds_read_b64 v[228:229], v13 offset:2560
    v_mfma_f32_16x16x32_bf16 v[48:51], a[72:75], a[104:107], v[48:51]
    v_mfma_f32_16x16x32_bf16 v[52:55], a[72:75], a[108:111], v[52:55]
    v_mfma_f32_16x16x32_bf16 v[56:59], a[72:75], a[112:115], v[56:59]
    ds_read_b64 v[230:231], v13 offset:2048
    v_mfma_f32_16x16x32_bf16 v[60:63], a[72:75], a[116:119], v[60:63]
    v_mfma_f32_16x16x32_bf16 v[60:63], a[76:79], a[112:115], v[60:63]
    v_mfma_f32_16x16x32_bf16 v[56:59], a[76:79], a[108:111], v[56:59]
    ds_read_b64 v[232:233], v13 offset:1536
    v_mfma_f32_16x16x32_bf16 v[52:55], a[76:79], a[104:107], v[52:55]
    v_mfma_f32_16x16x32_bf16 v[48:51], a[76:79], a[100:103], v[48:51]
    v_mfma_f32_16x16x32_bf16 v[44:47], a[76:79], a[96:99], v[44:47]
    ds_read_b64 v[234:235], v13 offset:1024
    v_mfma_f32_16x16x32_bf16 v[48:51], a[80:83], a[96:99], v[48:51]
    v_mfma_f32_16x16x32_bf16 v[52:55], a[80:83], a[100:103], v[52:55]
    v_mfma_f32_16x16x32_bf16 v[56:59], a[80:83], a[104:107], v[56:59]
    ds_read_b64 v[236:237], v13 offset:512
    v_mfma_f32_16x16x32_bf16 v[60:63], a[80:83], a[108:111], v[60:63]
    v_mfma_f32_16x16x32_bf16 v[60:63], a[84:87], a[104:107], v[60:63]
    v_mfma_f32_16x16x32_bf16 v[56:59], a[84:87], a[100:103], v[56:59]
    ds_read_b64 v[238:239], v13 offset:0
    v_mfma_f32_16x16x32_bf16 v[52:55], a[84:87], a[96:99], v[52:55]
    v_mfma_f32_16x16x32_bf16 v[56:59], a[88:91], a[96:99], v[56:59]
    v_mfma_f32_16x16x32_bf16 v[60:63], a[88:91], a[100:103], v[60:63]
    v_mfma_f32_16x16x32_bf16 v[60:63], a[92:95], a[96:99], v[60:63]
    s_waitcnt lgkmcnt(0)
    s_waitcnt vmcnt(0)
    s_mov_b32 s82, 0
L_f1_chk:
    v_cmp_ne_u32 vcc, 0, v22
    s_cmp_eq_u64 vcc, exec
    s_cbranch_scc1 L_f1_ok
    s_sleep 1
    buffer_load_dword v22, v23, s[36:39], s77 offen sc1
    s_waitcnt vmcnt(0)
    s_add_u32 s82, s82, 1
    s_cmp_lt_u32 s82, 200000
    s_cbranch_scc1 L_f1_chk
L_f1_ok:
    s_barrier
    s_add_u32 m0, s74, 16384
    s_nop 0
    buffer_load_dwordx4 v192, s[20:23], s75 offen sc1 lds
    buffer_load_dwordx4 v193, s[20:23], s75 offen offset:1024 sc1 lds
    s_add_u32 s75, s75, 1024
    s_add_u32 m0, s74, 24576
    s_nop 0
    buffer_load_dwordx4 v192, s[20:23], s75 offen sc1 lds
    buffer_load_dwordx4 v193, s[20:23], s75 offen offset:1024 sc1 lds
    s_add_u32 s75, s75, 1024
    s_add_u32 m0, s74, 32768
    s_nop 0
    buffer_load_dwordx4 v192, s[20:23], s75 offen sc1 lds
    buffer_load_dwordx4 v193, s[20:23], s75 offen offset:1024 sc1 lds
    s_add_u32 s75, s75, 1024
    s_add_u32 m0, s74, 40960
    s_nop 0
    buffer_load_dwordx4 v192, s[20:23], s75 offen sc1 lds
    buffer_load_dwordx4 v193, s[20:23], s75 offen offset:1024 sc1 lds
    s_add_u32 s75, s75, 1024
    s_add_u32 m0, s74, 49152
    s_nop 0
    buffer_load_dwordx4 v192, s[20:23], s75 offen sc1 lds
    buffer_load_dwordx4 v193, s[20:23], s75 offen offset:1024 sc1 lds
    s_add_u32 s75, s75, 1024
    s_add_u32 m0, s74, 57344
    s_nop 0
    buffer_load_dwordx4 v192, s[20:23], s75 offen sc1 lds
    buffer_load_dwordx4 v193, s[20:23], s75 offen offset:1024 sc1 lds
    s_add_u32 s75, s75, 1024
    s_add_u32 m0, s74, 65536
    s_nop 0
    buffer_load_dwordx4 v192, s[20:23], s75 offen sc1 lds
    buffer_load_dwordx4 v193, s[20:23], s75 offen offset:1024 sc1 lds
    s_add_u32 s75, s75, 1024
    s_add_u32 m0, s74, 73728
    s_nop 0
    buffer_load_dwordx4 v192, s[20:23], s75 offen sc1 lds
    buffer_load_dwordx4 v193, s[20:23], s75 offen offset:1024 sc1 lds
    s_add_u32 s75, s75, 1024
    s_and_b32 s78, s69, 1
    s_lshl_b32 s78, s78, 4
    s_lshr_b32 s90, s90, s78
    s_lshl_b32 s90, s90, 16
    v_lshlrev_b32 v12, 5, v3
    v_lshrrev_b32 v13, 1, v28
    v_lshl_add_u32 v12, v13, 4, v12
    v_and_b32 v13, 1, v28
    v_lshl_add_u32 v12, v13, 9, v12
    v_and_b32 v4, 0xffff0000, v225
    v_lshlrev_b32 v5, 16, v225
    v_and_b32 v6, 0xffff0000, v224
    v_lshlrev_b32 v7, 16, v224
    v_fmac_f32 v32, s90, v4
    v_fmac_f32 v33, s90, v5
    v_fmac_f32 v34, s90, v6
    v_fmac_f32 v35, s90, v7
    v_cvt_pk_bf16_f32 v224, v32, v33
    v_cvt_pk_bf16_f32 v225, v34, v35
    v_and_b32 v4, 0xffff0000, v227
    v_lshlrev_b32 v5, 16, v227
    v_and_b32 v6, 0xffff0000, v226
    v_lshlrev_b32 v7, 16, v226
    v_fmac_f32 v36, s90, v4
    v_fmac_f32 v37, s90, v5
    v_fmac_f32 v38, s90, v6
    v_fmac_f32 v39, s90, v7
    v_cvt_pk_bf16_f32 v226, v36, v37
    v_cvt_pk_bf16_f32 v227, v38, v39
    v_and_b32 v4, 0xffff0000, v229
    v_lshlrev_b32 v5, 16, v229
    v_and_b32 v6, 0xffff0000, v228
    v_lshlrev_b32 v7, 16, v228
    v_fmac_f32 v40, s90, v4
    v_fmac_f32 v41, s90, v5
    v_fmac_f32 v42, s90, v6
    v_fmac_f32 v43, s90, v7
    v_cvt_pk_bf16_f32 v228, v40, v41
    v_cvt_pk_bf16_f32 v229, v42, v43
    v_and_b32 v4, 0xffff0000, v231
    v_lshlrev_b32 v5, 16, v231
    v_and_b32 v6, 0xffff0000, v230
    v_lshlrev_b32 v7, 16, v230
    v_fmac_f32 v44, s90, v4
    v_fmac_f32 v45, s90, v5
    v_fmac_f32 v46, s90, v6
    v_fmac_f32 v47, s90, v7
    v_cvt_pk_bf16_f32 v230, v44, v45
    v_cvt_pk_bf16_f32 v231, v46, v47
    v_and_b32 v4, 0xffff0000, v233
    v_lshlrev_b32 v5, 16, v233
    v_and_b32 v6, 0xffff0000, v232
    v_lshlrev_b32 v7, 16, v232
    v_fmac_f32 v48, s90, v4
    v_fmac_f32 v49, s90, v5
    v_fmac_f32 v50, s90, v6
    v_fmac_f32 v51, s90, v7
    v_cvt_pk_bf16_f32 v232, v48, v49
    v_cvt_pk_bf16_f32 v233, v50, v51
    v_and_b32 v4, 0xffff0000, v235
    v_lshlrev_b32 v5, 16, v235
    v_and_b32 v6, 0xffff0000, v234
    v_lshlrev_b32 v7, 16, v234
    v_fmac_f32 v52, s90, v4
    v_fmac_f32 v53, s90, v5
    v_fmac_f32 v54, s90, v6
    v_fmac_f32 v55, s90, v7
    v_cvt_pk_bf16_f32 v234, v52, v53
    v_cvt_pk_bf16_f32 v235, v54, v55
    v_and_b32 v4, 0xffff0000, v237
    v_lshlrev_b32 v5, 16, v237
    v_and_b32 v6, 0xffff0000, v236
    v_lshlrev_b32 v7, 16, v236
    v_fmac_f32 v56, s90, v4
    v_fmac_f32 v57, s90, v5
    v_fmac_f32 v58, s90, v6
    v_fmac_f32 v59, s90, v7
    v_cvt_pk_bf16_f32 v236, v56, v57
    v_cvt_pk_bf16_f32 v237, v58, v59
    v_and_b32 v4, 0xffff0000, v239
    v_lshlrev_b32 v5, 16, v239
    v_and_b32 v6, 0xffff0000, v238
    v_lshlrev_b32 v7, 16, v238
    v_fmac_f32 v60, s90, v4
    v_fmac_f32 v61, s90, v5
    v_fmac_f32 v62, s90, v6
    v_fmac_f32 v63, s90, v7
    v_cvt_pk_bf16_f32 v238, v60, v61
    v_cvt_pk_bf16_f32 v239, v62, v63
    s_nop 1
    v_permlane16_swap_b32 v224, v226
    v_permlane16_swap_b32 v225, v227
    v_permlane16_swap_b32 v228, v230
    v_permlane16_swap_b32 v229, v231
    v_permlane16_swap_b32 v232, v234
    v_permlane16_swap_b32 v233, v235
    v_permlane16_swap_b32 v236, v238
    v_permlane16_swap_b32 v237, v239
    buffer_store_dwordx4 v[224:227], v12, s[32:35], s84 offen offset:0 sc1
    buffer_store_dwordx4 v[228:231], v12, s[32:35], s84 offen offset:1024 sc1
    buffer_store_dwordx4 v[232:235], v12, s[32:35], s84 offen offset:2048 sc1
    buffer_store_dwordx4 v[236:239], v12, s[32:35], s84 offen offset:3072 sc1
    v_mov_b32 v240, -1
    v_mov_b32 v241, -1
    v_mov_b32 v242, -1
    v_mov_b32 v243, -1
    s_lshl_b32 s83, s69, 12
    s_add_u32 s83, s83, 1048576
    buffer_store_dwordx4 v[240:243], v2, s[36:39], s83 offen offset:0 sc1
    buffer_store_dwordx4 v[240:243], v2, s[36:39], s83 offen offset:1024 sc1
    buffer_store_dwordx4 v[240:243], v2, s[36:39], s83 offen offset:2048 sc1
    buffer_store_dwordx4 v[240:243], v2, s[36:39], s83 offen offset:3072 sc1
    s_movk_i32 s7, 16384
    s_mov_b32 s66, 0
    v_add_u32 v214, s7, v200
    v_add_u32 v210, s7, v196
    v_add_u32 v211, s7, v197
    v_add_u32 v212, s7, v198
    v_add_u32 v213, s7, v199
    v_add_u32 v215, s7, v201
    s_add_u32 s7, s7, 16384
    s_cmp_eq_u32 s7, 81920
    s_cselect_b32 s7, 0, s7
    v_add_u32 v220, s7, v200
    v_add_u32 v216, s7, v196
    v_add_u32 v217, s7, v197
    v_add_u32 v218, s7, v198
    v_add_u32 v219, s7, v199
    v_add_u32 v221, s7, v201
    v_and_b32 v6, 1, v28
    v_lshrrev_b32 v7, 1, v28
    v_lshl_or_b32 v6, v6, 1, v7
    s_lshl_b32 s85, s67, 3
    s_lshl_b32 s78, s72, 2
    s_add_u32 s85, s85, s78
    s_lshl_b32 s78, s4, 1
    s_add_u32 s85, s85, s78
    s_lshl_b32 s87, s68, 1
    s_add_u32 s87, s87, s73
    s_lshl_b32 s78, s85, 15
    s_lshl_b32 s79, s87, 7
    s_add_u32 s78, s78, s79
    v_lshlrev_b32 v24, 11, v3
    v_lshl_add_u32 v24, v6, 4, v24
    v_add_u32 v24, s78, v24
    v_add_u32 v25, 0x8000, v24
    v_lshlrev_b32 v26, 3, v3
    s_lshl_b32 s86, s85, 7
    s_lshl_b32 s77, s87, 6
    v_add_u32 v23, s77, v23
    s_xor_b32 s77, s2, 1
    s_lshl_b32 s77, s77, 2
    v_mov_b32 v4, s77
    v_cmp_gt_u32 vcc, 16, v0
    s_movk_i32 s77, 17408
    s_nop 0
    v_cndmask_b32 v23, v4, v23, vcc
    v_lshrrev_b32 v21, 2, v0
    v_lshlrev_b32 v21, 12, v21
    v_and_b32 v27, 3, v0
    v_lshl_add_u32 v21, v27, 4, v21
    s_lshl_b32 s78, s87, 18
    s_lshl_b32 s79, s85, 5
    s_add_u32 s78, s78, s79
    v_add_u32 v21, s78, v21
    s_lshl_b32 s5, s64, 12
    s_add_u32 s5, s5, 65536
    v_bfe_u32 v7, v0, 2, 2
    v_lshl_add_u32 v7, v6, 3, v7
    v_lshlrev_b32 v7, 6, v7
    v_lshl_add_u32 v7, v27, 3, v7
    v_add_u32 v7, s5, v7
    s_xor_b32 s84, s83, 0x4000
    s_waitcnt vmcnt(20)
    s_barrier
    ds_read_b64 a[16:17], v214 offset:0
    ds_read_b64 a[18:19], v214 offset:512
    ds_read_b64_tr_b16 a[0:1], v210 offset:0
    ds_read_b64_tr_b16 a[2:3], v210 offset:4096
    ds_read_b64_tr_b16 a[4:5], v211 offset:0
    ds_read_b64_tr_b16 a[6:7], v211 offset:4096
    ds_read_b64_tr_b16 a[8:9], v212 offset:0
    ds_read_b64_tr_b16 a[10:11], v212 offset:4096
    ds_read_b64_tr_b16 a[12:13], v213 offset:0
    ds_read_b64_tr_b16 a[14:15], v213 offset:4096
    ds_read_b64 a[20:21], v214 offset:1024
    ds_read_b64 a[22:23], v214 offset:1536
    ds_read_b64 a[24:25], v215 offset:0
    ds_read_b64 a[26:27], v215 offset:512
    ds_read_b64 a[28:29], v215 offset:1024
    ds_read_b64 a[30:31], v215 offset:1536
    ds_read_b64 a[48:49], v214 offset:8192
    ds_read_b64 a[50:51], v214 offset:8704
    ds_read_b64_tr_b16 a[32:33], v210 offset:8192
    ds_read_b64_tr_b16 a[34:35], v210 offset:12288
    ds_read_b64_tr_b16 a[36:37], v211 offset:8192
    ds_read_b64_tr_b16 a[38:39], v211 offset:12288
    ds_read_b64_tr_b16 a[40:41], v212 offset:8192
    ds_read_b64_tr_b16 a[42:43], v212 offset:12288
    ds_read_b64_tr_b16 a[44:45], v213 offset:8192
    ds_read_b64_tr_b16 a[46:47], v213 offset:12288
    ds_read_b64 a[52:53], v214 offset:9216
    ds_read_b64 a[54:55], v214 offset:9728
    ds_read_b64 a[56:57], v215 offset:8192
    ds_read_b64 a[58:59], v215 offset:8704
    ds_read_b64 a[60:61], v215 offset:9216
    ds_read_b64 a[62:63], v215 offset:9728
    s_waitcnt vmcnt(16) lgkmcnt(15)
    s_barrier
    v_mfma_f32_16x16x32_bf16 v[64:67], a[0:3], a[16:19], 0
    ds_read_b64 a[80:81], v220 offset:0
    s_add_u32 m0, s74, s66
    v_mfma_f32_16x16x32_bf16 v[80:83], a[0:3], a[20:23], 0
    ds_read_b64 a[82:83], v220 offset:512
    buffer_load_dwordx4 v192, s[20:23], s75 offen sc1 lds
    v_mfma_f32_16x16x32_bf16 v[96:99], a[0:3], a[24:27], 0
    ds_read_b64_tr_b16 a[64:65], v216 offset:0
    s_add_u32 s7, s7, 16384
    v_mfma_f32_16x16x32_bf16 v[112:115], a[0:3], a[28:31], 0
    ds_read_b64_tr_b16 a[66:67], v216 offset:4096
    s_cmp_eq_u32 s7, 81920
    s_cselect_b32 s7, 0, s7
    v_mfma_f32_16x16x32_bf16 v[116:119], a[4:7], a[28:31], 0
    ds_read_b64_tr_b16 a[68:69], v217 offset:0
    v_mfma_f32_16x16x32_bf16 v[100:103], a[4:7], a[24:27], 0
    ds_read_b64_tr_b16 a[70:71], v217 offset:4096
    buffer_load_dwordx4 v193, s[20:23], s75 offen offset:1024 sc1 lds
    v_mfma_f32_16x16x32_bf16 v[84:87], a[4:7], a[20:23], 0
    ds_read_b64_tr_b16 a[72:73], v218 offset:0
    v_add_u32 v214, s7, v200
    v_mfma_f32_16x16x32_bf16 v[68:71], a[4:7], a[16:19], 0
    ds_read_b64_tr_b16 a[74:75], v218 offset:4096
    s_add_u32 s75, s75, 1024
    v_mfma_f32_16x16x32_bf16 v[72:75], a[8:11], a[16:19], 0
    ds_read_b64_tr_b16 a[76:77], v219 offset:0
    s_add_u32 m0, s71, s66
    v_mfma_f32_16x16x32_bf16 v[88:91], a[8:11], a[20:23], 0
    ds_read_b64_tr_b16 a[78:79], v219 offset:4096
    buffer_load_dwordx4 v194, s[44:47], s76 offen lds
    v_mfma_f32_16x16x32_bf16 v[104:107], a[8:11], a[24:27], 0
    ds_read_b64 a[84:85], v220 offset:1024
    v_add_u32 v210, s7, v196
    v_mfma_f32_16x16x32_bf16 v[120:123], a[8:11], a[28:31], 0
    ds_read_b64 a[86:87], v220 offset:1536
    v_mfma_f32_16x16x32_bf16 v[124:127], a[12:15], a[28:31], 0
    ds_read_b64 a[88:89], v221 offset:0
    v_mfma_f32_16x16x32_bf16 v[108:111], a[12:15], a[24:27], 0
    ds_read_b64 a[90:91], v221 offset:512
    buffer_load_dwordx4 v195, s[44:47], s76 offen offset:1024 lds
    v_mfma_f32_16x16x32_bf16 v[92:95], a[12:15], a[20:23], 0
    ds_read_b64 a[92:93], v221 offset:1024
    s_add_u32 s76, s76, 0x10000
    v_mfma_f32_16x16x32_bf16 v[76:79], a[12:15], a[16:19], 0
    ds_read_b64 a[94:95], v221 offset:1536
    s_add_u32 s3, s74, s66
    s_waitcnt lgkmcnt(15)
    v_mfma_f32_16x16x32_bf16 v[64:67], a[32:35], a[48:51], v[64:67]
    ds_read_b64 a[112:113], v220 offset:8192
    s_add_u32 m0, s3, 8192
    v_mfma_f32_16x16x32_bf16 v[80:83], a[32:35], a[52:55], v[80:83]
    ds_read_b64 a[114:115], v220 offset:8704
    buffer_load_dwordx4 v192, s[20:23], s75 offen sc1 lds
    v_mfma_f32_16x16x32_bf16 v[96:99], a[32:35], a[56:59], v[96:99]
    ds_read_b64_tr_b16 a[96:97], v216 offset:8192
    v_add_u32 v211, s7, v197
    v_mfma_f32_16x16x32_bf16 v[112:115], a[32:35], a[60:63], v[112:115]
    ds_read_b64_tr_b16 a[98:99], v216 offset:12288
    v_add_u32 v212, s7, v198
    v_mfma_f32_16x16x32_bf16 v[116:119], a[36:39], a[60:63], v[116:119]
    ds_read_b64_tr_b16 a[100:101], v217 offset:8192
    v_mfma_f32_16x16x32_bf16 v[100:103], a[36:39], a[56:59], v[100:103]
    ds_read_b64_tr_b16 a[102:103], v217 offset:12288
    buffer_load_dwordx4 v193, s[20:23], s75 offen offset:1024 sc1 lds
    v_mfma_f32_16x16x32_bf16 v[84:87], a[36:39], a[52:55], v[84:87]
    ds_read_b64_tr_b16 a[104:105], v218 offset:8192
    s_add_u32 s75, s75, 1024
    v_mfma_f32_16x16x32_bf16 v[68:71], a[36:39], a[48:51], v[68:71]
    ds_read_b64_tr_b16 a[106:107], v218 offset:12288
    s_add_u32 s3, s71, s66
    v_mfma_f32_16x16x32_bf16 v[72:75], a[40:43], a[48:51], v[72:75]
    ds_read_b64_tr_b16 a[108:109], v219 offset:8192
    s_add_u32 m0, s3, 8192
    v_mfma_f32_16x16x32_bf16 v[88:91], a[40:43], a[52:55], v[88:91]
    ds_read_b64_tr_b16 a[110:111], v219 offset:12288
    buffer_load_dwordx4 v194, s[44:47], s76 offen lds
    v_mfma_f32_16x16x32_bf16 v[104:107], a[40:43], a[56:59], v[104:107]
    ds_read_b64 a[116:117], v220 offset:9216
    v_add_u32 v213, s7, v199
    v_mfma_f32_16x16x32_bf16 v[120:123], a[40:43], a[60:63], v[120:123]
    ds_read_b64 a[118:119], v220 offset:9728
    v_add_u32 v215, s7, v201
    v_mfma_f32_16x16x32_bf16 v[124:127], a[44:47], a[60:63], v[124:127]
    ds_read_b64 a[120:121], v221 offset:8192
    v_mfma_f32_16x16x32_bf16 v[108:111], a[44:47], a[56:59], v[108:111]
    ds_read_b64 a[122:123], v221 offset:8704
    buffer_load_dwordx4 v195, s[44:47], s76 offen offset:1024 lds
    v_mfma_f32_16x16x32_bf16 v[92:95], a[44:47], a[52:55], v[92:95]
    ds_read_b64 a[124:125], v221 offset:9216
    s_add_u32 s76, s76, 0x10000
    v_mfma_f32_16x16x32_bf16 v[76:79], a[44:47], a[48:51], v[76:79]
    ds_read_b64 a[126:127], v221 offset:9728
    s_add_u32 s66, s66, 16384
    s_cmp_eq_u32 s66, 81920
    s_cselect_b32 s66, 0, s66
    s_waitcnt vmcnt(20) lgkmcnt(15)
    s_barrier
    v_mfma_f32_16x16x32_bf16 v[64:67], a[64:67], a[80:83], v[64:67]
    ds_read_b64 a[16:17], v214 offset:0
    s_add_u32 m0, s74, s66
    v_mfma_f32_16x16x32_bf16 v[80:83], a[64:67], a[84:87], v[80:83]
    ds_read_b64 a[18:19], v214 offset:512
    buffer_load_dwordx4 v192, s[20:23], s75 offen sc1 lds
    v_mfma_f32_16x16x32_bf16 v[96:99], a[64:67], a[88:91], v[96:99]
    ds_read_b64_tr_b16 a[0:1], v210 offset:0
    s_add_u32 s7, s7, 16384
    v_mfma_f32_16x16x32_bf16 v[112:115], a[64:67], a[92:95], v[112:115]
    ds_read_b64_tr_b16 a[2:3], v210 offset:4096
    s_cmp_eq_u32 s7, 81920
    s_cselect_b32 s7, 0, s7
    v_mfma_f32_16x16x32_bf16 v[116:119], a[68:71], a[92:95], v[116:119]
    ds_read_b64_tr_b16 a[4:5], v211 offset:0
    v_mfma_f32_16x16x32_bf16 v[100:103], a[68:71], a[88:91], v[100:103]
    ds_read_b64_tr_b16 a[6:7], v211 offset:4096
    buffer_load_dwordx4 v193, s[20:23], s75 offen offset:1024 sc1 lds
    v_mfma_f32_16x16x32_bf16 v[84:87], a[68:71], a[84:87], v[84:87]
    ds_read_b64_tr_b16 a[8:9], v212 offset:0
    v_add_u32 v220, s7, v200
    v_mfma_f32_16x16x32_bf16 v[68:71], a[68:71], a[80:83], v[68:71]
    ds_read_b64_tr_b16 a[10:11], v212 offset:4096
    s_add_u32 s75, s75, 1024
    v_mfma_f32_16x16x32_bf16 v[72:75], a[72:75], a[80:83], v[72:75]
    ds_read_b64_tr_b16 a[12:13], v213 offset:0
    s_add_u32 m0, s71, s66
    v_mfma_f32_16x16x32_bf16 v[88:91], a[72:75], a[84:87], v[88:91]
    ds_read_b64_tr_b16 a[14:15], v213 offset:4096
    buffer_load_dwordx4 v194, s[44:47], s76 offen lds
    v_mfma_f32_16x16x32_bf16 v[104:107], a[72:75], a[88:91], v[104:107]
    ds_read_b64 a[20:21], v214 offset:1024
    v_add_u32 v216, s7, v196
    v_mfma_f32_16x16x32_bf16 v[120:123], a[72:75], a[92:95], v[120:123]
    ds_read_b64 a[22:23], v214 offset:1536
    v_mfma_f32_16x16x32_bf16 v[124:127], a[76:79], a[92:95], v[124:127]
    ds_read_b64 a[24:25], v215 offset:0
    v_mfma_f32_16x16x32_bf16 v[108:111], a[76:79], a[88:91], v[108:111]
    ds_read_b64 a[26:27], v215 offset:512
    buffer_load_dwordx4 v195, s[44:47], s76 offen offset:1024 lds
    v_mfma_f32_16x16x32_bf16 v[92:95], a[76:79], a[84:87], v[92:95]
    ds_read_b64 a[28:29], v215 offset:1024
    s_add_u32 s76, s76, 0x10000
    v_mfma_f32_16x16x32_bf16 v[76:79], a[76:79], a[80:83], v[76:79]
    ds_read_b64 a[30:31], v215 offset:1536
    s_add_u32 s3, s74, s66
    s_waitcnt lgkmcnt(15)
    v_mfma_f32_16x16x32_bf16 v[64:67], a[96:99], a[112:115], v[64:67]
    ds_read_b64 a[48:49], v214 offset:8192
    s_add_u32 m0, s3, 8192
    v_mfma_f32_16x16x32_bf16 v[80:83], a[96:99], a[116:119], v[80:83]
    ds_read_b64 a[50:51], v214 offset:8704
    buffer_load_dwordx4 v192, s[20:23], s75 offen sc1 lds
    v_mfma_f32_16x16x32_bf16 v[96:99], a[96:99], a[120:123], v[96:99]
    ds_read_b64_tr_b16 a[32:33], v210 offset:8192
    v_add_u32 v217, s7, v197
    v_mfma_f32_16x16x32_bf16 v[112:115], a[96:99], a[124:127], v[112:115]
    ds_read_b64_tr_b16 a[34:35], v210 offset:12288
    v_add_u32 v218, s7, v198
    v_mfma_f32_16x16x32_bf16 v[116:119], a[100:103], a[124:127], v[116:119]
    ds_read_b64_tr_b16 a[36:37], v211 offset:8192
    v_mfma_f32_16x16x32_bf16 v[100:103], a[100:103], a[120:123], v[100:103]
    ds_read_b64_tr_b16 a[38:39], v211 offset:12288
    buffer_load_dwordx4 v193, s[20:23], s75 offen offset:1024 sc1 lds
    v_mfma_f32_16x16x32_bf16 v[84:87], a[100:103], a[116:119], v[84:87]
    ds_read_b64_tr_b16 a[40:41], v212 offset:8192
    s_add_u32 s75, s75, 1024
    v_mfma_f32_16x16x32_bf16 v[68:71], a[100:103], a[112:115], v[68:71]
    ds_read_b64_tr_b16 a[42:43], v212 offset:12288
    s_add_u32 s3, s71, s66
    v_mfma_f32_16x16x32_bf16 v[72:75], a[104:107], a[112:115], v[72:75]
    ds_read_b64_tr_b16 a[44:45], v213 offset:8192
    s_add_u32 m0, s3, 8192
    v_mfma_f32_16x16x32_bf16 v[88:91], a[104:107], a[116:119], v[88:91]
    ds_read_b64_tr_b16 a[46:47], v213 offset:12288
    buffer_load_dwordx4 v194, s[44:47], s76 offen lds
    v_mfma_f32_16x16x32_bf16 v[104:107], a[104:107], a[120:123], v[104:107]
    ds_read_b64 a[52:53], v214 offset:9216
    v_add_u32 v219, s7, v199
    v_mfma_f32_16x16x32_bf16 v[120:123], a[104:107], a[124:127], v[120:123]
    ds_read_b64 a[54:55], v214 offset:9728
    v_add_u32 v221, s7, v201
    v_mfma_f32_16x16x32_bf16 v[124:127], a[108:111], a[124:127], v[124:127]
    ds_read_b64 a[56:57], v215 offset:8192
    v_mfma_f32_16x16x32_bf16 v[108:111], a[108:111], a[120:123], v[108:111]
    ds_read_b64 a[58:59], v215 offset:8704
    buffer_load_dwordx4 v195, s[44:47], s76 offen offset:1024 lds
    v_mfma_f32_16x16x32_bf16 v[92:95], a[108:111], a[116:119], v[92:95]
    ds_read_b64 a[60:61], v215 offset:9216
    s_add_u32 s76, s76, 0x10000
    v_mfma_f32_16x16x32_bf16 v[76:79], a[108:111], a[112:115], v[76:79]
    ds_read_b64 a[62:63], v215 offset:9728
    s_add_u32 s66, s66, 16384
    s_cmp_eq_u32 s66, 81920
    s_cselect_b32 s66, 0, s66
    s_waitcnt vmcnt(24) lgkmcnt(15)
    s_barrier
    v_mfma_f32_16x16x32_bf16 v[64:67], a[0:3], a[16:19], v[64:67]
    ds_read_b64 a[80:81], v220 offset:0
    s_add_u32 m0, s74, s66
    v_mfma_f32_16x16x32_bf16 v[80:83], a[0:3], a[20:23], v[80:83]
    ds_read_b64 a[82:83], v220 offset:512
    buffer_load_dwordx4 v192, s[20:23], s75 offen sc1 lds
    v_mfma_f32_16x16x32_bf16 v[96:99], a[0:3], a[24:27], v[96:99]
    ds_read_b64_tr_b16 a[64:65], v216 offset:0
    s_add_u32 s7, s7, 16384
    v_mfma_f32_16x16x32_bf16 v[112:115], a[0:3], a[28:31], v[112:115]
    ds_read_b64_tr_b16 a[66:67], v216 offset:4096
    s_cmp_eq_u32 s7, 81920
    s_cselect_b32 s7, 0, s7
    v_mfma_f32_16x16x32_bf16 v[116:119], a[4:7], a[28:31], v[116:119]
    ds_read_b64_tr_b16 a[68:69], v217 offset:0
    v_mfma_f32_16x16x32_bf16 v[100:103], a[4:7], a[24:27], v[100:103]
    ds_read_b64_tr_b16 a[70:71], v217 offset:4096
    buffer_load_dwordx4 v193, s[20:23], s75 offen offset:1024 sc1 lds
    v_mfma_f32_16x16x32_bf16 v[84:87], a[4:7], a[20:23], v[84:87]
    ds_read_b64_tr_b16 a[72:73], v218 offset:0
    v_add_u32 v214, s7, v200
    v_mfma_f32_16x16x32_bf16 v[68:71], a[4:7], a[16:19], v[68:71]
    ds_read_b64_tr_b16 a[74:75], v218 offset:4096
    s_add_u32 s75, s75, 1024
    v_mfma_f32_16x16x32_bf16 v[72:75], a[8:11], a[16:19], v[72:75]
    ds_read_b64_tr_b16 a[76:77], v219 offset:0
    s_add_u32 m0, s71, s66
    v_mfma_f32_16x16x32_bf16 v[88:91], a[8:11], a[20:23], v[88:91]
    ds_read_b64_tr_b16 a[78:79], v219 offset:4096
    buffer_load_dwordx4 v194, s[44:47], s76 offen lds
    v_mfma_f32_16x16x32_bf16 v[104:107], a[8:11], a[24:27], v[104:107]
    ds_read_b64 a[84:85], v220 offset:1024
    v_add_u32 v210, s7, v196
    v_mfma_f32_16x16x32_bf16 v[120:123], a[8:11], a[28:31], v[120:123]
    ds_read_b64 a[86:87], v220 offset:1536
    v_mfma_f32_16x16x32_bf16 v[124:127], a[12:15], a[28:31], v[124:127]
    ds_read_b64 a[88:89], v221 offset:0
    v_mfma_f32_16x16x32_bf16 v[108:111], a[12:15], a[24:27], v[108:111]
    ds_read_b64 a[90:91], v221 offset:512
    buffer_load_dwordx4 v195, s[44:47], s76 offen offset:1024 lds
    v_mfma_f32_16x16x32_bf16 v[92:95], a[12:15], a[20:23], v[92:95]
    ds_read_b64 a[92:93], v221 offset:1024
    s_add_u32 s76, s76, 0x10000
    v_mfma_f32_16x16x32_bf16 v[76:79], a[12:15], a[16:19], v[76:79]
    ds_read_b64 a[94:95], v221 offset:1536
    s_add_u32 s3, s74, s66
    s_waitcnt lgkmcnt(15)
    v_mfma_f32_16x16x32_bf16 v[64:67], a[32:35], a[48:51], v[64:67]
    ds_read_b64 a[112:113], v220 offset:8192
    s_add_u32 m0, s3, 8192
    v_mfma_f32_16x16x32_bf16 v[80:83], a[32:35], a[52:55], v[80:83]
    ds_read_b64 a[114:115], v220 offset:8704
    buffer_load_dwordx4 v192, s[20:23], s75 offen sc1 lds
    v_mfma_f32_16x16x32_bf16 v[96:99], a[32:35], a[56:59], v[96:99]
    ds_read_b64_tr_b16 a[96:97], v216 offset:8192
    v_add_u32 v211, s7, v197
    v_mfma_f32_16x16x32_bf16 v[112:115], a[32:35], a[60:63], v[112:115]
    ds_read_b64_tr_b16 a[98:99], v216 offset:12288
    v_add_u32 v212, s7, v198
    v_mfma_f32_16x16x32_bf16 v[116:119], a[36:39], a[60:63], v[116:119]
    ds_read_b64_tr_b16 a[100:101], v217 offset:8192
    v_mfma_f32_16x16x32_bf16 v[100:103], a[36:39], a[56:59], v[100:103]
    ds_read_b64_tr_b16 a[102:103], v217 offset:12288
    buffer_load_dwordx4 v193, s[20:23], s75 offen offset:1024 sc1 lds
    v_mfma_f32_16x16x32_bf16 v[84:87], a[36:39], a[52:55], v[84:87]
    ds_read_b64_tr_b16 a[104:105], v218 offset:8192
    s_add_u32 s75, s75, 1024
    v_mfma_f32_16x16x32_bf16 v[68:71], a[36:39], a[48:51], v[68:71]
    ds_read_b64_tr_b16 a[106:107], v218 offset:12288
    s_add_u32 s3, s71, s66
    v_mfma_f32_16x16x32_bf16 v[72:75], a[40:43], a[48:51], v[72:75]
    ds_read_b64_tr_b16 a[108:109], v219 offset:8192
    s_add_u32 m0, s3, 8192
    v_mfma_f32_16x16x32_bf16 v[88:91], a[40:43], a[52:55], v[88:91]
    ds_read_b64_tr_b16 a[110:111], v219 offset:12288
    buffer_load_dwordx4 v194, s[44:47], s76 offen lds
    v_mfma_f32_16x16x32_bf16 v[104:107], a[40:43], a[56:59], v[104:107]
    ds_read_b64 a[116:117], v220 offset:9216
    v_add_u32 v213, s7, v199
    v_mfma_f32_16x16x32_bf16 v[120:123], a[40:43], a[60:63], v[120:123]
    ds_read_b64 a[118:119], v220 offset:9728
    v_add_u32 v215, s7, v201
    v_mfma_f32_16x16x32_bf16 v[124:127], a[44:47], a[60:63], v[124:127]
    ds_read_b64 a[120:121], v221 offset:8192
    v_mfma_f32_16x16x32_bf16 v[108:111], a[44:47], a[56:59], v[108:111]
    ds_read_b64 a[122:123], v221 offset:8704
    buffer_load_dwordx4 v195, s[44:47], s76 offen offset:1024 lds
    v_mfma_f32_16x16x32_bf16 v[92:95], a[44:47], a[52:55], v[92:95]
    ds_read_b64 a[124:125], v221 offset:9216
    s_add_u32 s76, s76, 0x10000
    v_mfma_f32_16x16x32_bf16 v[76:79], a[44:47], a[48:51], v[76:79]
    ds_read_b64 a[126:127], v221 offset:9728
    s_add_u32 s66, s66, 16384
    s_cmp_eq_u32 s66, 81920
    s_cselect_b32 s66, 0, s66
    s_waitcnt vmcnt(16) lgkmcnt(15)
    s_barrier
    s_cmp_lg_u32 s64, 0
    s_cbranch_scc1 L_f2_nosig
    v_mov_b32 v1, 1
    s_mov_b64 exec, 1
    buffer_store_dword v1, off, s[36:39], s81 sc1
    s_mov_b64 exec, -1
L_f2_nosig:
    v_mfma_f32_16x16x32_bf16 v[64:67], a[64:67], a[80:83], v[64:67]
    ds_read_b64 a[16:17], v214 offset:0
    s_add_u32 m0, s74, s66
    v_mfma_f32_16x16x32_bf16 v[80:83], a[64:67], a[84:87], v[80:83]
    ds_read_b64 a[18:19], v214 offset:512
    buffer_load_dwordx4 v192, s[20:23], s75 offen sc1 lds
    v_mfma_f32_16x16x32_bf16 v[96:99], a[64:67], a[88:91], v[96:99]
    ds_read_b64_tr_b16 a[0:1], v210 offset:0
    s_add_u32 s7, s7, 16384
    v_mfma_f32_16x16x32_bf16 v[112:115], a[64:67], a[92:95], v[112:115]
    ds_read_b64_tr_b16 a[2:3], v210 offset:4096
    s_cmp_eq_u32 s7, 81920
    s_cselect_b32 s7, 0, s7
    v_mfma_f32_16x16x32_bf16 v[116:119], a[68:71], a[92:95], v[116:119]
    ds_read_b64_tr_b16 a[4:5], v211 offset:0
    v_mfma_f32_16x16x32_bf16 v[100:103], a[68:71], a[88:91], v[100:103]
    ds_read_b64_tr_b16 a[6:7], v211 offset:4096
    buffer_load_dwordx4 v193, s[20:23], s75 offen offset:1024 sc1 lds
    v_mfma_f32_16x16x32_bf16 v[84:87], a[68:71], a[84:87], v[84:87]
    ds_read_b64_tr_b16 a[8:9], v212 offset:0
    v_add_u32 v220, s7, v200
    v_mfma_f32_16x16x32_bf16 v[68:71], a[68:71], a[80:83], v[68:71]
    ds_read_b64_tr_b16 a[10:11], v212 offset:4096
    s_add_u32 s75, s75, 1024
    v_mfma_f32_16x16x32_bf16 v[72:75], a[72:75], a[80:83], v[72:75]
    ds_read_b64_tr_b16 a[12:13], v213 offset:0
    s_add_u32 m0, s71, s66
    v_mfma_f32_16x16x32_bf16 v[88:91], a[72:75], a[84:87], v[88:91]
    ds_read_b64_tr_b16 a[14:15], v213 offset:4096
    buffer_load_dwordx4 v194, s[44:47], s76 offen lds
    v_mfma_f32_16x16x32_bf16 v[104:107], a[72:75], a[88:91], v[104:107]
    ds_read_b64 a[20:21], v214 offset:1024
    v_add_u32 v216, s7, v196
    v_mfma_f32_16x16x32_bf16 v[120:123], a[72:75], a[92:95], v[120:123]
    ds_read_b64 a[22:23], v214 offset:1536
    v_mfma_f32_16x16x32_bf16 v[124:127], a[76:79], a[92:95], v[124:127]
    ds_read_b64 a[24:25], v215 offset:0
    v_mfma_f32_16x16x32_bf16 v[108:111], a[76:79], a[88:91], v[108:111]
    ds_read_b64 a[26:27], v215 offset:512
    buffer_load_dwordx4 v195, s[44:47], s76 offen offset:1024 lds
    v_mfma_f32_16x16x32_bf16 v[92:95], a[76:79], a[84:87], v[92:95]
    ds_read_b64 a[28:29], v215 offset:1024
    s_add_u32 s76, s76, 0x10000
    v_mfma_f32_16x16x32_bf16 v[76:79], a[76:79], a[80:83], v[76:79]
    ds_read_b64 a[30:31], v215 offset:1536
    s_add_u32 s3, s74, s66
    s_waitcnt lgkmcnt(15)
    v_mfma_f32_16x16x32_bf16 v[64:67], a[96:99], a[112:115], v[64:67]
    ds_read_b64 a[48:49], v214 offset:8192
    s_add_u32 m0, s3, 8192
    v_mfma_f32_16x16x32_bf16 v[80:83], a[96:99], a[116:119], v[80:83]
    ds_read_b64 a[50:51], v214 offset:8704
    buffer_load_dwordx4 v192, s[20:23], s75 offen sc1 lds
    v_mfma_f32_16x16x32_bf16 v[96:99], a[96:99], a[120:123], v[96:99]
    ds_read_b64_tr_b16 a[32:33], v210 offset:8192
    v_add_u32 v217, s7, v197
    v_mfma_f32_16x16x32_bf16 v[112:115], a[96:99], a[124:127], v[112:115]
    ds_read_b64_tr_b16 a[34:35], v210 offset:12288
    v_add_u32 v218, s7, v198
    v_mfma_f32_16x16x32_bf16 v[116:119], a[100:103], a[124:127], v[116:119]
    ds_read_b64_tr_b16 a[36:37], v211 offset:8192
    v_mfma_f32_16x16x32_bf16 v[100:103], a[100:103], a[120:123], v[100:103]
    ds_read_b64_tr_b16 a[38:39], v211 offset:12288
    buffer_load_dwordx4 v193, s[20:23], s75 offen offset:1024 sc1 lds
    v_mfma_f32_16x16x32_bf16 v[84:87], a[100:103], a[116:119], v[84:87]
    ds_read_b64_tr_b16 a[40:41], v212 offset:8192
    s_add_u32 s75, s75, 1024
    v_mfma_f32_16x16x32_bf16 v[68:71], a[100:103], a[112:115], v[68:71]
    ds_read_b64_tr_b16 a[42:43], v212 offset:12288
    s_add_u32 s3, s71, s66
    v_mfma_f32_16x16x32_bf16 v[72:75], a[104:107], a[112:115], v[72:75]
    ds_read_b64_tr_b16 a[44:45], v213 offset:8192
    s_add_u32 m0, s3, 8192
    v_mfma_f32_16x16x32_bf16 v[88:91], a[104:107], a[116:119], v[88:91]
    ds_read_b64_tr_b16 a[46:47], v213 offset:12288
    buffer_load_dwordx4 v194, s[44:47], s76 offen lds
    v_mfma_f32_16x16x32_bf16 v[104:107], a[104:107], a[120:123], v[104:107]
    ds_read_b64 a[52:53], v214 offset:9216
    v_add_u32 v219, s7, v199
    v_mfma_f32_16x16x32_bf16 v[120:123], a[104:107], a[124:127], v[120:123]
    ds_read_b64 a[54:55], v214 offset:9728
    v_add_u32 v221, s7, v201
    v_mfma_f32_16x16x32_bf16 v[124:127], a[108:111], a[124:127], v[124:127]
    ds_read_b64 a[56:57], v215 offset:8192
    v_mfma_f32_16x16x32_bf16 v[108:111], a[108:111], a[120:123], v[108:111]
    ds_read_b64 a[58:59], v215 offset:8704
    buffer_load_dwordx4 v195, s[44:47], s76 offen offset:1024 lds
    v_mfma_f32_16x16x32_bf16 v[92:95], a[108:111], a[116:119], v[92:95]
    ds_read_b64 a[60:61], v215 offset:9216
    s_add_u32 s76, s76, 0x10000
    v_mfma_f32_16x16x32_bf16 v[76:79], a[108:111], a[112:115], v[76:79]
    ds_read_b64 a[62:63], v215 offset:9728
    s_add_u32 s66, s66, 16384
    s_cmp_eq_u32 s66, 81920
    s_cselect_b32 s66, 0, s66
    s_mov_b32 s82, 0
L_g2_loop:
    s_waitcnt vmcnt(16) lgkmcnt(15)
    s_barrier
    v_mfma_f32_16x16x32_bf16 v[64:67], a[0:3], a[16:19], v[64:67]
    ds_read_b64 a[80:81], v220 offset:0
    s_add_u32 m0, s74, s66
    v_mfma_f32_16x16x32_bf16 v[80:83], a[0:3], a[20:23], v[80:83]
    ds_read_b64 a[82:83], v220 offset:512
    buffer_load_dwordx4 v192, s[20:23], s75 offen sc1 lds
    v_mfma_f32_16x16x32_bf16 v[96:99], a[0:3], a[24:27], v[96:99]
    ds_read_b64_tr_b16 a[64:65], v216 offset:0
    s_add_u32 s7, s7, 16384
    v_mfma_f32_16x16x32_bf16 v[112:115], a[0:3], a[28:31], v[112:115]
    ds_read_b64_tr_b16 a[66:67], v216 offset:4096
    s_cmp_eq_u32 s7, 81920
    s_cselect_b32 s7, 0, s7
    v_mfma_f32_16x16x32_bf16 v[116:119], a[4:7], a[28:31], v[116:119]
    ds_read_b64_tr_b16 a[68:69], v217 offset:0
    v_mfma_f32_16x16x32_bf16 v[100:103], a[4:7], a[24:27], v[100:103]
    ds_read_b64_tr_b16 a[70:71], v217 offset:4096
    buffer_load_dwordx4 v193, s[20:23], s75 offen offset:1024 sc1 lds
    v_mfma_f32_16x16x32_bf16 v[84:87], a[4:7], a[20:23], v[84:87]
    ds_read_b64_tr_b16 a[72:73], v218 offset:0
    v_add_u32 v214, s7, v200
    v_mfma_f32_16x16x32_bf16 v[68:71], a[4:7], a[16:19], v[68:71]
    ds_read_b64_tr_b16 a[74:75], v218 offset:4096
    s_add_u32 s75, s75, 1024
    v_mfma_f32_16x16x32_bf16 v[72:75], a[8:11], a[16:19], v[72:75]
    ds_read_b64_tr_b16 a[76:77], v219 offset:0
    s_add_u32 m0, s71, s66
    v_mfma_f32_16x16x32_bf16 v[88:91], a[8:11], a[20:23], v[88:91]
    ds_read_b64_tr_b16 a[78:79], v219 offset:4096
    buffer_load_dwordx4 v194, s[44:47], s76 offen lds
    v_mfma_f32_16x16x32_bf16 v[104:107], a[8:11], a[24:27], v[104:107]
    ds_read_b64 a[84:85], v220 offset:1024
    v_add_u32 v210, s7, v196
    v_mfma_f32_16x16x32_bf16 v[120:123], a[8:11], a[28:31], v[120:123]
    ds_read_b64 a[86:87], v220 offset:1536
    v_mfma_f32_16x16x32_bf16 v[124:127], a[12:15], a[28:31], v[124:127]
    ds_read_b64 a[88:89], v221 offset:0
    v_mfma_f32_16x16x32_bf16 v[108:111], a[12:15], a[24:27], v[108:111]
    ds_read_b64 a[90:91], v221 offset:512
    buffer_load_dwordx4 v195, s[44:47], s76 offen offset:1024 lds
    v_mfma_f32_16x16x32_bf16 v[92:95], a[12:15], a[20:23], v[92:95]
    ds_read_b64 a[92:93], v221 offset:1024
    s_add_u32 s76, s76, 0x10000
    v_mfma_f32_16x16x32_bf16 v[76:79], a[12:15], a[16:19], v[76:79]
    ds_read_b64 a[94:95], v221 offset:1536
    s_add_u32 s3, s74, s66
    s_waitcnt lgkmcnt(15)
    v_mfma_f32_16x16x32_bf16 v[64:67], a[32:35], a[48:51], v[64:67]
    ds_read_b64 a[112:113], v220 offset:8192
    s_add_u32 m0, s3, 8192
    v_mfma_f32_16x16x32_bf16 v[80:83], a[32:35], a[52:55], v[80:83]
    ds_read_b64 a[114:115], v220 offset:8704
    buffer_load_dwordx4 v192, s[20:23], s75 offen sc1 lds
    v_mfma_f32_16x16x32_bf16 v[96:99], a[32:35], a[56:59], v[96:99]
    ds_read_b64_tr_b16 a[96:97], v216 offset:8192
    v_add_u32 v211, s7, v197
    v_mfma_f32_16x16x32_bf16 v[112:115], a[32:35], a[60:63], v[112:115]
    ds_read_b64_tr_b16 a[98:99], v216 offset:12288
    v_add_u32 v212, s7, v198
    v_mfma_f32_16x16x32_bf16 v[116:119], a[36:39], a[60:63], v[116:119]
    ds_read_b64_tr_b16 a[100:101], v217 offset:8192
    v_mfma_f32_16x16x32_bf16 v[100:103], a[36:39], a[56:59], v[100:103]
    ds_read_b64_tr_b16 a[102:103], v217 offset:12288
    buffer_load_dwordx4 v193, s[20:23], s75 offen offset:1024 sc1 lds
    v_mfma_f32_16x16x32_bf16 v[84:87], a[36:39], a[52:55], v[84:87]
    ds_read_b64_tr_b16 a[104:105], v218 offset:8192
    s_add_u32 s75, s75, 1024
    v_mfma_f32_16x16x32_bf16 v[68:71], a[36:39], a[48:51], v[68:71]
    ds_read_b64_tr_b16 a[106:107], v218 offset:12288
    s_add_u32 s3, s71, s66
    v_mfma_f32_16x16x32_bf16 v[72:75], a[40:43], a[48:51], v[72:75]
    ds_read_b64_tr_b16 a[108:109], v219 offset:8192
    s_add_u32 m0, s3, 8192
    v_mfma_f32_16x16x32_bf16 v[88:91], a[40:43], a[52:55], v[88:91]
    ds_read_b64_tr_b16 a[110:111], v219 offset:12288
    buffer_load_dwordx4 v194, s[44:47], s76 offen lds
    v_mfma_f32_16x16x32_bf16 v[104:107], a[40:43], a[56:59], v[104:107]
    ds_read_b64 a[116:117], v220 offset:9216
    v_add_u32 v213, s7, v199
    v_mfma_f32_16x16x32_bf16 v[120:123], a[40:43], a[60:63], v[120:123]
    ds_read_b64 a[118:119], v220 offset:9728
    v_add_u32 v215, s7, v201
    v_mfma_f32_16x16x32_bf16 v[124:127], a[44:47], a[60:63], v[124:127]
    ds_read_b64 a[120:121], v221 offset:8192
    v_mfma_f32_16x16x32_bf16 v[108:111], a[44:47], a[56:59], v[108:111]
    ds_read_b64 a[122:123], v221 offset:8704
    buffer_load_dwordx4 v195, s[44:47], s76 offen offset:1024 lds
    v_mfma_f32_16x16x32_bf16 v[92:95], a[44:47], a[52:55], v[92:95]
    ds_read_b64 a[124:125], v221 offset:9216
    s_add_u32 s76, s76, 0x10000
    v_mfma_f32_16x16x32_bf16 v[76:79], a[44:47], a[48:51], v[76:79]
    ds_read_b64 a[126:127], v221 offset:9728
    s_add_u32 s66, s66, 16384
    s_cmp_eq_u32 s66, 81920
    s_cselect_b32 s66, 0, s66
    s_waitcnt vmcnt(16) lgkmcnt(15)
    s_barrier
    v_mfma_f32_16x16x32_bf16 v[64:67], a[64:67], a[80:83], v[64:67]
    ds_read_b64 a[16:17], v214 offset:0
    s_add_u32 m0, s74, s66
    v_mfma_f32_16x16x32_bf16 v[80:83], a[64:67], a[84:87], v[80:83]
    ds_read_b64 a[18:19], v214 offset:512
    buffer_load_dwordx4 v192, s[20:23], s75 offen sc1 lds
    v_mfma_f32_16x16x32_bf16 v[96:99], a[64:67], a[88:91], v[96:99]
    ds_read_b64_tr_b16 a[0:1], v210 offset:0
    s_add_u32 s7, s7, 16384
    v_mfma_f32_16x16x32_bf16 v[112:115], a[64:67], a[92:95], v[112:115]
    ds_read_b64_tr_b16 a[2:3], v210 offset:4096
    s_cmp_eq_u32 s7, 81920
    s_cselect_b32 s7, 0, s7
    v_mfma_f32_16x16x32_bf16 v[116:119], a[68:71], a[92:95], v[116:119]
    ds_read_b64_tr_b16 a[4:5], v211 offset:0
    v_mfma_f32_16x16x32_bf16 v[100:103], a[68:71], a[88:91], v[100:103]
    ds_read_b64_tr_b16 a[6:7], v211 offset:4096
    buffer_load_dwordx4 v193, s[20:23], s75 offen offset:1024 sc1 lds
    v_mfma_f32_16x16x32_bf16 v[84:87], a[68:71], a[84:87], v[84:87]
    ds_read_b64_tr_b16 a[8:9], v212 offset:0
    v_add_u32 v220, s7, v200
    v_mfma_f32_16x16x32_bf16 v[68:71], a[68:71], a[80:83], v[68:71]
    ds_read_b64_tr_b16 a[10:11], v212 offset:4096
    s_add_u32 s75, s75, 1024
    v_mfma_f32_16x16x32_bf16 v[72:75], a[72:75], a[80:83], v[72:75]
    ds_read_b64_tr_b16 a[12:13], v213 offset:0
    s_add_u32 m0, s71, s66
    v_mfma_f32_16x16x32_bf16 v[88:91], a[72:75], a[84:87], v[88:91]
    ds_read_b64_tr_b16 a[14:15], v213 offset:4096
    buffer_load_dwordx4 v194, s[44:47], s76 offen lds
    v_mfma_f32_16x16x32_bf16 v[104:107], a[72:75], a[88:91], v[104:107]
    ds_read_b64 a[20:21], v214 offset:1024
    v_add_u32 v216, s7, v196
    v_mfma_f32_16x16x32_bf16 v[120:123], a[72:75], a[92:95], v[120:123]
    ds_read_b64 a[22:23], v214 offset:1536
    v_mfma_f32_16x16x32_bf16 v[124:127], a[76:79], a[92:95], v[124:127]
    ds_read_b64 a[24:25], v215 offset:0
    v_mfma_f32_16x16x32_bf16 v[108:111], a[76:79], a[88:91], v[108:111]
    ds_read_b64 a[26:27], v215 offset:512
    buffer_load_dwordx4 v195, s[44:47], s76 offen offset:1024 lds
    v_mfma_f32_16x16x32_bf16 v[92:95], a[76:79], a[84:87], v[92:95]
    ds_read_b64 a[28:29], v215 offset:1024
    s_add_u32 s76, s76, 0x10000
    v_mfma_f32_16x16x32_bf16 v[76:79], a[76:79], a[80:83], v[76:79]
    ds_read_b64 a[30:31], v215 offset:1536
    s_add_u32 s3, s74, s66
    s_waitcnt lgkmcnt(15)
    v_mfma_f32_16x16x32_bf16 v[64:67], a[96:99], a[112:115], v[64:67]
    ds_read_b64 a[48:49], v214 offset:8192
    s_add_u32 m0, s3, 8192
    v_mfma_f32_16x16x32_bf16 v[80:83], a[96:99], a[116:119], v[80:83]
    ds_read_b64 a[50:51], v214 offset:8704
    buffer_load_dwordx4 v192, s[20:23], s75 offen sc1 lds
    v_mfma_f32_16x16x32_bf16 v[96:99], a[96:99], a[120:123], v[96:99]
    ds_read_b64_tr_b16 a[32:33], v210 offset:8192
    v_add_u32 v217, s7, v197
    v_mfma_f32_16x16x32_bf16 v[112:115], a[96:99], a[124:127], v[112:115]
    ds_read_b64_tr_b16 a[34:35], v210 offset:12288
    v_add_u32 v218, s7, v198
    v_mfma_f32_16x16x32_bf16 v[116:119], a[100:103], a[124:127], v[116:119]
    ds_read_b64_tr_b16 a[36:37], v211 offset:8192
    v_mfma_f32_16x16x32_bf16 v[100:103], a[100:103], a[120:123], v[100:103]
    ds_read_b64_tr_b16 a[38:39], v211 offset:12288
    buffer_load_dwordx4 v193, s[20:23], s75 offen offset:1024 sc1 lds
    v_mfma_f32_16x16x32_bf16 v[84:87], a[100:103], a[116:119], v[84:87]
    ds_read_b64_tr_b16 a[40:41], v212 offset:8192
    s_add_u32 s75, s75, 1024
    v_mfma_f32_16x16x32_bf16 v[68:71], a[100:103], a[112:115], v[68:71]
    ds_read_b64_tr_b16 a[42:43], v212 offset:12288
    s_add_u32 s3, s71, s66
    v_mfma_f32_16x16x32_bf16 v[72:75], a[104:107], a[112:115], v[72:75]
    ds_read_b64_tr_b16 a[44:45], v213 offset:8192
    s_add_u32 m0, s3, 8192
    v_mfma_f32_16x16x32_bf16 v[88:91], a[104:107], a[116:119], v[88:91]
    ds_read_b64_tr_b16 a[46:47], v213 offset:12288
    buffer_load_dwordx4 v194, s[44:47], s76 offen lds
    v_mfma_f32_16x16x32_bf16 v[104:107], a[104:107], a[120:123], v[104:107]
    ds_read_b64 a[52:53], v214 offset:9216
    v_add_u32 v219, s7, v199
    v_mfma_f32_16x16x32_bf16 v[120:123], a[104:107], a[124:127], v[120:123]
    ds_read_b64 a[54:55], v214 offset:9728
    v_add_u32 v221, s7, v201
    v_mfma_f32_16x16x32_bf16 v[124:127], a[108:111], a[124:127], v[124:127]
    ds_read_b64 a[56:57], v215 offset:8192
    v_mfma_f32_16x16x32_bf16 v[108:111], a[108:111], a[120:123], v[108:111]
    ds_read_b64 a[58:59], v215 offset:8704
    buffer_load_dwordx4 v195, s[44:47], s76 offen offset:1024 lds
    v_mfma_f32_16x16x32_bf16 v[92:95], a[108:111], a[116:119], v[92:95]
    ds_read_b64 a[60:61], v215 offset:9216
    s_add_u32 s76, s76, 0x10000
    v_mfma_f32_16x16x32_bf16 v[76:79], a[108:111], a[112:115], v[76:79]
    ds_read_b64 a[62:63], v215 offset:9728
    s_add_u32 s66, s66, 16384
    s_cmp_eq_u32 s66, 81920
    s_cselect_b32 s66, 0, s66
    s_add_u32 s82, s82, 1
    s_cmp_lt_u32 s82, 10
    s_cbranch_scc1 L_g2_loop
    s_waitcnt vmcnt(16) lgkmcnt(15)
    s_barrier
    v_mfma_f32_16x16x32_bf16 v[64:67], a[0:3], a[16:19], v[64:67]
    ds_read_b64 a[80:81], v220 offset:0
    s_add_u32 s7, s7, 16384
    v_mfma_f32_16x16x32_bf16 v[80:83], a[0:3], a[20:23], v[80:83]
    ds_read_b64 a[82:83], v220 offset:512
    buffer_load_dword v22, v23, s[36:39], s77 offen sc1
    v_mfma_f32_16x16x32_bf16 v[96:99], a[0:3], a[24:27], v[96:99]
    ds_read_b64_tr_b16 a[64:65], v216 offset:0
    s_cmp_eq_u32 s7, 81920
    s_cselect_b32 s7, 0, s7
    v_mfma_f32_16x16x32_bf16 v[112:115], a[0:3], a[28:31], v[112:115]
    ds_read_b64_tr_b16 a[66:67], v216 offset:4096
    v_mfma_f32_16x16x32_bf16 v[116:119], a[4:7], a[28:31], v[116:119]
    ds_read_b64_tr_b16 a[68:69], v217 offset:0
    v_mfma_f32_16x16x32_bf16 v[100:103], a[4:7], a[24:27], v[100:103]
    ds_read_b64_tr_b16 a[70:71], v217 offset:4096
    buffer_load_dwordx4 v[32:35], v24, s[8:11], 0 offen offset:0
    v_mfma_f32_16x16x32_bf16 v[84:87], a[4:7], a[20:23], v[84:87]
    ds_read_b64_tr_b16 a[72:73], v218 offset:0
    v_add_u32 v214, s7, v200
    v_mfma_f32_16x16x32_bf16 v[68:71], a[4:7], a[16:19], v[68:71]
    ds_read_b64_tr_b16 a[74:75], v218 offset:4096
    v_mfma_f32_16x16x32_bf16 v[72:75], a[8:11], a[16:19], v[72:75]
    ds_read_b64_tr_b16 a[76:77], v219 offset:0
    v_mfma_f32_16x16x32_bf16 v[88:91], a[8:11], a[20:23], v[88:91]
    ds_read_b64_tr_b16 a[78:79], v219 offset:4096
    v_mfma_f32_16x16x32_bf16 v[104:107], a[8:11], a[24:27], v[104:107]
    ds_read_b64 a[84:85], v220 offset:1024
    buffer_load_dwordx4 v[36:39], v24, s[8:11], 0 offen offset:64
    v_mfma_f32_16x16x32_bf16 v[120:123], a[8:11], a[28:31], v[120:123]
    ds_read_b64 a[86:87], v220 offset:1536
    v_add_u32 v210, s7, v196
    v_mfma_f32_16x16x32_bf16 v[124:127], a[12:15], a[28:31], v[124:127]
    ds_read_b64 a[88:89], v221 offset:0
    v_mfma_f32_16x16x32_bf16 v[108:111], a[12:15], a[24:27], v[108:111]
    ds_read_b64 a[90:91], v221 offset:512
    v_mfma_f32_16x16x32_bf16 v[92:95], a[12:15], a[20:23], v[92:95]
    ds_read_b64 a[92:93], v221 offset:1024
    buffer_load_dwordx2 v[48:49], v26, s[36:39], s86 offen offset:0 sc1
    v_mfma_f32_16x16x32_bf16 v[76:79], a[12:15], a[16:19], v[76:79]
    ds_read_b64 a[94:95], v221 offset:1536
    v_add_u32 v211, s7, v197
    s_waitcnt lgkmcnt(15)
    v_mfma_f32_16x16x32_bf16 v[64:67], a[32:35], a[48:51], v[64:67]
    ds_read_b64 a[112:113], v220 offset:8192
    v_mfma_f32_16x16x32_bf16 v[80:83], a[32:35], a[52:55], v[80:83]
    ds_read_b64 a[114:115], v220 offset:8704
    v_mfma_f32_16x16x32_bf16 v[96:99], a[32:35], a[56:59], v[96:99]
    ds_read_b64_tr_b16 a[96:97], v216 offset:8192
    v_add_u32 v212, s7, v198
    v_mfma_f32_16x16x32_bf16 v[112:115], a[32:35], a[60:63], v[112:115]
    ds_read_b64_tr_b16 a[98:99], v216 offset:12288
    buffer_load_dwordx4 v[40:43], v25, s[8:11], 0 offen offset:0
    v_mfma_f32_16x16x32_bf16 v[116:119], a[36:39], a[60:63], v[116:119]
    ds_read_b64_tr_b16 a[100:101], v217 offset:8192
    v_mfma_f32_16x16x32_bf16 v[100:103], a[36:39], a[56:59], v[100:103]
    ds_read_b64_tr_b16 a[102:103], v217 offset:12288
    v_mfma_f32_16x16x32_bf16 v[84:87], a[36:39], a[52:55], v[84:87]
    ds_read_b64_tr_b16 a[104:105], v218 offset:8192
    v_add_u32 v213, s7, v199
    v_mfma_f32_16x16x32_bf16 v[68:71], a[36:39], a[48:51], v[68:71]
    ds_read_b64_tr_b16 a[106:107], v218 offset:12288
    buffer_load_dwordx4 v[44:47], v25, s[8:11], 0 offen offset:64
    v_mfma_f32_16x16x32_bf16 v[72:75], a[40:43], a[48:51], v[72:75]
    ds_read_b64_tr_b16 a[108:109], v219 offset:8192
    v_mfma_f32_16x16x32_bf16 v[88:91], a[40:43], a[52:55], v[88:91]
    ds_read_b64_tr_b16 a[110:111], v219 offset:12288
    v_mfma_f32_16x16x32_bf16 v[104:107], a[40:43], a[56:59], v[104:107]
    ds_read_b64 a[116:117], v220 offset:9216
    v_add_u32 v215, s7, v201
    v_mfma_f32_16x16x32_bf16 v[120:123], a[40:43], a[60:63], v[120:123]
    ds_read_b64 a[118:119], v220 offset:9728
    v_mfma_f32_16x16x32_bf16 v[124:127], a[44:47], a[60:63], v[124:127]
    ds_read_b64 a[120:121], v221 offset:8192
    buffer_load_dwordx2 v[50:51], v26, s[36:39], s86 offen offset:128 sc1
    v_mfma_f32_16x16x32_bf16 v[108:111], a[44:47], a[56:59], v[108:111]
    ds_read_b64 a[122:123], v221 offset:8704
    v_mfma_f32_16x16x32_bf16 v[92:95], a[44:47], a[52:55], v[92:95]
    ds_read_b64 a[124:125], v221 offset:9216
    v_mfma_f32_16x16x32_bf16 v[76:79], a[44:47], a[48:51], v[76:79]
    ds_read_b64 a[126:127], v221 offset:9728
    s_waitcnt vmcnt(15) lgkmcnt(15)
    s_barrier
    v_mfma_f32_16x16x32_bf16 v[64:67], a[64:67], a[80:83], v[64:67]
    ds_read_b64 a[144:145], v214 offset:0
    s_add_u32 s7, s7, 16384
    v_mfma_f32_16x16x32_bf16 v[80:83], a[64:67], a[84:87], v[80:83]
    ds_read_b64 a[146:147], v214 offset:512
    v_mfma_f32_16x16x32_bf16 v[96:99], a[64:67], a[88:91], v[96:99]
    ds_read_b64_tr_b16 a[128:129], v210 offset:0
    s_cmp_eq_u32 s7, 81920
    s_cselect_b32 s7, 0, s7
    v_mfma_f32_16x16x32_bf16 v[112:115], a[64:67], a[92:95], v[112:115]
    ds_read_b64_tr_b16 a[130:131], v210 offset:4096
    v_mfma_f32_16x16x32_bf16 v[116:119], a[68:71], a[92:95], v[116:119]
    ds_read_b64_tr_b16 a[132:133], v211 offset:0
    v_mfma_f32_16x16x32_bf16 v[100:103], a[68:71], a[88:91], v[100:103]
    ds_read_b64_tr_b16 a[134:135], v211 offset:4096
    v_mfma_f32_16x16x32_bf16 v[84:87], a[68:71], a[84:87], v[84:87]
    ds_read_b64_tr_b16 a[136:137], v212 offset:0
    v_add_u32 v220, s7, v200
    v_mfma_f32_16x16x32_bf16 v[68:71], a[68:71], a[80:83], v[68:71]
    ds_read_b64_tr_b16 a[138:139], v212 offset:4096
    v_mfma_f32_16x16x32_bf16 v[72:75], a[72:75], a[80:83], v[72:75]
    ds_read_b64_tr_b16 a[140:141], v213 offset:0
    v_mfma_f32_16x16x32_bf16 v[88:91], a[72:75], a[84:87], v[88:91]
    ds_read_b64_tr_b16 a[142:143], v213 offset:4096
    v_mfma_f32_16x16x32_bf16 v[104:107], a[72:75], a[88:91], v[104:107]
    ds_read_b64 a[148:149], v214 offset:1024
    v_add_u32 v216, s7, v196
    v_mfma_f32_16x16x32_bf16 v[120:123], a[72:75], a[92:95], v[120:123]
    ds_read_b64 a[150:151], v214 offset:1536
    v_mfma_f32_16x16x32_bf16 v[124:127], a[76:79], a[92:95], v[124:127]
    ds_read_b64 a[152:153], v215 offset:0
    v_mfma_f32_16x16x32_bf16 v[108:111], a[76:79], a[88:91], v[108:111]
    ds_read_b64 a[154:155], v215 offset:512
    v_mfma_f32_16x16x32_bf16 v[92:95], a[76:79], a[84:87], v[92:95]
    ds_read_b64 a[156:157], v215 offset:1024
    v_add_u32 v217, s7, v197
    v_mfma_f32_16x16x32_bf16 v[76:79], a[76:79], a[80:83], v[76:79]
    ds_read_b64 a[158:159], v215 offset:1536
    s_waitcnt lgkmcnt(15)
    v_mfma_f32_16x16x32_bf16 v[64:67], a[96:99], a[112:115], v[64:67]
    ds_read_b64 a[176:177], v214 offset:8192
    v_mfma_f32_16x16x32_bf16 v[80:83], a[96:99], a[116:119], v[80:83]
    ds_read_b64 a[178:179], v214 offset:8704
    v_mfma_f32_16x16x32_bf16 v[96:99], a[96:99], a[120:123], v[96:99]
    ds_read_b64_tr_b16 a[160:161], v210 offset:8192
    v_add_u32 v218, s7, v198
    v_mfma_f32_16x16x32_bf16 v[112:115], a[96:99], a[124:127], v[112:115]
    ds_read_b64_tr_b16 a[162:163], v210 offset:12288
    v_mfma_f32_16x16x32_bf16 v[116:119], a[100:103], a[124:127], v[116:119]
    ds_read_b64_tr_b16 a[164:165], v211 offset:8192
    v_mfma_f32_16x16x32_bf16 v[100:103], a[100:103], a[120:123], v[100:103]
    ds_read_b64_tr_b16 a[166:167], v211 offset:12288
    v_mfma_f32_16x16x32_bf16 v[84:87], a[100:103], a[116:119], v[84:87]
    ds_read_b64_tr_b16 a[168:169], v212 offset:8192
    v_add_u32 v219, s7, v199
    v_mfma_f32_16x16x32_bf16 v[68:71], a[100:103], a[112:115], v[68:71]
    ds_read_b64_tr_b16 a[170:171], v212 offset:12288
    v_mfma_f32_16x16x32_bf16 v[72:75], a[104:107], a[112:115], v[72:75]
    ds_read_b64_tr_b16 a[172:173], v213 offset:8192
    v_mfma_f32_16x16x32_bf16 v[88:91], a[104:107], a[116:119], v[88:91]
    ds_read_b64_tr_b16 a[174:175], v213 offset:12288
    v_mfma_f32_16x16x32_bf16 v[104:107], a[104:107], a[120:123], v[104:107]
    ds_read_b64 a[180:181], v214 offset:9216
    v_add_u32 v221, s7, v201
    v_mfma_f32_16x16x32_bf16 v[120:123], a[104:107], a[124:127], v[120:123]
    ds_read_b64 a[182:183], v214 offset:9728
    v_mfma_f32_16x16x32_bf16 v[124:127], a[108:111], a[124:127], v[124:127]
    ds_read_b64 a[184:185], v215 offset:8192
    v_mfma_f32_16x16x32_bf16 v[108:111], a[108:111], a[120:123], v[108:111]
    ds_read_b64 a[186:187], v215 offset:8704
    v_mfma_f32_16x16x32_bf16 v[92:95], a[108:111], a[116:119], v[92:95]
    ds_read_b64 a[188:189], v215 offset:9216
    v_mfma_f32_16x16x32_bf16 v[76:79], a[108:111], a[112:115], v[76:79]
    ds_read_b64 a[190:191], v215 offset:9728
    s_waitcnt vmcnt(6) lgkmcnt(0)
    s_barrier
    s_mov_b32 s82, 0
L_f2_chk:
    v_cmp_ne_u32 vcc, 0, v22
    s_cmp_eq_u64 vcc, exec
    s_cbranch_scc1 L_f2_ok
    s_sleep 1
    buffer_load_dword v22, v23, s[36:39], s77 offen sc1
    s_waitcnt vmcnt(0)
    s_add_u32 s82, s82, 1
    s_cmp_lt_u32 s82, 200000
    s_cbranch_scc1 L_f2_chk
L_f2_ok:
    v_mfma_f32_16x16x32_bf16 v[96:99], a[128:131], a[152:155], v[96:99]
    ds_read_b64 a[208:209], v220 offset:0
    ds_read_b64 a[210:211], v220 offset:512
    ds_read_b64_tr_b16 a[192:193], v216 offset:0
    ds_read_b64_tr_b16 a[194:195], v216 offset:4096
    ds_read_b64_tr_b16 a[196:197], v217 offset:0
    ds_read_b64_tr_b16 a[198:199], v217 offset:4096
    ds_read_b64_tr_b16 a[200:201], v218 offset:0
    ds_read_b64_tr_b16 a[202:203], v218 offset:4096
    ds_read_b64_tr_b16 a[204:205], v219 offset:0
    s_mov_b32 m0, s5
    v_mfma_f32_16x16x32_bf16 v[112:115], a[128:131], a[156:159], v[112:115]
    ds_read_b64_tr_b16 a[206:207], v219 offset:4096
    buffer_load_dwordx4 v21, s[32:35], 0 offen sc1 lds
    v_mfma_f32_16x16x32_bf16 v[116:119], a[132:135], a[156:159], v[116:119]
    ds_read_b64 a[212:213], v220 offset:1024
    v_mfma_f32_16x16x32_bf16 v[100:103], a[132:135], a[152:155], v[100:103]
    ds_read_b64 a[214:215], v220 offset:1536
    v_mfma_f32_16x16x32_bf16 v[104:107], a[136:139], a[152:155], v[104:107]
    ds_read_b64 a[216:217], v221 offset:0
    v_mfma_f32_16x16x32_bf16 v[120:123], a[136:139], a[156:159], v[120:123]
    ds_read_b64 a[218:219], v221 offset:512
    v_mfma_f32_16x16x32_bf16 v[124:127], a[140:143], a[156:159], v[124:127]
    ds_read_b64 a[220:221], v221 offset:1024
    s_mov_b32 s78, 64512
    v_mfma_f32_16x16x32_bf16 v[108:111], a[140:143], a[152:155], v[108:111]
    ds_read_b64 a[222:223], v221 offset:1536
    buffer_load_dwordx4 v21, s[32:35], s78 offen offset:1024 sc1 lds
    v_mfma_f32_16x16x32_bf16 v[96:99], a[160:163], a[184:187], v[96:99]
    ds_read_b64 a[240:241], v220 offset:8192
    v_mfma_f32_16x16x32_bf16 v[112:115], a[160:163], a[188:191], v[112:115]
    ds_read_b64 a[242:243], v220 offset:8704
    v_mfma_f32_16x16x32_bf16 v[116:119], a[164:167], a[188:191], v[116:119]
    ds_read_b64_tr_b16 a[224:225], v216 offset:8192
    v_mfma_f32_16x16x32_bf16 v[100:103], a[164:167], a[184:187], v[100:103]
    ds_read_b64_tr_b16 a[226:227], v216 offset:12288
    v_mfma_f32_16x16x32_bf16 v[104:107], a[168:171], a[184:187], v[104:107]
    ds_read_b64_tr_b16 a[228:229], v217 offset:8192
    s_mov_b32 s78, 129024
    v_mfma_f32_16x16x32_bf16 v[120:123], a[168:171], a[188:191], v[120:123]
    ds_read_b64_tr_b16 a[230:231], v217 offset:12288
    buffer_load_dwordx4 v21, s[32:35], s78 offen offset:2048 sc1 lds
    v_mfma_f32_16x16x32_bf16 v[124:127], a[172:175], a[188:191], v[124:127]
    ds_read_b64_tr_b16 a[232:233], v218 offset:8192
    v_mfma_f32_16x16x32_bf16 v[108:111], a[172:175], a[184:187], v[108:111]
    ds_read_b64_tr_b16 a[234:235], v218 offset:12288
    v_mfma_f32_16x16x32_bf16 v[64:67], a[128:131], a[144:147], v[64:67]
    ds_read_b64_tr_b16 a[236:237], v219 offset:8192
    v_mfma_f32_16x16x32_bf16 v[80:83], a[128:131], a[148:151], v[80:83]
    ds_read_b64_tr_b16 a[238:239], v219 offset:12288
    v_mfma_f32_16x16x32_bf16 v[84:87], a[132:135], a[148:151], v[84:87]
    ds_read_b64 a[244:245], v220 offset:9216
    s_mov_b32 s78, 193536
    v_mfma_f32_16x16x32_bf16 v[68:71], a[132:135], a[144:147], v[68:71]
    ds_read_b64 a[246:247], v220 offset:9728
    buffer_load_dwordx4 v21, s[32:35], s78 offen offset:3072 sc1 lds
    v_mfma_f32_16x16x32_bf16 v[72:75], a[136:139], a[144:147], v[72:75]
    ds_read_b64 a[248:249], v221 offset:8192
    v_mfma_f32_16x16x32_bf16 v[88:91], a[136:139], a[148:151], v[88:91]
    ds_read_b64 a[250:251], v221 offset:8704
    v_mfma_f32_16x16x32_bf16 v[92:95], a[140:143], a[148:151], v[92:95]
    ds_read_b64 a[252:253], v221 offset:9216
    v_mfma_f32_16x16x32_bf16 v[76:79], a[140:143], a[144:147], v[76:79]
    ds_read_b64 a[254:255], v221 offset:9728
    s_waitcnt lgkmcnt(0)
    v_mfma_f32_16x16x32_bf16 v[96:99], a[192:195], a[216:219], v[96:99]
    v_mfma_f32_16x16x32_bf16 v[112:115], a[192:195], a[220:223], v[112:115]
    v_mfma_f32_16x16x32_bf16 v[116:119], a[196:199], a[220:223], v[116:119]
    v_mfma_f32_16x16x32_bf16 v[100:103], a[196:199], a[216:219], v[100:103]
    v_mfma_f32_16x16x32_bf16 v[104:107], a[200:203], a[216:219], v[104:107]
    v_mfma_f32_16x16x32_bf16 v[120:123], a[200:203], a[220:223], v[120:123]
    v_mfma_f32_16x16x32_bf16 v[124:127], a[204:207], a[220:223], v[124:127]
    v_mfma_f32_16x16x32_bf16 v[108:111], a[204:207], a[216:219], v[108:111]
    v_mfma_f32_16x16x32_bf16 v[96:99], a[224:227], a[248:251], v[96:99]
    v_mfma_f32_16x16x32_bf16 v[112:115], a[224:227], a[252:255], v[112:115]
    v_mfma_f32_16x16x32_bf16 v[116:119], a[228:231], a[252:255], v[116:119]
    v_mfma_f32_16x16x32_bf16 v[100:103], a[228:231], a[248:251], v[100:103]
    v_mfma_f32_16x16x32_bf16 v[104:107], a[232:235], a[248:251], v[104:107]
    v_mfma_f32_16x16x32_bf16 v[120:123], a[232:235], a[252:255], v[120:123]
    v_mfma_f32_16x16x32_bf16 v[124:127], a[236:239], a[252:255], v[124:127]
    v_mfma_f32_16x16x32_bf16 v[108:111], a[236:239], a[248:251], v[108:111]
    v_mfma_f32_16x16x32_bf16 v[64:67], a[160:163], a[176:179], v[64:67]
    s_nop 3
    v_mfma_f32_16x16x32_bf16 v[80:83], a[160:163], a[180:183], v[80:83]
    v_mfma_f32_16x16x32_bf16 v[84:87], a[164:167], a[180:183], v[84:87]
    v_mfma_f32_16x16x32_bf16 v[68:71], a[164:167], a[176:179], v[68:71]
    v_mfma_f32_16x16x32_bf16 v[72:75], a[168:171], a[176:179], v[72:75]
    v_cvt_pk_bf16_f32 v144, v96, v97
    v_cvt_pk_bf16_f32 v145, v98, v99
    v_mfma_f32_16x16x32_bf16 v[88:91], a[168:171], a[180:183], v[88:91]
    v_cvt_pk_bf16_f32 v146, v100, v101
    v_cvt_pk_bf16_f32 v147, v102, v103
    v_mfma_f32_16x16x32_bf16 v[92:95], a[172:175], a[180:183], v[92:95]
    v_cvt_pk_bf16_f32 v148, v104, v105
    v_cvt_pk_bf16_f32 v149, v106, v107
    buffer_store_dwordx4 v[144:147], v2, s[36:39], s83 offen offset:0 sc1
    v_mfma_f32_16x16x32_bf16 v[76:79], a[172:175], a[176:179], v[76:79]
    v_cvt_pk_bf16_f32 v150, v108, v109
    v_cvt_pk_bf16_f32 v151, v110, v111
    v_mfma_f32_16x16x32_bf16 v[64:67], a[192:195], a[208:211], v[64:67]
    v_cvt_pk_bf16_f32 v152, v112, v113
    v_cvt_pk_bf16_f32 v153, v114, v115
    buffer_store_dwordx4 v[148:151], v2, s[36:39], s83 offen offset:1024 sc1
    v_mfma_f32_16x16x32_bf16 v[80:83], a[192:195], a[212:215], v[80:83]
    v_cvt_pk_bf16_f32 v154, v116, v117
    v_cvt_pk_bf16_f32 v155, v118, v119
    v_mfma_f32_16x16x32_bf16 v[84:87], a[196:199], a[212:215], v[84:87]
    v_cvt_pk_bf16_f32 v156, v120, v121
    v_cvt_pk_bf16_f32 v157, v122, v123
    buffer_store_dwordx4 v[152:155], v2, s[36:39], s83 offen offset:2048 sc1
    v_mfma_f32_16x16x32_bf16 v[68:71], a[196:199], a[208:211], v[68:71]
    v_cvt_pk_bf16_f32 v158, v124, v125
    v_cvt_pk_bf16_f32 v159, v126, v127
    v_mfma_f32_16x16x32_bf16 v[72:75], a[200:203], a[208:211], v[72:75]
    buffer_store_dwordx4 v[156:159], v2, s[36:39], s83 offen offset:3072 sc1
    v_mfma_f32_16x16x32_bf16 v[88:91], a[200:203], a[212:215], v[88:91]
    v_mfma_f32_16x16x32_bf16 v[92:95], a[204:207], a[212:215], v[92:95]
    s_waitcnt vmcnt(4)
    v_mfma_f32_16x16x32_bf16 v[76:79], a[204:207], a[208:211], v[76:79]
    ds_read_b64_tr_b16 v[224:225], v7 offset:0
    v_mfma_f32_16x16x32_bf16 v[64:67], a[224:227], a[240:243], v[64:67]
    ds_read_b64_tr_b16 v[226:227], v7 offset:256
    v_mfma_f32_16x16x32_bf16 v[80:83], a[224:227], a[244:247], v[80:83]
    ds_read_b64_tr_b16 v[228:229], v7 offset:2048
    v_mfma_f32_16x16x32_bf16 v[84:87], a[228:231], a[244:247], v[84:87]
    ds_read_b64_tr_b16 v[230:231], v7 offset:2304
    v_mfma_f32_16x16x32_bf16 v[68:71], a[228:231], a[240:243], v[68:71]
    ds_read_b64_tr_b16 v[232:233], v7 offset:32
    v_mfma_f32_16x16x32_bf16 v[72:75], a[232:235], a[240:243], v[72:75]
    ds_read_b64_tr_b16 v[234:235], v7 offset:288
    v_mfma_f32_16x16x32_bf16 v[88:91], a[232:235], a[244:247], v[88:91]
    ds_read_b64_tr_b16 v[236:237], v7 offset:2080
    v_mfma_f32_16x16x32_bf16 v[92:95], a[236:239], a[244:247], v[92:95]
    ds_read_b64_tr_b16 v[238:239], v7 offset:2336
    v_mfma_f32_16x16x32_bf16 v[76:79], a[236:239], a[240:243], v[76:79]
    s_waitcnt lgkmcnt(0)
    s_nop 6
    buffer_load_dwordx4 v[128:131], v2, s[36:39], s84 offen offset:0 sc1
    buffer_load_dwordx4 v[132:135], v2, s[36:39], s84 offen offset:1024 sc1
    buffer_load_dwordx4 v[136:139], v2, s[36:39], s84 offen offset:2048 sc1
    buffer_load_dwordx4 v[140:143], v2, s[36:39], s84 offen offset:3072 sc1
    v_permlane16_swap_b32 v64, v68
    v_permlane16_swap_b32 v65, v69
    v_permlane16_swap_b32 v66, v70
    v_permlane16_swap_b32 v67, v71
    v_lshlrev_b32 v52, 16, v32
    v_and_b32 v53, 0xffff0000, v32
    v_lshlrev_b32 v56, 16, v224
    v_and_b32 v57, 0xffff0000, v224
    v_pk_add_f32 v[54:55], v[52:53], v[48:49] op_sel_hi:[1,0]
    v_pk_add_f32 v[64:65], v[64:65], v[52:53]
    v_pk_mul_f32 v[54:55], v[54:55], v[48:49] op_sel:[0,1] op_sel_hi:[1,1]
    v_pk_fma_f32 v[64:65], v[54:55], v[56:57], v[64:65]
    v_lshlrev_b32 v52, 16, v33
    v_and_b32 v53, 0xffff0000, v33
    v_lshlrev_b32 v56, 16, v225
    v_and_b32 v57, 0xffff0000, v225
    v_pk_add_f32 v[54:55], v[52:53], v[48:49] op_sel_hi:[1,0]
    v_pk_add_f32 v[66:67], v[66:67], v[52:53]
    v_pk_mul_f32 v[54:55], v[54:55], v[48:49] op_sel:[0,1] op_sel_hi:[1,1]
    v_pk_fma_f32 v[66:67], v[54:55], v[56:57], v[66:67]
    v_lshlrev_b32 v52, 16, v34
    v_and_b32 v53, 0xffff0000, v34
    v_lshlrev_b32 v56, 16, v226
    v_and_b32 v57, 0xffff0000, v226
    v_pk_add_f32 v[54:55], v[52:53], v[48:49] op_sel_hi:[1,0]
    v_pk_add_f32 v[68:69], v[68:69], v[52:53]
    v_pk_mul_f32 v[54:55], v[54:55], v[48:49] op_sel:[0,1] op_sel_hi:[1,1]
    v_pk_fma_f32 v[68:69], v[54:55], v[56:57], v[68:69]
    v_lshlrev_b32 v52, 16, v35
    v_and_b32 v53, 0xffff0000, v35
    v_lshlrev_b32 v56, 16, v227
    v_and_b32 v57, 0xffff0000, v227
    v_pk_add_f32 v[54:55], v[52:53], v[48:49] op_sel_hi:[1,0]
    v_pk_add_f32 v[70:71], v[70:71], v[52:53]
    v_pk_mul_f32 v[54:55], v[54:55], v[48:49] op_sel:[0,1] op_sel_hi:[1,1]
    v_pk_fma_f32 v[70:71], v[54:55], v[56:57], v[70:71]
    v_permlane16_swap_b32 v72, v76
    v_permlane16_swap_b32 v73, v77
    v_permlane16_swap_b32 v74, v78
    v_permlane16_swap_b32 v75, v79
    v_lshlrev_b32 v52, 16, v36
    v_and_b32 v53, 0xffff0000, v36
    v_lshlrev_b32 v56, 16, v228
    v_and_b32 v57, 0xffff0000, v228
    v_pk_add_f32 v[54:55], v[52:53], v[48:49] op_sel_hi:[1,0]
    v_pk_add_f32 v[72:73], v[72:73], v[52:53]
    v_pk_mul_f32 v[54:55], v[54:55], v[48:49] op_sel:[0,1] op_sel_hi:[1,1]
    v_pk_fma_f32 v[72:73], v[54:55], v[56:57], v[72:73]
    v_lshlrev_b32 v52, 16, v37
    v_and_b32 v53, 0xffff0000, v37
    v_lshlrev_b32 v56, 16, v229
    v_and_b32 v57, 0xffff0000, v229
    v_pk_add_f32 v[54:55], v[52:53], v[48:49] op_sel_hi:[1,0]
    v_pk_add_f32 v[74:75], v[74:75], v[52:53]
    v_pk_mul_f32 v[54:55], v[54:55], v[48:49] op_sel:[0,1] op_sel_hi:[1,1]
    v_pk_fma_f32 v[74:75], v[54:55], v[56:57], v[74:75]
    v_lshlrev_b32 v52, 16, v38
    v_and_b32 v53, 0xffff0000, v38
    v_lshlrev_b32 v56, 16, v230
    v_and_b32 v57, 0xffff0000, v230
    v_pk_add_f32 v[54:55], v[52:53], v[48:49] op_sel_hi:[1,0]
    v_pk_add_f32 v[76:77], v[76:77], v[52:53]
    v_pk_mul_f32 v[54:55], v[54:55], v[48:49] op_sel:[0,1] op_sel_hi:[1,1]
    v_pk_fma_f32 v[76:77], v[54:55], v[56:57], v[76:77]
    v_lshlrev_b32 v52, 16, v39
    v_and_b32 v53, 0xffff0000, v39
    v_lshlrev_b32 v56, 16, v231
    v_and_b32 v57, 0xffff0000, v231
    v_pk_add_f32 v[54:55], v[52:53], v[48:49] op_sel_hi:[1,0]
    v_pk_add_f32 v[78:79], v[78:79], v[52:53]
    v_pk_mul_f32 v[54:55], v[54:55], v[48:49] op_sel:[0,1] op_sel_hi:[1,1]
    v_pk_fma_f32 v[78:79], v[54:55], v[56:57], v[78:79]
    v_permlane16_swap_b32 v80, v84
    v_permlane16_swap_b32 v81, v85
    v_permlane16_swap_b32 v82, v86
    v_permlane16_swap_b32 v83, v87
    v_lshlrev_b32 v52, 16, v40
    v_and_b32 v53, 0xffff0000, v40
    v_lshlrev_b32 v56, 16, v232
    v_and_b32 v57, 0xffff0000, v232
    v_pk_add_f32 v[54:55], v[52:53], v[50:51] op_sel_hi:[1,0]
    v_pk_add_f32 v[80:81], v[80:81], v[52:53]
    v_pk_mul_f32 v[54:55], v[54:55], v[50:51] op_sel:[0,1] op_sel_hi:[1,1]
    v_pk_fma_f32 v[80:81], v[54:55], v[56:57], v[80:81]
    v_lshlrev_b32 v52, 16, v41
    v_and_b32 v53, 0xffff0000, v41
    v_lshlrev_b32 v56, 16, v233
    v_and_b32 v57, 0xffff0000, v233
    v_pk_add_f32 v[54:55], v[52:53], v[50:51] op_sel_hi:[1,0]
    v_pk_add_f32 v[82:83], v[82:83], v[52:53]
    v_pk_mul_f32 v[54:55], v[54:55], v[50:51] op_sel:[0,1] op_sel_hi:[1,1]
    v_pk_fma_f32 v[82:83], v[54:55], v[56:57], v[82:83]
    v_lshlrev_b32 v52, 16, v42
    v_and_b32 v53, 0xffff0000, v42
    v_lshlrev_b32 v56, 16, v234
    v_and_b32 v57, 0xffff0000, v234
    v_pk_add_f32 v[54:55], v[52:53], v[50:51] op_sel_hi:[1,0]
    v_pk_add_f32 v[84:85], v[84:85], v[52:53]
    v_pk_mul_f32 v[54:55], v[54:55], v[50:51] op_sel:[0,1] op_sel_hi:[1,1]
    v_pk_fma_f32 v[84:85], v[54:55], v[56:57], v[84:85]
    v_lshlrev_b32 v52, 16, v43
    v_and_b32 v53, 0xffff0000, v43
    v_lshlrev_b32 v56, 16, v235
    v_and_b32 v57, 0xffff0000, v235
    v_pk_add_f32 v[54:55], v[52:53], v[50:51] op_sel_hi:[1,0]
    v_pk_add_f32 v[86:87], v[86:87], v[52:53]
    v_pk_mul_f32 v[54:55], v[54:55], v[50:51] op_sel:[0,1] op_sel_hi:[1,1]
    v_pk_fma_f32 v[86:87], v[54:55], v[56:57], v[86:87]
    v_permlane16_swap_b32 v88, v92
    v_permlane16_swap_b32 v89, v93
    v_permlane16_swap_b32 v90, v94
    v_permlane16_swap_b32 v91, v95
    v_lshlrev_b32 v52, 16, v44
    v_and_b32 v53, 0xffff0000, v44
    v_lshlrev_b32 v56, 16, v236
    v_and_b32 v57, 0xffff0000, v236
    v_pk_add_f32 v[54:55], v[52:53], v[50:51] op_sel_hi:[1,0]
    v_pk_add_f32 v[88:89], v[88:89], v[52:53]
    v_pk_mul_f32 v[54:55], v[54:55], v[50:51] op_sel:[0,1] op_sel_hi:[1,1]
    v_pk_fma_f32 v[88:89], v[54:55], v[56:57], v[88:89]
    v_lshlrev_b32 v52, 16, v45
    v_and_b32 v53, 0xffff0000, v45
    v_lshlrev_b32 v56, 16, v237
    v_and_b32 v57, 0xffff0000, v237
    v_pk_add_f32 v[54:55], v[52:53], v[50:51] op_sel_hi:[1,0]
    v_pk_add_f32 v[90:91], v[90:91], v[52:53]
    v_pk_mul_f32 v[54:55], v[54:55], v[50:51] op_sel:[0,1] op_sel_hi:[1,1]
    v_pk_fma_f32 v[90:91], v[54:55], v[56:57], v[90:91]
    v_lshlrev_b32 v52, 16, v46
    v_and_b32 v53, 0xffff0000, v46
    v_lshlrev_b32 v56, 16, v238
    v_and_b32 v57, 0xffff0000, v238
    v_pk_add_f32 v[54:55], v[52:53], v[50:51] op_sel_hi:[1,0]
    v_pk_add_f32 v[92:93], v[92:93], v[52:53]
    v_pk_mul_f32 v[54:55], v[54:55], v[50:51] op_sel:[0,1] op_sel_hi:[1,1]
    v_pk_fma_f32 v[92:93], v[54:55], v[56:57], v[92:93]
    v_lshlrev_b32 v52, 16, v47
    v_and_b32 v53, 0xffff0000, v47
    v_lshlrev_b32 v56, 16, v239
    v_and_b32 v57, 0xffff0000, v239
    v_pk_add_f32 v[54:55], v[52:53], v[50:51] op_sel_hi:[1,0]
    v_pk_add_f32 v[94:95], v[94:95], v[52:53]
    v_pk_mul_f32 v[54:55], v[54:55], v[50:51] op_sel:[0,1] op_sel_hi:[1,1]
    v_pk_fma_f32 v[94:95], v[54:55], v[56:57], v[94:95]
    s_mov_b32 s82, 0
L_px_chk:
    s_waitcnt vmcnt(0)
    v_max3_u32 v52, v128, v129, v130
    v_max3_u32 v52, v52, v131, v132
    v_max3_u32 v52, v52, v133, v134
    v_max3_u32 v52, v52, v135, v136
    v_max3_u32 v52, v52, v137, v138
    v_max3_u32 v52, v52, v139, v140
    v_max3_u32 v52, v52, v141, v142
    v_max_u32 v52, v52, v143
    v_cmp_ne_u32 vcc, -1, v52
    s_cmp_eq_u64 vcc, exec
    s_cbranch_scc1 L_px_ok
    buffer_load_dwordx4 v[128:131], v2, s[36:39], s84 offen offset:0 sc1
    buffer_load_dwordx4 v[132:135], v2, s[36:39], s84 offen offset:1024 sc1
    buffer_load_dwordx4 v[136:139], v2, s[36:39], s84 offen offset:2048 sc1
    buffer_load_dwordx4 v[140:143], v2, s[36:39], s84 offen offset:3072 sc1
    s_add_u32 s82, s82, 1
    s_cmp_lt_u32 s82, 200000
    s_cbranch_scc1 L_px_chk
    s_waitcnt vmcnt(0)
L_px_ok:
    v_permlane16_swap_b32 v128, v130
    v_permlane16_swap_b32 v129, v131
    v_lshlrev_b32 v52, 16, v128
    v_and_b32 v53, 0xffff0000, v128
    v_lshlrev_b32 v54, 16, v129
    v_and_b32 v55, 0xffff0000, v129
    v_lshlrev_b32 v56, 16, v130
    v_and_b32 v57, 0xffff0000, v130
    v_lshlrev_b32 v58, 16, v131
    v_and_b32 v59, 0xffff0000, v131
    v_pk_add_f32 v[64:65], v[64:65], v[52:53]
    v_pk_add_f32 v[66:67], v[66:67], v[54:55]
    v_pk_add_f32 v[68:69], v[68:69], v[56:57]
    v_pk_add_f32 v[70:71], v[70:71], v[58:59]
    v_cvt_pk_bf16_f32 v96, v64, v65
    v_cvt_pk_bf16_f32 v97, v66, v67
    v_cvt_pk_bf16_f32 v98, v68, v69
    v_cvt_pk_bf16_f32 v99, v70, v71
    buffer_store_dwordx4 v[96:99], v24, s[48:51], 0 offen offset:0 sc1
    v_permlane16_swap_b32 v132, v134
    v_permlane16_swap_b32 v133, v135
    v_lshlrev_b32 v52, 16, v132
    v_and_b32 v53, 0xffff0000, v132
    v_lshlrev_b32 v54, 16, v133
    v_and_b32 v55, 0xffff0000, v133
    v_lshlrev_b32 v56, 16, v134
    v_and_b32 v57, 0xffff0000, v134
    v_lshlrev_b32 v58, 16, v135
    v_and_b32 v59, 0xffff0000, v135
    v_pk_add_f32 v[72:73], v[72:73], v[52:53]
    v_pk_add_f32 v[74:75], v[74:75], v[54:55]
    v_pk_add_f32 v[76:77], v[76:77], v[56:57]
    v_pk_add_f32 v[78:79], v[78:79], v[58:59]
    v_cvt_pk_bf16_f32 v100, v72, v73
    v_cvt_pk_bf16_f32 v101, v74, v75
    v_cvt_pk_bf16_f32 v102, v76, v77
    v_cvt_pk_bf16_f32 v103, v78, v79
    buffer_store_dwordx4 v[100:103], v24, s[48:51], 0 offen offset:64 sc1
    v_permlane16_swap_b32 v136, v138
    v_permlane16_swap_b32 v137, v139
    v_lshlrev_b32 v52, 16, v136
    v_and_b32 v53, 0xffff0000, v136
    v_lshlrev_b32 v54, 16, v137
    v_and_b32 v55, 0xffff0000, v137
    v_lshlrev_b32 v56, 16, v138
    v_and_b32 v57, 0xffff0000, v138
    v_lshlrev_b32 v58, 16, v139
    v_and_b32 v59, 0xffff0000, v139
    v_pk_add_f32 v[80:81], v[80:81], v[52:53]
    v_pk_add_f32 v[82:83], v[82:83], v[54:55]
    v_pk_add_f32 v[84:85], v[84:85], v[56:57]
    v_pk_add_f32 v[86:87], v[86:87], v[58:59]
    v_cvt_pk_bf16_f32 v104, v80, v81
    v_cvt_pk_bf16_f32 v105, v82, v83
    v_cvt_pk_bf16_f32 v106, v84, v85
    v_cvt_pk_bf16_f32 v107, v86, v87
    buffer_store_dwordx4 v[104:107], v25, s[48:51], 0 offen offset:0 sc1
    v_permlane16_swap_b32 v140, v142
    v_permlane16_swap_b32 v141, v143
    v_lshlrev_b32 v52, 16, v140
    v_and_b32 v53, 0xffff0000, v140
    v_lshlrev_b32 v54, 16, v141
    v_and_b32 v55, 0xffff0000, v141
    v_lshlrev_b32 v56, 16, v142
    v_and_b32 v57, 0xffff0000, v142
    v_lshlrev_b32 v58, 16, v143
    v_and_b32 v59, 0xffff0000, v143
    v_pk_add_f32 v[88:89], v[88:89], v[52:53]
    v_pk_add_f32 v[90:91], v[90:91], v[54:55]
    v_pk_add_f32 v[92:93], v[92:93], v[56:57]
    v_pk_add_f32 v[94:95], v[94:95], v[58:59]
    v_cvt_pk_bf16_f32 v108, v88, v89
    v_cvt_pk_bf16_f32 v109, v90, v91
    v_cvt_pk_bf16_f32 v110, v92, v93
    v_cvt_pk_bf16_f32 v111, v94, v95
    buffer_store_dwordx4 v[108:111], v25, s[48:51], 0 offen offset:64 sc1
L_end:
    s_endpgm
.section .rodata,"a"
.p2align 6
.amdhsa_kernel parallel_sum__ssm_conv_h3__swiglu_ffn__prompt_kernel
  .amdhsa_next_free_vgpr 512
  .amdhsa_next_free_sgpr 102
  .amdhsa_accum_offset 256
  .amdhsa_group_segment_fixed_size 0
  .amdhsa_kernarg_size 104
  .amdhsa_user_sgpr_count 2
  .amdhsa_user_sgpr_kernarg_segment_ptr 1
  .amdhsa_system_sgpr_workgroup_id_x 1
  .amdhsa_float_denorm_mode_32 3
.end_amdhsa_kernel
```
